```python
import torch

def _softmax(x, axis=-1):
    return torch.softmax(x, dim=axis)
def _gelu(x):
    return torch.nn.functional.gelu(x, approximate="tanh")
def _silu(x):
    return torch.nn.functional.silu(x)
def _sigmoid(x):
    return torch.sigmoid(x)
def _layernorm(x, axis=-1, eps=1e-5):
    m = x.mean(dim=axis, keepdim=True)
    v = x.var(dim=axis, keepdim=True, unbiased=False)
    return (x - m) / torch.sqrt(v + eps)
def _scatter_add(tgt, idx, src, axis=0):
    return tgt.clone().index_add_(axis, idx, src)
def _segment_sum(src, seg, n):
    out = torch.zeros((n,) + src.shape[1:], dtype=src.dtype)
    return out.index_add_(0, seg, src)
def _pad(x, pw):
    flat = tuple(v for pair in reversed(pw) for v in pair)
    return torch.nn.functional.pad(x, flat)

kernel_name = 'gated_mix__ssm_conv_s5__dense_activation_squared_relu__prompt'

def setup_inputs():

    _w = (lambda a: (lambda t: t.to(torch.bfloat16) if t.is_floating_point() else t)(torch.as_tensor(a)))
    def _A_setup():
        B, S, D = 1, 2048, 640
        P = D
        Lambda_re = -0.5 * (lambda _x: torch.exp(torch.as_tensor(_x)))((lambda *s: torch.randn(*s, dtype=torch.bfloat16) * 0.4)(P))
        Lambda_im = (lambda *s: torch.randn(*s, dtype=torch.bfloat16) * 0.8)(P) * 1.0
        B_re = (lambda *s: torch.randn(*s, dtype=torch.bfloat16) * 0.8)(P, D) * (D ** -0.5)
        B_im = (lambda *s: torch.randn(*s, dtype=torch.bfloat16) * 0.8)(P, D) * (D ** -0.5)
        C_re = (lambda *s: torch.randn(*s, dtype=torch.bfloat16) * 0.4)(D, P) * (P ** -0.5)
        C_im = (lambda *s: torch.randn(*s, dtype=torch.bfloat16) * 0.8)(D, P) * (P ** -0.5)
        log_dt = (lambda *s: torch.randn(*s, dtype=torch.bfloat16) * 0.4)(P) * 0.3 - 2.0
        Dskip = (lambda *s: torch.randn(*s, dtype=torch.bfloat16) * 0.2)(D)
        return {
            "x": _w((lambda *s: torch.randn(*s, dtype=torch.bfloat16) * 0.05)(B, S, D)),
            "Lambda_re": _w(Lambda_re),
            "Lambda_im": _w(Lambda_im),
            "B_re": _w(B_re),
            "B_im": _w(B_im),
            "C_re": _w(C_re),
            "C_im": _w(C_im),
            "log_dt": _w(log_dt),
            "Dskip": _w(Dskip),
        }
    _A_in = _A_setup()

    def _B_setup():
        B, S, D, F = 1, 2048, 640, 1536
        return {
            "x": _w((lambda *s: torch.randn(*s, dtype=torch.bfloat16) * 0.05)(B, S, D)),
            "w1": _w((lambda *s: torch.randn(*s, dtype=torch.bfloat16) * 0.05)(D, F)),
            "b1": _w((lambda *s: torch.randn(*s, dtype=torch.bfloat16) * 0.05)(F)),
            "w2": _w((lambda *s: torch.randn(*s, dtype=torch.bfloat16) * 0.05)(F, D)),
            "b2": _w((lambda *s: torch.randn(*s, dtype=torch.bfloat16) * 0.05)(D)),
        }
    _B_in = _B_setup()

    return {
        "A_x": _A_in["x"],
        "A_Lambda_re": _A_in["Lambda_re"],
        "A_Lambda_im": _A_in["Lambda_im"],
        "A_B_re": _A_in["B_re"],
        "A_B_im": _A_in["B_im"],
        "A_C_re": _A_in["C_re"],
        "A_C_im": _A_in["C_im"],
        "A_log_dt": _A_in["log_dt"],
        "A_Dskip": _A_in["Dskip"],
        "B_x": _B_in["x"],
        "B_w1": _B_in["w1"],
        "B_b1": _B_in["b1"],
        "B_w2": _B_in["w2"],
        "B_b2": _B_in["b2"],
        "gate_w": _w((lambda *s: torch.randn(*s, dtype=torch.bfloat16) * 0.05)(640) * 16.0),
    }

def reference(A_x, A_Lambda_re, A_Lambda_im, A_B_re, A_B_im, A_C_re, A_C_im, A_log_dt, A_Dskip, B_x, B_w1, B_b1, B_w2, B_b2, gate_w):
    def _A_ref(x, Lambda_re, Lambda_im, B_re, B_im, C_re, C_im, log_dt, Dskip):
        Bsz, L, H = x.shape
        Lam = Lambda_re + 1j * Lambda_im
        Bmat = B_re + 1j * B_im
        Cmat = C_re + 1j * C_im
        dt = torch.exp(log_dt)
        Lam_bar = torch.exp(dt * Lam)
        B_bar = ((Lam_bar - 1.0) / Lam)[:, None] * Bmat
        Bu = torch.einsum("bld,pd->blp", x + 0j, B_bar)
        h = torch.zeros_like(Bu[:, 0, :])
        hs = []
        for t in range(L):
            h = Lam_bar[None, :] * h + Bu[:, t, :]
            hs.append(h)
        hseq = torch.stack(hs, 1)
        y = 2.0 * torch.einsum("blp,dp->bld", hseq, Cmat).real + x * Dskip[None, None, :]
        return y

    def _B_ref(x, w1, b1, w2, b2):
        h = torch.einsum("bsd,df->bsf", x, w1) + b1
        zero = torch.zeros_like(h)
        r = torch.where(h > zero, h, zero)
        h = r * r
        out = torch.einsum("bsf,fd->bsd", h, w2) + b2
        return out

    x = A_x
    g = _sigmoid((x * gate_w).sum(-1, keepdims=True))
    a = _A_ref(x, A_Lambda_re, A_Lambda_im, A_B_re, A_B_im, A_C_re, A_C_im, A_log_dt, A_Dskip)
    b = _B_ref(x, B_w1, B_b1, B_w2, B_b2)
    return g * a + (1 - g) * b
```

```asm
; @launch grid=(256,1,1) block=(256,1,1) lds=163840
.amdgcn_target "amdgcn-amd-amdhsa--gfx950"
.text
.globl gated_mix__ssm_conv_s5__dense_activation_squared_relu__prompt_kernel
.p2align 8
.type gated_mix__ssm_conv_s5__dense_activation_squared_relu__prompt_kernel,@function
gated_mix__ssm_conv_s5__dense_activation_squared_relu__prompt_kernel:
    s_cmp_ge_u32 s2, 256
    s_cbranch_scc1 L_end
    s_load_dwordx16 s[4:19], s[0:1], 0
    s_load_dwordx8 s[20:27], s[0:1], 64
    s_load_dwordx8 s[28:35], s[0:1], 96
    s_load_dwordx4 s[36:39], s[0:1], 128
    s_memrealtime s[64:65]
    s_lshr_b32 s3, s2, 3
    s_getpc_b64 s[40:41]
L_pc_1:
    v_lshrrev_b32 v44, 4, v0
    v_lshl_add_u32 v44, s3, 4, v44
    v_lshlrev_b32 v44, 7, v44
    v_min_u32 v44, L_end-L_pc_1-4, v44
    v_mov_b32 v45, s41
    v_add_co_u32 v44, vcc, s40, v44
    s_nop 1
    v_addc_co_u32 v45, vcc, 0, v45, vcc
    global_load_dword v47, v[44:45], off
    v_and_b32 v1, 63, v0
    v_lshrrev_b32 v2, 6, v0
    s_and_b32 s81, s2, 7
    s_lshr_b32 s40, s81, 1
    s_lshl_b32 s82, s40, 2
    s_and_b32 s41, s3, 3
    v_readfirstlane_b32 s86, v2
    s_add_u32 s82, s82, s41
    s_and_b32 s81, s81, 1
    s_lshr_b32 s83, s3, 2
    s_add_u32 s41, s41, s83
    s_and_b32 s41, s41, 3
    s_lshl_b32 s41, s41, 3
    s_or_b32 s41, s41, 0x80000
    s_mul_i32 s40, s40, 5
    s_add_u32 s40, s40, 1
    s_lshr_b32 s40, s40, 1
    s_mul_i32 s60, s81, 5
    s_add_u32 s40, s40, s60
    s_sub_u32 s60, s40, 10
    s_cmp_ge_u32 s40, 10
    s_cselect_b32 s40, s60, s40
    s_bfe_u32 s70, 0x3020100, s41
    s_add_u32 s70, s70, s40
    s_sub_u32 s60, s70, 10
    s_min_u32 s70, s60, s70
    s_lshl_b32 s70, s70, 7
    s_mul_i32 s84, s81, 10
    s_lshl_b32 s85, s83, 1
    s_add_u32 s60, s83, 2
    s_cmp_lt_u32 s83, 2
    s_cselect_b32 s60, s85, s60
    s_cselect_b32 s63, 1, 1536
    s_add_u32 s84, s84, s60
    s_mul_i32 s60, s81, 12
    s_add_u32 s85, s85, s60
    s_sub_u32 s85, s85, 4
    v_lshrrev_b32 v48, 3, v1
    v_and_b32 v49, 7, v1
    v_lshrrev_b32 v50, 4, v1
    v_and_b32 v51, 3, v48
    v_lshrrev_b32 v3, 5, v1
    v_lshl_add_u32 v51, v3, 4, v51
    v_lshl_add_u32 v51, v2, 5, v51
    v_mul_u32_u24 v51, 1280, v51
    v_xor_b32 v53, v49, v50
    v_xor_b32 v54, 4, v53
    v_and_b32 v52, 1, v50
    v_xor_b32 v52, v52, v49
    v_lshl_add_u32 v4, v52, 4, v51
    v_xor_b32 v5, 32, v4
    v_add_u32 v5, 4096, v5
    v_xor_b32 v6, 64, v4
    v_add_u32 v6, 8192, v6
    v_xor_b32 v7, 96, v4
    v_add_u32 v7, 12288, v7
    v_and_b32 v55, 1, v2
    v_lshl_add_u32 v55, v55, 4, v48
    v_mul_u32_u24 v55, 1280, v55
    v_lshl_add_u32 v8, v53, 4, v55
    v_lshl_add_u32 v9, v54, 4, v55
    v_add_u32 v9, 9216, v9
    v_lshl_add_u32 v55, v2, 4, v48
    v_mul_u32_u24 v55, 3072, v55
    v_and_b32 v56, 1, v50
    v_lshlrev_b32 v56, 2, v56
    v_xor_b32 v56, v56, v49
    v_lshl_add_u32 v10, v56, 4, v55
    s_cmp_lt_u32 s83, 2
    s_cselect_b64 vcc, -1, 0
    v_add_u32 v11, 23552, v10
    v_cndmask_b32 v10, v10, v8, vcc
    v_cndmask_b32 v11, v11, v9, vcc
    s_lshl_b32 s42, s85, 7
    s_max_i32 s42, s42, 0
    s_lshl_b32 s43, s86, 13
    v_lshl_add_u32 v58, v2, 5, v1
    v_min_u32 v58, 127, v58
    v_lshlrev_b32 v59, 4, v58
    s_lshl_b32 s60, s84, 6
    v_cmp_le_u32 s[92:93], 8, v58
    v_cmp_le_u32 s[94:95], 16, v58
    v_cmp_le_u32 s[96:97], 24, v58
    v_cmp_le_u32 s[98:99], 40, v58
    v_and_b32 v60, 0x70, v59
    v_add_u32 v60, s60, v60
    v_min_u32 v60, 1264, v60
    v_subrev_u32 v61, 384, v59
    v_add_u32 v61, s42, v61
    v_cndmask_b32 v60, v60, v61, s[96:97]
    v_subrev_u32 v61, 640, v59
    v_cndmask_b32 v60, v60, v61, s[98:99]
    s_lshl_b32 s60, s81, 2
    s_and_b32 s61, s3, 3
    s_add_u32 s60, s60, s61
    s_mul_i32 s60, s60, 160
    v_and_b32 v61, 3, v58
    v_mul_u32_u24 v61, 48, v61
    v_add_u32 v61, s60, v61
    v_cmp_le_u32 vcc, 0x78, v58
    s_nop 1
    v_cndmask_b32 v60, v60, v61, vcc
    s_mov_b64 s[76:77], vcc
    v_cmp_le_u32 vcc, 0x7c, v58
    s_nop 0
    s_mov_b64 s[78:79], vcc
    v_mov_b32 v61, 0
    s_mul_i32 s60, s82, 163840
    s_mul_i32 s61, s84, 40960
    s_waitcnt lgkmcnt(0)
    s_add_u32 s44, s4, s60
    s_addc_u32 s45, s5, 0
    s_mov_b32 s46, 163840
    s_mov_b32 s47, 0x20000
    s_mov_b32 s65, s61
    s_lshl_b32 s60, s86, 9
    s_add_u32 m0, s60, 161792
    v_mov_b32 v62, s6
    v_mov_b32 v63, s7
    v_mov_b32 v64, s8
    v_mov_b32 v65, s9
    v_cndmask_b32 v62, v62, v64, s[92:93]
    v_cndmask_b32 v63, v63, v65, s[92:93]
    v_mov_b32 v64, s18
    v_mov_b32 v65, s19
    v_cndmask_b32 v62, v62, v64, s[94:95]
    v_cndmask_b32 v63, v63, v65, s[94:95]
    v_mov_b32 v64, s26
    v_mov_b32 v65, s27
    v_cndmask_b32 v62, v62, v64, s[96:97]
    v_cndmask_b32 v63, v63, v65, s[96:97]
    v_mov_b32 v64, s32
    v_mov_b32 v65, s33
    v_cndmask_b32 v62, v62, v64, s[98:99]
    v_cndmask_b32 v63, v63, v65, s[98:99]
    v_mov_b32 v64, s20
    v_mov_b32 v65, s21
    v_cndmask_b32 v62, v62, v64, s[76:77]
    v_cndmask_b32 v63, v63, v65, s[76:77]
    v_mov_b32 v64, s30
    v_mov_b32 v65, s31
    v_cndmask_b32 v62, v62, v64, s[78:79]
    v_cndmask_b32 v63, v63, v65, s[78:79]
    v_lshl_add_u64 v[62:63], v[60:61], 0, v[62:63]
    s_mov_b32 exec_hi, 0
    global_load_lds_dwordx4 v[62:63], off
    s_mov_b64 exec, -1
    s_add_u32 m0, s43, 0
    s_mul_i32 s61, s70, s63
    buffer_load_dwordx4 v4, s[44:47], s70 offen offset:0 lds
    buffer_load_dwordx4 v5, s[44:47], s70 offen offset:1024 lds
    buffer_load_dwordx4 v6, s[44:47], s70 offen offset:2048 lds
    buffer_load_dwordx4 v7, s[44:47], s70 offen offset:3072 lds
    s_cmp_lt_u32 s86, 2
    s_cselect_b32 s66, s10, s12
    s_cselect_b32 s67, s11, s13
    s_add_u32 s66, s66, s65
    s_addc_u32 s67, s67, 0
    s_add_u32 s48, s24, s42
    s_addc_u32 s49, s25, 0
    s_sub_u32 s50, 1966080, s42
    s_cmp_lt_u32 s83, 2
    s_cselect_b32 s48, s66, s48
    s_cselect_b32 s49, s67, s49
    s_cselect_b32 s50, 81920, s50
    s_mov_b32 s51, 0x20000
    s_mov_b32 s60, -1920
    s_cselect_b32 s60, 38912, s60
    s_ashr_i32 s65, s60, 31
    s_add_u32 s52, s48, s60
    s_addc_u32 s53, s49, s65
    s_sub_u32 s54, s50, s60
    s_add_u32 m0, s43, 4096
    s_mov_b32 s55, 0x20000
    buffer_load_dwordx4 v10, s[48:51], s61 offen offset:0 lds
    buffer_load_dwordx4 v11, s[48:51], s61 offen offset:1024 lds
    buffer_load_dwordx4 v10, s[52:55], s61 offen offset:2048 lds
    buffer_load_dwordx4 v11, s[52:55], s61 offen offset:3072 lds
    s_mov_b64 s[24:25], s[66:67]
    s_mov_b32 s56, s38
    s_mov_b32 s57, s39
    s_mov_b32 s58, 16777216
    s_mov_b32 s59, 0x20000
    s_or_b32 s64, s64, 1
    v_mov_b32 v45, 0
    s_or_b32 s60, s2, s86
    s_cmp_lg_u32 s60, 0
    s_cbranch_scc1 L_nn_2
    v_mov_b32 v52, s64
    s_mov_b64 exec, 1
    global_store_dword v45, v52, s[36:37] sc1
    s_mov_b64 exec, -1
L_nn_2:
    s_bfe_u32 s71, 0x4, s41
    s_add_u32 s71, s71, s40
    s_sub_u32 s60, s71, 10
    s_min_u32 s71, s60, s71
    s_lshl_b32 s71, s71, 7
    s_bfe_u32 s72, 0x1010501, s41
    s_add_u32 s72, s72, s40
    s_sub_u32 s60, s72, 10
    s_min_u32 s72, s60, s72
    s_lshl_b32 s72, s72, 7
    s_bfe_u32 s73, 0x2060202, s41
    s_add_u32 s73, s73, s40
    s_sub_u32 s60, s73, 10
    s_min_u32 s73, s60, s73
    s_lshl_b32 s73, s73, 7
    s_bfe_u32 s74, 0x7030303, s41
    s_add_u32 s74, s74, s40
    s_sub_u32 s60, s74, 10
    s_min_u32 s74, s60, s74
    s_lshl_b32 s74, s74, 7
    s_bfe_u32 s75, 0x4040408, s41
    s_add_u32 s75, s75, s40
    s_sub_u32 s60, s75, 10
    s_min_u32 s75, s60, s75
    s_lshl_b32 s75, s75, 7
    s_bfe_u32 s76, 0x5050905, s41
    s_add_u32 s76, s76, s40
    s_sub_u32 s60, s76, 10
    s_min_u32 s76, s60, s76
    s_lshl_b32 s76, s76, 7
    s_bfe_u32 s77, 0x6070606, s41
    s_add_u32 s77, s77, s40
    s_sub_u32 s60, s77, 10
    s_min_u32 s77, s60, s77
    s_lshl_b32 s77, s77, 7
    s_bfe_u32 s78, 0x8080707, s41
    s_add_u32 s78, s78, s40
    s_sub_u32 s60, s78, 10
    s_min_u32 s78, s60, s78
    s_lshl_b32 s78, s78, 7
    s_bfe_u32 s79, 0x9090809, s41
    s_add_u32 s79, s79, s40
    s_sub_u32 s60, s79, 10
    s_min_u32 s79, s60, s79
    s_lshl_b32 s79, s79, 7
    v_and_b32 v79, 31, v1
    v_lshrrev_b32 v48, 1, v79
    v_and_b32 v48, 7, v48
    v_xor_b32 v48, v48, v3
    v_lshlrev_b32 v49, 7, v79
    v_add_u32 v49, s43, v49
    v_lshrrev_b32 v50, 4, v79
    v_lshlrev_b32 v50, 13, v50
    v_and_b32 v51, 15, v79
    v_lshl_add_u32 v50, v51, 7, v50
    v_lshrrev_b32 v51, 3, v79
    v_bfe_u32 v52, v79, 1, 1
    v_lshl_add_u32 v52, v51, 1, v52
    v_xor_b32 v52, v52, v3
    v_xor_b32 v51, 0, v52
    v_lshl_add_u32 v12, v51, 4, v49
    v_xor_b32 v51, 0, v48
    v_lshl_add_u32 v20, v51, 4, v50
    v_add_u32 v16, 0x10000, v12
    v_add_u32 v24, 0x10000, v20
    v_xor_b32 v51, 2, v52
    v_lshl_add_u32 v13, v51, 4, v49
    v_xor_b32 v51, 2, v48
    v_lshl_add_u32 v21, v51, 4, v50
    v_add_u32 v17, 0x10000, v13
    v_add_u32 v25, 0x10000, v21
    v_xor_b32 v51, 4, v52
    v_lshl_add_u32 v14, v51, 4, v49
    v_xor_b32 v51, 4, v48
    v_lshl_add_u32 v22, v51, 4, v50
    v_add_u32 v18, 0x10000, v14
    v_add_u32 v26, 0x10000, v22
    v_xor_b32 v51, 6, v52
    v_lshl_add_u32 v15, v51, 4, v49
    v_xor_b32 v51, 6, v48
    v_lshl_add_u32 v23, v51, 4, v50
    v_add_u32 v19, 0x10000, v15
    v_add_u32 v27, 0x10000, v23
    v_bfe_u32 v48, v1, 2, 2
    v_lshl_add_u32 v49, v3, 3, v48
    v_lshlrev_b32 v49, 7, v49
    v_lshrrev_b32 v50, 1, v48
    v_lshl_add_u32 v49, v50, 6, v49
    v_and_b32 v50, 1, v1
    v_lshl_add_u32 v49, v50, 5, v49
    v_bfe_u32 v50, v1, 4, 1
    v_lshl_add_u32 v49, v50, 4, v49
    v_bfe_u32 v50, v1, 1, 1
    v_lshl_add_u32 v28, v50, 3, v49
    v_xor_b32 v29, 64, v28
    v_add_u32 v30, 0x10000, v28
    v_add_u32 v31, 0x10000, v29
    s_lshl_b32 s62, s81, 3
    s_add_u32 s62, s62, s83
    s_lshl_b32 s90, s62, 8
    s_lshl_b32 s62, s62, 2
    s_and_b32 s65, s86, 1
    s_lshl_b32 s65, s65, 1
    s_add_u32 s62, s62, s65
    s_lshl_b32 s65, s65, 6
    s_add_u32 s90, s90, s65
    s_lshr_b32 s65, s86, 1
    s_lshl_b32 s66, s65, 6
    s_add_u32 s62, s62, s66
    s_lshl_b32 s66, s82, 1
    s_add_u32 s65, s65, s66
    s_mul_i32 s64, s65, 360448
    s_lshl_b32 s65, s65, 12
    s_add_u32 s90, s90, s65
    s_add_u32 s90, s90, 16515072
    s_and_b32 s65, s86, 1
    s_lshl_b32 s65, s65, 11
    s_add_u32 s64, s64, s65
    v_add_u32 v48, s62, v3
    s_lshl_b32 s62, s82, 7
    v_add_lshl_u32 v89, v48, s62, 3
    v_bfe_u32 v49, v48, 2, 2
    v_bfe_u32 v50, v48, 4, 1
    v_lshl_add_u32 v49, v49, 1, v50
    v_and_b32 v50, 3, v48
    v_lshl_add_u32 v49, v49, 2, v50
    v_lshrrev_b32 v48, 5, v48
    v_lshlrev_b32 v48, 13, v48
    v_lshl_add_u32 v48, v49, 7, v48
    v_lshrrev_b32 v50, 3, v49
    v_bfe_u32 v49, v49, 1, 1
    v_lshl_add_u32 v49, v50, 1, v49
    v_lshrrev_b32 v50, 2, v79
    v_xor_b32 v49, v49, v50
    v_lshl_add_u32 v48, v49, 4, v48
    v_and_b32 v49, 3, v79
    v_lshl_add_u32 v80, v49, 2, v48
    v_add_u32 v81, 0x10000, v80
    v_lshlrev_b32 v82, 2, v79
    v_add_u32 v82, 162432, v82
    v_mov_b32 v88, 0
    s_lshr_b32 s62, s43, 1
    v_lshlrev_b32 v33, 4, v1
    v_bfe_u32 v48, v79, 2, 1
    v_lshlrev_b32 v48, 10, v48
    v_lshl_add_u32 v48, v3, 9, v48
    v_lshrrev_b32 v49, 3, v79
    v_lshl_add_u32 v48, v49, 6, v48
    v_and_b32 v49, 3, v79
    v_lshl_add_u32 v32, v49, 4, v48
    v_lshlrev_b32 v35, 3, v79
    v_add_u32 v35, 71680, v35
    v_lshl_add_u32 v48, v2, 1, v3
    v_lshl_add_u32 v34, v48, 8, v35
    s_add_u32 s6, s43, 69632
    v_lshlrev_b32 v48, 10, v3
    v_lshl_add_u32 v48, v79, 4, v48
    v_add_u32 v36, s6, v48
    v_xor_b32 v37, 0x240, v36
    v_lshrrev_b32 v48, 4, v1
    v_lshlrev_b32 v48, 7, v48
    v_bfe_u32 v49, v1, 2, 2
    v_lshl_add_u32 v48, v49, 4, v48
    v_and_b32 v49, 1, v1
    v_lshl_add_u32 v48, v49, 3, v48
    v_bfe_u32 v49, v1, 1, 1
    v_mul_u32_u24 v49, 0x240, v49
    v_add_u32 v48, v48, v49
    v_add_u32 v38, s6, v48
    v_xor_b32 v39, 64, v38
    s_sub_u32 s6, s82, 1
    s_lshl_b32 s7, s86, 2
    s_sub_u32 s6, s6, s7
    v_sub_u32 v48, s6, v3
    v_lshlrev_b32 v48, 9, v48
    v_lshl_add_u32 v40, v79, 4, v48
    s_lshr_b32 s6, s82, 2
    s_lshl_b32 s6, s6, 3
    s_lshr_b32 s7, s3, 2
    s_add_u32 s87, s6, s7
    s_lshl_b32 s6, s81, 2
    s_and_b32 s7, s3, 3
    s_add_u32 s88, s6, s7
    s_sub_u32 s6, s88, s87
    s_and_b32 s6, s6, 3
    s_lshl_b32 s6, s6, 3
    s_or_b32 s89, s6, 0x80000
    v_mul_u32_u24 v41, 5120, v2
    v_add_u32 v41, v41, v33
    v_add_u32 v42, 0x1000, v41
    v_lshl_add_u32 v44, v2, 12, v33
    s_lshl_b32 s6, s87, 12
    s_add_u32 s6, s6, 16515072
    v_lshl_add_u32 v43, v79, 7, s6
    s_mul_i32 s6, s88, 5
    s_lshr_b32 s6, s6, 2
    s_lshl_b32 s6, s6, 11
    s_add_u32 s6, s6, 16064512
    v_lshl_add_u32 v92, v79, 7, s6
    s_cmp_lt_u32 s83, 2
    s_cbranch_scc1 L_typeA
    s_bitcmp1_b32 s86, 0
    s_cselect_b64 s[66:67], -1, 0
    s_bitcmp1_b32 s86, 1
    s_cselect_b64 s[68:69], -1, 0
    s_cmp_lt_u32 s2, 224
    s_cselect_b32 s22, 1, 0
    s_cmp_lt_u32 s86, 3
    s_cselect_b32 s22, s22, 0
    s_sub_u32 s41, s2, 64
    s_lshr_b32 s65, s41, 4
    s_and_b32 s41, s41, 15
    s_mul_i32 s41, s41, 3
    s_add_u32 s41, s41, s86
    s_mul_i32 s26, s41, 40960
    s_lshl_b32 s60, s65, 7
    s_add_u32 s26, s26, s60
    s_lshl_b32 s65, s65, 2
    s_bfe_u32 s60, s41, 0x10001
    s_mul_i32 s60, s60, 24
    s_and_b32 s40, s41, 1
    s_add_u32 s60, s60, s40
    s_lshr_b32 s41, s41, 2
    s_lshl_b32 s41, s41, 1
    s_add_u32 s41, s41, s60
    s_mul_i32 s41, s41, 5120
    s_add_u32 s41, s41, 11534336
    s_mov_b32 s8, s28
    s_mov_b32 s9, s29
    s_mov_b32 s10, 1966080
    s_mov_b32 s11, 0x20000
    s_cmp_lg_u32 s22, 0
    s_cselect_b32 s10, s10, 0
    s_cselect_b32 s40, 0, 0x7ff00000
    v_add_u32 v67, s40, v33
    s_add_u32 s60, s65, 0
    s_mul_i32 s40, s60, 52
    s_lshr_b32 s40, s40, 8
    s_mul_i32 s96, s40, 445440
    s_lshl_b32 s60, s60, 10
    s_add_u32 s96, s96, s60
    s_add_u32 s96, s96, s41
    s_add_u32 s60, s65, 1
    s_mul_i32 s40, s60, 52
    s_lshr_b32 s40, s40, 8
    s_mul_i32 s97, s40, 445440
    s_lshl_b32 s60, s60, 10
    s_add_u32 s97, s97, s60
    s_add_u32 s97, s97, s41
    s_add_u32 s60, s65, 2
    s_mul_i32 s40, s60, 52
    s_lshr_b32 s40, s40, 8
    s_mul_i32 s98, s40, 445440
    s_lshl_b32 s60, s60, 10
    s_add_u32 s98, s98, s60
    s_add_u32 s98, s98, s41
    s_add_u32 s60, s65, 3
    s_mul_i32 s40, s60, 52
    s_lshr_b32 s40, s40, 8
    s_mul_i32 s99, s40, 445440
    s_lshl_b32 s60, s60, 10
    s_add_u32 s99, s99, s60
    s_add_u32 s99, s99, s41
    v_lshrrev_b32 v48, 3, v1
    v_mul_u32_u24 v48, 1280, v48
    v_and_b32 v49, 7, v1
    v_lshl_add_u32 v62, v49, 4, v48
    v_lshrrev_b32 v48, 4, v1
    v_bfe_u32 v49, v1, 2, 2
    v_lshl_add_u32 v48, v48, 3, v49
    v_lshlrev_b32 v48, 7, v48
    v_and_b32 v49, 3, v1
    v_lshl_add_u32 v48, v49, 3, v48
    s_add_u32 s60, s43, 131072
    v_add_u32 v66, s60, v48
    v_add_u32 v63, 9216, v62
    v_add_u32 v64, 18432, v62
    v_add_u32 v65, 27648, v62
    s_mov_b32 s92, s24
    s_mov_b32 s93, s25
    s_mov_b32 s94, 40960
    s_mov_b32 s95, 0x20000
    s_add_u32 m0, s43, 131072
    s_nop 0
    buffer_load_dwordx4 v62, s[8:11], s26 offen offset:0 nt lds
    buffer_load_dwordx4 v63, s[8:11], s26 offen offset:1024 nt lds
    buffer_load_dwordx4 v64, s[8:11], s26 offen offset:2048 nt lds
    buffer_load_dwordx4 v65, s[8:11], s26 offen offset:3072 nt lds
    v_lshlrev_b32 v49, 5, v3
    v_add_u32 v49, 162176, v49
    s_waitcnt vmcnt(12)
    s_barrier
    v_lshlrev_b32 v48, 1, v79
    v_add_u32 v48, 161792, v48
    ds_read_u16 v72, v48 offset:0
    ds_read_u16 v73, v48 offset:128
    ds_read_u16 v74, v48 offset:256
    v_add_u32 v83, s70, v82
    ds_read_b32 v52, v83
    v_add_u32 v83, s71, v82
    ds_read_b32 v53, v83
    v_add_u32 v83, s72, v82
    ds_read_b32 v54, v83
    v_add_u32 v83, s73, v82
    ds_read_b32 v55, v83
    v_add_u32 v83, s74, v82
    ds_read_b32 v56, v83
    v_add_u32 v83, s75, v82
    ds_read_b32 v57, v83
    v_add_u32 v83, s76, v82
    ds_read_b32 v58, v83
    v_add_u32 v83, s77, v82
    ds_read_b32 v59, v83
    v_add_u32 v83, s78, v82
    ds_read_b32 v60, v83
    v_add_u32 v83, s79, v82
    ds_read_b32 v61, v83
    ds_read_b128 v[176:179], v49 offset:0
    ds_read_b128 v[180:183], v49 offset:16
    ds_read_b128 v[184:187], v49 offset:64
    ds_read_b128 v[188:191], v49 offset:80
    ds_read_b128 v[192:195], v49 offset:128
    ds_read_b128 v[196:199], v49 offset:144
    ds_read_b128 v[200:203], v49 offset:192
    ds_read_b128 v[204:207], v49 offset:208
    s_waitcnt lgkmcnt(15)
    v_lshlrev_b32 v72, 16, v72
    v_lshlrev_b32 v73, 16, v73
    v_lshlrev_b32 v74, 16, v74
    v_mul_f32 v48, 0x3fb8aa3b, v74
    v_exp_f32 v48, v48
    v_mul_f32 v244, v72, v72
    v_cvt_pk_bf16_f32 v48, v48, v48
    v_lshlrev_b32 v48, 16, v48
    v_mul_f32 v49, v48, v73
    v_mul_f32 v48, v48, v72
    v_mul_f32 v49, 0.15915494, v49
    v_mul_f32 v48, 0x3fb8aa3b, v48
    v_fract_f32 v49, v49
    v_exp_f32 v48, v48
    v_cos_f32 v50, v49
    v_sin_f32 v51, v49
    s_add_u32 m0, s43, 32768
    s_mul_i32 s61, s71, s63
    buffer_load_dwordx4 v4, s[44:47], s71 offen offset:0 lds
    v_fmac_f32 v244, v73, v73
    v_mul_f32 v240, v48, v50
    v_mul_f32 v241, v48, v51
    v_rcp_f32 v48, v244
    v_add_f32 v50, -1.0, v240
    v_mul_f32 v242, v50, v72
    v_mul_f32 v243, v241, v72
    v_fmac_f32 v242, v241, v73
    v_fma_f32 v243, -v50, v73, v243
    v_mul_f32 v242, v242, v48
    v_mul_f32 v243, v243, v48
    v_mov_b32 v208, v240
    v_mov_b32 v224, v241
    v_mul_f32 v209, v208, v240
    v_mul_f32 v225, v208, v241
    v_fma_f32 v209, -v224, v241, v209
    buffer_load_dwordx4 v5, s[44:47], s71 offen offset:1024 lds
    v_fmac_f32 v225, v224, v240
    v_mul_f32 v210, v209, v240
    v_mul_f32 v226, v209, v241
    v_fma_f32 v210, -v225, v241, v210
    v_fmac_f32 v226, v225, v240
    v_mul_f32 v211, v210, v240
    v_mul_f32 v227, v210, v241
    v_fma_f32 v211, -v226, v241, v211
    v_fmac_f32 v227, v226, v240
    v_mul_f32 v212, v211, v240
    v_mul_f32 v228, v211, v241
    v_fma_f32 v212, -v227, v241, v212
    v_fmac_f32 v228, v227, v240
    v_mul_f32 v213, v212, v240
    v_mul_f32 v229, v212, v241
    v_fma_f32 v213, -v228, v241, v213
    buffer_load_dwordx4 v6, s[44:47], s71 offen offset:2048 lds
    v_fmac_f32 v229, v228, v240
    v_mul_f32 v214, v213, v240
    v_mul_f32 v230, v213, v241
    v_fma_f32 v214, -v229, v241, v214
    v_fmac_f32 v230, v229, v240
    v_mul_f32 v215, v214, v240
    v_mul_f32 v231, v214, v241
    v_fma_f32 v215, -v230, v241, v215
    v_fmac_f32 v231, v230, v240
    v_mul_f32 v216, v215, v240
    v_mul_f32 v232, v215, v241
    v_fma_f32 v216, -v231, v241, v216
    s_waitcnt lgkmcnt(6)
    v_lshlrev_b32 v96, 16, v176
    v_and_b32 v97, 0xffff0000, v176
    v_lshlrev_b32 v98, 16, v177
    buffer_load_dwordx4 v7, s[44:47], s71 offen offset:3072 lds
    v_and_b32 v99, 0xffff0000, v177
    v_lshlrev_b32 v100, 16, v178
    v_and_b32 v101, 0xffff0000, v178
    v_lshlrev_b32 v102, 16, v179
    v_and_b32 v103, 0xffff0000, v179
    v_lshlrev_b32 v104, 16, v180
    v_and_b32 v105, 0xffff0000, v180
    v_lshlrev_b32 v106, 16, v181
    v_and_b32 v107, 0xffff0000, v181
    v_lshlrev_b32 v108, 16, v182
    v_and_b32 v109, 0xffff0000, v182
    v_lshlrev_b32 v110, 16, v183
    v_and_b32 v111, 0xffff0000, v183
    s_waitcnt lgkmcnt(4)
    v_lshlrev_b32 v112, 16, v184
    v_and_b32 v113, 0xffff0000, v184
    s_add_u32 m0, s43, 36864
    s_nop 0
    buffer_load_dwordx4 v10, s[48:51], s61 offen offset:0 lds
    v_lshlrev_b32 v114, 16, v185
    v_and_b32 v115, 0xffff0000, v185
    v_lshlrev_b32 v116, 16, v186
    v_and_b32 v117, 0xffff0000, v186
    v_lshlrev_b32 v118, 16, v187
    v_and_b32 v119, 0xffff0000, v187
    v_lshlrev_b32 v120, 16, v188
    v_and_b32 v121, 0xffff0000, v188
    v_lshlrev_b32 v122, 16, v189
    v_and_b32 v123, 0xffff0000, v189
    v_lshlrev_b32 v124, 16, v190
    v_and_b32 v125, 0xffff0000, v190
    v_lshlrev_b32 v126, 16, v191
    v_and_b32 v127, 0xffff0000, v191
    s_waitcnt lgkmcnt(2)
    v_lshlrev_b32 v128, 16, v192
    buffer_load_dwordx4 v11, s[48:51], s61 offen offset:1024 lds
    v_and_b32 v129, 0xffff0000, v192
    v_lshlrev_b32 v130, 16, v193
    v_and_b32 v131, 0xffff0000, v193
    v_lshlrev_b32 v132, 16, v194
    v_and_b32 v133, 0xffff0000, v194
    v_lshlrev_b32 v134, 16, v195
    v_and_b32 v135, 0xffff0000, v195
    v_lshlrev_b32 v136, 16, v196
    v_and_b32 v137, 0xffff0000, v196
    v_lshlrev_b32 v138, 16, v197
    v_and_b32 v139, 0xffff0000, v197
    v_lshlrev_b32 v140, 16, v198
    v_and_b32 v141, 0xffff0000, v198
    v_lshlrev_b32 v142, 16, v199
    v_and_b32 v143, 0xffff0000, v199
    s_waitcnt lgkmcnt(0)
    buffer_load_dwordx4 v10, s[52:55], s61 offen offset:2048 lds
    v_lshlrev_b32 v144, 16, v200
    v_and_b32 v145, 0xffff0000, v200
    v_lshlrev_b32 v146, 16, v201
    v_and_b32 v147, 0xffff0000, v201
    v_lshlrev_b32 v148, 16, v202
    v_and_b32 v149, 0xffff0000, v202
    v_lshlrev_b32 v150, 16, v203
    v_and_b32 v151, 0xffff0000, v203
    v_lshlrev_b32 v152, 16, v204
    v_and_b32 v153, 0xffff0000, v204
    v_lshlrev_b32 v154, 16, v205
    v_and_b32 v155, 0xffff0000, v205
    v_lshlrev_b32 v156, 16, v206
    v_and_b32 v157, 0xffff0000, v206
    v_lshlrev_b32 v158, 16, v207
    v_and_b32 v159, 0xffff0000, v207
    buffer_load_dwordx4 v11, s[52:55], s61 offen offset:3072 lds
    v_add_u32 v72, 131072, v12
    v_add_u32 v73, 131072, v13
    v_add_u32 v74, 131072, v14
    v_add_u32 v75, 131072, v15
    v_add_u32 v78, 131072, v80
    v_add_u32 v68, 131072, v28
    v_add_u32 v69, 131072, v29
    s_waitcnt vmcnt(12)
    s_barrier
    ds_read_b128 a[0:3], v12 offset:0
    ds_read_b64_tr_b16 a[160:161], v28 offset:4096
    ds_read_b64_tr_b16 a[162:163], v28 offset:4608
    ds_read_b64_tr_b16 a[164:165], v29 offset:4096
    ds_read_b64_tr_b16 a[166:167], v29 offset:4608
    ds_read_b64_tr_b16 a[168:169], v28 offset:6144
    ds_read_b64_tr_b16 a[170:171], v28 offset:6656
    ds_read_b64_tr_b16 a[172:173], v29 offset:6144
    ds_read_b64_tr_b16 a[174:175], v29 offset:6656
    ds_read_b128 a[4:7], v13 offset:0
    ds_read_b64_tr_b16 a[176:177], v28 offset:12288
    ds_read_b64_tr_b16 a[178:179], v28 offset:12800
    ds_read_b64_tr_b16 a[180:181], v29 offset:12288
    ds_read_b64_tr_b16 a[182:183], v29 offset:12800
    ds_read_b64_tr_b16 a[184:185], v28 offset:14336
    ds_read_b64_tr_b16 a[186:187], v28 offset:14848
    ds_read_b64_tr_b16 a[188:189], v29 offset:14336
    ds_read_b64_tr_b16 a[190:191], v29 offset:14848
    ds_read_b32 v84, v80 offset:0
    s_waitcnt lgkmcnt(10)
    v_mfma_f32_32x32x16_bf16 v[96:111], a[160:163], a[0:3], v[96:111]
    ds_read_b128 a[8:11], v14 offset:0
    ds_read_b64_tr_b16 a[192:193], v28 offset:20480
    ds_read_b64_tr_b16 a[194:195], v28 offset:20992
    s_add_u32 m0, s43, 65536
    s_mul_i32 s61, s72, s63
    buffer_load_dwordx4 v4, s[44:47], s72 offen offset:0 lds
    v_mfma_f32_32x32x16_bf16 v[112:127], a[164:167], a[0:3], v[112:127]
    ds_read_b64_tr_b16 a[196:197], v29 offset:20480
    ds_read_b64_tr_b16 a[198:199], v29 offset:20992
    buffer_load_dwordx4 v5, s[44:47], s72 offen offset:1024 lds
    s_waitcnt lgkmcnt(5)
    v_lshlrev_b32 v90, 16, v84
    v_mfma_f32_32x32x16_bf16 v[128:143], a[168:171], a[0:3], v[128:143]
    ds_read_b64_tr_b16 a[200:201], v28 offset:22528
    ds_read_b64_tr_b16 a[202:203], v28 offset:23040
    buffer_load_dwordx4 v6, s[44:47], s72 offen offset:2048 lds
    v_lshlrev_b32 v91, 16, v52
    v_and_b32 v84, 0xffff0000, v84
    v_fmac_f32 v232, v231, v240
    v_mfma_f32_32x32x16_bf16 v[144:159], a[172:175], a[0:3], v[144:159]
    ds_read_b64_tr_b16 a[204:205], v29 offset:22528
    ds_read_b64_tr_b16 a[206:207], v29 offset:23040
    buffer_load_dwordx4 v7, s[44:47], s72 offen offset:3072 lds
    s_add_u32 m0, s43, 69632
    v_and_b32 v52, 0xffff0000, v52
    v_mul_f32 v90, v90, v91
    v_mfma_f32_32x32x16_bf16 v[96:111], a[176:179], a[4:7], v[96:111]
    ds_read_b128 a[12:15], v15 offset:0
    ds_read_b64_tr_b16 a[160:161], v28 offset:28672
    ds_read_b64_tr_b16 a[162:163], v28 offset:29184
    buffer_load_dwordx4 v10, s[48:51], s61 offen offset:0 lds
    v_mul_f32 v84, v84, v52
    v_cvt_pk_bf16_f32 v90, v90, v84
    v_mfma_f32_32x32x16_bf16 v[112:127], a[180:183], a[4:7], v[112:127]
    ds_read_b64_tr_b16 a[164:165], v29 offset:28672
    ds_read_b64_tr_b16 a[166:167], v29 offset:29184
    buffer_load_dwordx4 v11, s[48:51], s61 offen offset:1024 lds
    v_lshlrev_b32 v91, 16, v90
    v_and_b32 v90, 0xffff0000, v90
    v_mul_f32 v217, v216, v240
    v_mfma_f32_32x32x16_bf16 v[128:143], a[184:187], a[4:7], v[128:143]
    ds_read_b64_tr_b16 a[168:169], v28 offset:30720
    ds_read_b64_tr_b16 a[170:171], v28 offset:31232
    buffer_load_dwordx4 v10, s[52:55], s61 offen offset:2048 lds
    v_add_f32 v88, v88, v91
    v_add_f32 v88, v88, v90
    v_mul_f32 v233, v216, v241
    v_mfma_f32_32x32x16_bf16 v[144:159], a[188:191], a[4:7], v[144:159]
    ds_read_b64_tr_b16 a[172:173], v29 offset:30720
    ds_read_b64_tr_b16 a[174:175], v29 offset:31232
    buffer_load_dwordx4 v11, s[52:55], s61 offen offset:3072 lds
    s_add_u32 m0, s43, 98304
    s_mul_i32 s61, s73, s63
    s_waitcnt vmcnt(16)
    ds_read_b64_tr_b16 a[240:241], v66 offset:0
    ds_read_b64_tr_b16 a[242:243], v66 offset:512
    ds_read_b64_tr_b16 a[244:245], v66 offset:32
    ds_read_b64_tr_b16 a[246:247], v66 offset:544
    ds_read_b64_tr_b16 a[248:249], v66 offset:64
    ds_read_b64_tr_b16 a[250:251], v66 offset:576
    ds_read_b64_tr_b16 a[252:253], v66 offset:96
    ds_read_b64_tr_b16 a[254:255], v66 offset:608
    s_waitcnt vmcnt(8)
    s_barrier
    s_waitcnt lgkmcnt(15)
    v_mfma_f32_32x32x16_bf16 v[96:111], a[192:195], a[8:11], v[96:111]
    ds_read_b32 v86, v80 offset:32768
    ds_read_b128 a[16:19], v12 offset:32768
    ds_read_b64_tr_b16 a[176:177], v28 offset:36864
    buffer_load_dwordx4 v4, s[44:47], s73 offen offset:0 lds
    v_fma_f32 v217, -v232, v241, v217
    v_mfma_f32_32x32x16_bf16 v[112:127], a[196:199], a[8:11], v[112:127]
    ds_read_b64_tr_b16 a[178:179], v28 offset:37376
    ds_read_b64_tr_b16 a[180:181], v29 offset:36864
    ds_read_b64_tr_b16 a[182:183], v29 offset:37376
    buffer_load_dwordx4 v5, s[44:47], s73 offen offset:1024 lds
    v_fmac_f32 v233, v232, v240
    v_mfma_f32_32x32x16_bf16 v[128:143], a[200:203], a[8:11], v[128:143]
    ds_read_b64_tr_b16 a[184:185], v28 offset:38912
    ds_read_b64_tr_b16 a[186:187], v28 offset:39424
    buffer_load_dwordx4 v6, s[44:47], s73 offen offset:2048 lds
    v_mul_f32 v218, v217, v240
    v_mfma_f32_32x32x16_bf16 v[144:159], a[204:207], a[8:11], v[144:159]
    ds_read_b64_tr_b16 a[188:189], v29 offset:38912
    ds_read_b64_tr_b16 a[190:191], v29 offset:39424
    buffer_load_dwordx4 v7, s[44:47], s73 offen offset:3072 lds
    s_add_u32 m0, s43, 102400
    v_mul_f32 v234, v217, v241
    s_waitcnt lgkmcnt(15)
    v_mfma_f32_32x32x16_bf16 v[96:111], a[160:163], a[12:15], v[96:111]
    ds_read_b128 a[20:23], v13 offset:32768
    ds_read_b64_tr_b16 a[192:193], v28 offset:45056
    ds_read_b64_tr_b16 a[194:195], v28 offset:45568
    buffer_load_dwordx4 v10, s[48:51], s61 offen offset:0 lds
    v_fma_f32 v218, -v233, v241, v218
    v_mfma_f32_32x32x16_bf16 v[112:127], a[164:167], a[12:15], v[112:127]
    ds_read_b64_tr_b16 a[196:197], v29 offset:45056
    ds_read_b64_tr_b16 a[198:199], v29 offset:45568
    buffer_load_dwordx4 v11, s[48:51], s61 offen offset:1024 lds
    s_waitcnt lgkmcnt(14)
    v_lshlrev_b32 v90, 16, v86
    v_fmac_f32 v234, v233, v240
    v_mfma_f32_32x32x16_bf16 v[128:143], a[168:171], a[12:15], v[128:143]
    ds_read_b64_tr_b16 a[200:201], v28 offset:47104
    ds_read_b64_tr_b16 a[202:203], v28 offset:47616
    buffer_load_dwordx4 v10, s[52:55], s61 offen offset:2048 lds
    buffer_store_dwordx4 a[240:243], v67, s[56:59], s96 offen sc1
    buffer_store_dwordx4 a[244:247], v67, s[56:59], s97 offen sc1
    buffer_store_dwordx4 a[248:251], v67, s[56:59], s98 offen sc1
    buffer_store_dwordx4 a[252:255], v67, s[56:59], s99 offen sc1
    v_lshlrev_b32 v91, 16, v53
    v_and_b32 v86, 0xffff0000, v86
    v_mfma_f32_32x32x16_bf16 v[144:159], a[172:175], a[12:15], v[144:159]
    ds_read_b64_tr_b16 a[204:205], v29 offset:47104
    ds_read_b64_tr_b16 a[206:207], v29 offset:47616
    buffer_load_dwordx4 v11, s[52:55], s61 offen offset:3072 lds
    v_and_b32 v53, 0xffff0000, v53
    v_mul_f32 v90, v90, v91
    v_mul_f32 v219, v218, v240
    s_waitcnt lgkmcnt(9)
    v_mfma_f32_32x32x16_bf16 v[96:111], a[176:179], a[16:19], v[96:111]
    ds_read_b128 a[24:27], v14 offset:32768
    ds_read_b64_tr_b16 a[160:161], v28 offset:53248
    ds_read_b64_tr_b16 a[162:163], v28 offset:53760
    s_add_u32 m0, s43, 131072
    s_mul_i32 s61, s74, s63
    v_mfma_f32_32x32x16_bf16 v[112:127], a[180:183], a[16:19], v[112:127]
    ds_read_b64_tr_b16 a[164:165], v29 offset:53248
    ds_read_b64_tr_b16 a[166:167], v29 offset:53760
    buffer_load_dwordx4 v4, s[44:47], s74 offen offset:0 lds
    v_mul_f32 v86, v86, v53
    v_cvt_pk_bf16_f32 v90, v90, v86
    v_mul_f32 v235, v218, v241
    v_mfma_f32_32x32x16_bf16 v[128:143], a[184:187], a[16:19], v[128:143]
    ds_read_b64_tr_b16 a[168:169], v28 offset:55296
    ds_read_b64_tr_b16 a[170:171], v28 offset:55808
    buffer_load_dwordx4 v5, s[44:47], s74 offen offset:1024 lds
    v_lshlrev_b32 v91, 16, v90
    v_and_b32 v90, 0xffff0000, v90
    v_fma_f32 v219, -v234, v241, v219
    v_mfma_f32_32x32x16_bf16 v[144:159], a[188:191], a[16:19], v[144:159]
    ds_read_b64_tr_b16 a[172:173], v29 offset:55296
    ds_read_b64_tr_b16 a[174:175], v29 offset:55808
    buffer_load_dwordx4 v6, s[44:47], s74 offen offset:2048 lds
    v_add_f32 v88, v88, v91
    v_add_f32 v88, v88, v90
    v_fmac_f32 v235, v234, v240
    s_waitcnt lgkmcnt(9)
    v_mfma_f32_32x32x16_bf16 v[96:111], a[192:195], a[20:23], v[96:111]
    ds_read_b128 a[28:31], v15 offset:32768
    ds_read_b64_tr_b16 a[176:177], v28 offset:61440
    ds_read_b64_tr_b16 a[178:179], v28 offset:61952
    buffer_load_dwordx4 v7, s[44:47], s74 offen offset:3072 lds
    s_add_u32 m0, s43, 135168
    v_mul_f32 v220, v219, v240
    v_mfma_f32_32x32x16_bf16 v[112:127], a[196:199], a[20:23], v[112:127]
    ds_read_b64_tr_b16 a[180:181], v29 offset:61440
    ds_read_b64_tr_b16 a[182:183], v29 offset:61952
    buffer_load_dwordx4 v10, s[48:51], s61 offen offset:0 lds
    v_mul_f32 v236, v219, v241
    v_mfma_f32_32x32x16_bf16 v[128:143], a[200:203], a[20:23], v[128:143]
    ds_read_b64_tr_b16 a[184:185], v28 offset:63488
    ds_read_b64_tr_b16 a[186:187], v28 offset:64000
    buffer_load_dwordx4 v11, s[48:51], s61 offen offset:1024 lds
    v_fma_f32 v220, -v235, v241, v220
    v_mfma_f32_32x32x16_bf16 v[144:159], a[204:207], a[20:23], v[144:159]
    ds_read_b64_tr_b16 a[188:189], v29 offset:63488
    ds_read_b64_tr_b16 a[190:191], v29 offset:64000
    buffer_load_dwordx4 v10, s[52:55], s61 offen offset:2048 lds
    v_fmac_f32 v236, v235, v240
    s_waitcnt vmcnt(19)
    s_barrier
    s_waitcnt lgkmcnt(9)
    v_mfma_f32_32x32x16_bf16 v[96:111], a[160:163], a[24:27], v[96:111]
    ds_read_b32 v84, v81 offset:0
    ds_read_b128 a[32:35], v16 offset:0
    ds_read_b64_tr_b16 a[192:193], v30 offset:4096
    buffer_load_dwordx4 v11, s[52:55], s61 offen offset:3072 lds
    s_add_u32 m0, s43, 0
    s_mul_i32 s61, s75, s63
    v_mfma_f32_32x32x16_bf16 v[112:127], a[164:167], a[24:27], v[112:127]
    ds_read_b64_tr_b16 a[194:195], v30 offset:4608
    ds_read_b64_tr_b16 a[196:197], v31 offset:4096
    ds_read_b64_tr_b16 a[198:199], v31 offset:4608
    buffer_load_dwordx4 v4, s[44:47], s75 offen offset:0 lds
    v_mul_f32 v221, v220, v240
    v_mfma_f32_32x32x16_bf16 v[128:143], a[168:171], a[24:27], v[128:143]
    ds_read_b64_tr_b16 a[200:201], v30 offset:6144
    ds_read_b64_tr_b16 a[202:203], v30 offset:6656
    v_mul_f32 v237, v220, v241
    v_mfma_f32_32x32x16_bf16 v[144:159], a[172:175], a[24:27], v[144:159]
    ds_read_b64_tr_b16 a[204:205], v31 offset:6144
    ds_read_b64_tr_b16 a[206:207], v31 offset:6656
    buffer_load_dwordx4 v5, s[44:47], s75 offen offset:1024 lds
    v_fma_f32 v221, -v236, v241, v221
    s_waitcnt lgkmcnt(10)
    v_mfma_f32_32x32x16_bf16 v[96:111], a[176:179], a[28:31], v[96:111]
    ds_read_b128 a[36:39], v17 offset:0
    ds_read_b64_tr_b16 a[160:161], v30 offset:12288
    ds_read_b64_tr_b16 a[162:163], v30 offset:12800
    global_load_dword v46, v45, s[36:37] sc1
    v_fmac_f32 v237, v236, v240
    v_mfma_f32_32x32x16_bf16 v[112:127], a[180:183], a[28:31], v[112:127]
    ds_read_b64_tr_b16 a[164:165], v31 offset:12288
    ds_read_b64_tr_b16 a[166:167], v31 offset:12800
    buffer_load_dwordx4 v6, s[44:47], s75 offen offset:2048 lds
    s_waitcnt lgkmcnt(14)
    v_lshlrev_b32 v90, 16, v84
    v_mul_f32 v222, v221, v240
    v_mfma_f32_32x32x16_bf16 v[128:143], a[184:187], a[28:31], v[128:143]
    ds_read_b64_tr_b16 a[168:169], v30 offset:14336
    ds_read_b64_tr_b16 a[170:171], v30 offset:14848
    v_lshlrev_b32 v91, 16, v54
    v_and_b32 v84, 0xffff0000, v84
    v_mul_f32 v238, v221, v241
    v_mfma_f32_32x32x16_bf16 v[144:159], a[188:191], a[28:31], v[144:159]
    ds_read_b64_tr_b16 a[172:173], v31 offset:14336
    ds_read_b64_tr_b16 a[174:175], v31 offset:14848
    buffer_load_dwordx4 v7, s[44:47], s75 offen offset:3072 lds
    s_add_u32 m0, s43, 4096
    v_and_b32 v54, 0xffff0000, v54
    v_mul_f32 v90, v90, v91
    s_waitcnt lgkmcnt(9)
    v_mfma_f32_32x32x16_bf16 v[96:111], a[192:195], a[32:35], v[96:111]
    ds_read_b128 a[40:43], v18 offset:0
    ds_read_b64_tr_b16 a[176:177], v30 offset:20480
    ds_read_b64_tr_b16 a[178:179], v30 offset:20992
    v_mul_f32 v84, v84, v54
    v_cvt_pk_bf16_f32 v90, v90, v84
    v_fma_f32 v222, -v237, v241, v222
    v_mfma_f32_32x32x16_bf16 v[112:127], a[196:199], a[32:35], v[112:127]
    ds_read_b64_tr_b16 a[180:181], v31 offset:20480
    ds_read_b64_tr_b16 a[182:183], v31 offset:20992
    buffer_load_dwordx4 v10, s[48:51], s61 offen offset:0 lds
    v_lshlrev_b32 v91, 16, v90
    v_and_b32 v90, 0xffff0000, v90
    v_fmac_f32 v238, v237, v240
    v_mfma_f32_32x32x16_bf16 v[128:143], a[200:203], a[32:35], v[128:143]
    ds_read_b64_tr_b16 a[184:185], v30 offset:22528
    ds_read_b64_tr_b16 a[186:187], v30 offset:23040
    v_add_f32 v88, v88, v91
    v_add_f32 v88, v88, v90
    v_mul_f32 v223, v222, v240
    v_mfma_f32_32x32x16_bf16 v[144:159], a[204:207], a[32:35], v[144:159]
    ds_read_b64_tr_b16 a[188:189], v31 offset:22528
    ds_read_b64_tr_b16 a[190:191], v31 offset:23040
    buffer_load_dwordx4 v11, s[48:51], s61 offen offset:1024 lds
    v_mul_f32 v239, v222, v241
    s_waitcnt lgkmcnt(9)
    v_mfma_f32_32x32x16_bf16 v[96:111], a[160:163], a[36:39], v[96:111]
    ds_read_b128 a[44:47], v19 offset:0
    ds_read_b64_tr_b16 a[192:193], v30 offset:28672
    ds_read_b64_tr_b16 a[194:195], v30 offset:29184
    v_fma_f32 v223, -v238, v241, v223
    v_mfma_f32_32x32x16_bf16 v[112:127], a[164:167], a[36:39], v[112:127]
    ds_read_b64_tr_b16 a[196:197], v31 offset:28672
    ds_read_b64_tr_b16 a[198:199], v31 offset:29184
    buffer_load_dwordx4 v10, s[52:55], s61 offen offset:2048 lds
    v_fmac_f32 v239, v238, v240
    v_mfma_f32_32x32x16_bf16 v[128:143], a[168:171], a[36:39], v[128:143]
    ds_read_b64_tr_b16 a[200:201], v30 offset:30720
    ds_read_b64_tr_b16 a[202:203], v30 offset:31232
    v_cmp_eq_u32 s[12:13], 1, v3
    v_mfma_f32_32x32x16_bf16 v[144:159], a[172:175], a[36:39], v[144:159]
    ds_read_b64_tr_b16 a[204:205], v31 offset:30720
    ds_read_b64_tr_b16 a[206:207], v31 offset:31232
    buffer_load_dwordx4 v11, s[52:55], s61 offen offset:3072 lds
    v_mov_b32 v244, v223
    s_waitcnt vmcnt(17)
    s_barrier
    s_waitcnt lgkmcnt(9)
    v_mfma_f32_32x32x16_bf16 v[96:111], a[176:179], a[40:43], v[96:111]
    ds_read_b32 v86, v81 offset:32768
    ds_read_b128 a[48:51], v16 offset:32768
    ds_read_b64_tr_b16 a[160:161], v30 offset:36864
    v_mov_b32 v245, v239
    v_mfma_f32_32x32x16_bf16 v[112:127], a[180:183], a[40:43], v[112:127]
    ds_read_b64_tr_b16 a[162:163], v30 offset:37376
    ds_read_b64_tr_b16 a[164:165], v31 offset:36864
    ds_read_b64_tr_b16 a[166:167], v31 offset:37376
    s_add_u32 m0, s43, 32768
    s_mul_i32 s61, s76, s63
    buffer_load_dwordx4 v4, s[44:47], s76 offen offset:0 lds
    v_mfma_f32_32x32x16_bf16 v[128:143], a[184:187], a[40:43], v[128:143]
    ds_read_b64_tr_b16 a[168:169], v30 offset:38912
    ds_read_b64_tr_b16 a[170:171], v30 offset:39424
    v_cndmask_b32 v50, 1.0, v244, s[12:13]
    v_mfma_f32_32x32x16_bf16 v[144:159], a[188:191], a[40:43], v[144:159]
    ds_read_b64_tr_b16 a[172:173], v31 offset:38912
    ds_read_b64_tr_b16 a[174:175], v31 offset:39424
    buffer_load_dwordx4 v5, s[44:47], s76 offen offset:1024 lds
    v_cndmask_b32 v51, 0, v245, s[12:13]
    s_waitcnt lgkmcnt(10)
    v_mfma_f32_32x32x16_bf16 v[96:111], a[192:195], a[44:47], v[96:111]
    ds_read_b128 a[52:55], v17 offset:32768
    ds_read_b64_tr_b16 a[176:177], v30 offset:45056
    ds_read_b64_tr_b16 a[178:179], v30 offset:45568
    v_mul_f32 v246, v242, v50
    v_mfma_f32_32x32x16_bf16 v[112:127], a[196:199], a[44:47], v[112:127]
    ds_read_b64_tr_b16 a[180:181], v31 offset:45056
    ds_read_b64_tr_b16 a[182:183], v31 offset:45568
    buffer_load_dwordx4 v6, s[44:47], s76 offen offset:2048 lds
    s_waitcnt lgkmcnt(14)
    v_lshlrev_b32 v90, 16, v86
    v_mul_f32 v247, v242, v51
    v_mfma_f32_32x32x16_bf16 v[128:143], a[200:203], a[44:47], v[128:143]
    ds_read_b64_tr_b16 a[184:185], v30 offset:47104
    ds_read_b64_tr_b16 a[186:187], v30 offset:47616
    v_lshlrev_b32 v91, 16, v55
    v_and_b32 v86, 0xffff0000, v86
    v_fma_f32 v246, -v243, v51, v246
    v_mfma_f32_32x32x16_bf16 v[144:159], a[204:207], a[44:47], v[144:159]
    ds_read_b64_tr_b16 a[188:189], v31 offset:47104
    ds_read_b64_tr_b16 a[190:191], v31 offset:47616
    buffer_load_dwordx4 v7, s[44:47], s76 offen offset:3072 lds
    s_add_u32 m0, s43, 36864
    v_and_b32 v55, 0xffff0000, v55
    v_mul_f32 v90, v90, v91
    s_waitcnt lgkmcnt(9)
    v_mfma_f32_32x32x16_bf16 v[96:111], a[160:163], a[48:51], v[96:111]
    ds_read_b128 a[56:59], v18 offset:32768
    ds_read_b64_tr_b16 a[192:193], v30 offset:53248
    ds_read_b64_tr_b16 a[194:195], v30 offset:53760
    v_mul_f32 v86, v86, v55
    v_cvt_pk_bf16_f32 v90, v90, v86
    v_fmac_f32 v247, v243, v50
    v_mfma_f32_32x32x16_bf16 v[112:127], a[164:167], a[48:51], v[112:127]
    ds_read_b64_tr_b16 a[196:197], v31 offset:53248
    ds_read_b64_tr_b16 a[198:199], v31 offset:53760
    buffer_load_dwordx4 v10, s[48:51], s61 offen offset:0 lds
    v_lshlrev_b32 v91, 16, v90
    v_and_b32 v90, 0xffff0000, v90
    v_mul_f32 v48, v244, v244
    v_mfma_f32_32x32x16_bf16 v[128:143], a[168:171], a[48:51], v[128:143]
    ds_read_b64_tr_b16 a[200:201], v30 offset:55296
    ds_read_b64_tr_b16 a[202:203], v30 offset:55808
    v_add_f32 v88, v88, v91
    v_add_f32 v88, v88, v90
    v_add_f32 v49, v244, v244
    v_mfma_f32_32x32x16_bf16 v[144:159], a[172:175], a[48:51], v[144:159]
    ds_read_b64_tr_b16 a[204:205], v31 offset:55296
    ds_read_b64_tr_b16 a[206:207], v31 offset:55808
    buffer_load_dwordx4 v11, s[48:51], s61 offen offset:1024 lds
    v_fma_f32 v48, -v245, v245, v48
    s_waitcnt lgkmcnt(9)
    v_mfma_f32_32x32x16_bf16 v[96:111], a[176:179], a[52:55], v[96:111]
    ds_read_b128 a[60:63], v19 offset:32768
    ds_read_b64_tr_b16 a[160:161], v30 offset:61440
    ds_read_b64_tr_b16 a[162:163], v30 offset:61952
    v_mul_f32 v49, v49, v245
    v_mfma_f32_32x32x16_bf16 v[112:127], a[180:183], a[52:55], v[112:127]
    ds_read_b64_tr_b16 a[164:165], v31 offset:61440
    ds_read_b64_tr_b16 a[166:167], v31 offset:61952
    buffer_load_dwordx4 v10, s[52:55], s61 offen offset:2048 lds
    v_cndmask_b32 v50, 1.0, v48, s[66:67]
    v_mfma_f32_32x32x16_bf16 v[128:143], a[184:187], a[52:55], v[128:143]
    ds_read_b64_tr_b16 a[168:169], v30 offset:63488
    ds_read_b64_tr_b16 a[170:171], v30 offset:64000
    v_cndmask_b32 v51, 0, v49, s[66:67]
    v_mfma_f32_32x32x16_bf16 v[144:159], a[188:191], a[52:55], v[144:159]
    ds_read_b64_tr_b16 a[172:173], v31 offset:63488
    ds_read_b64_tr_b16 a[174:175], v31 offset:64000
    buffer_load_dwordx4 v11, s[52:55], s61 offen offset:3072 lds
    v_mul_f32 v252, v246, v50
    s_waitcnt vmcnt(17)
    s_barrier
    s_waitcnt lgkmcnt(9)
    v_mfma_f32_32x32x16_bf16 v[96:111], a[192:195], a[56:59], v[96:111]
    ds_read_b32 v84, v78 offset:0
    ds_read_b128 a[64:67], v72 offset:0
    ds_read_b64_tr_b16 a[176:177], v68 offset:4096
    v_mul_f32 v253, v246, v51
    v_mfma_f32_32x32x16_bf16 v[112:127], a[196:199], a[56:59], v[112:127]
    ds_read_b64_tr_b16 a[178:179], v68 offset:4608
    ds_read_b64_tr_b16 a[180:181], v69 offset:4096
    ds_read_b64_tr_b16 a[182:183], v69 offset:4608
    s_add_u32 m0, s43, 65536
    s_mul_i32 s61, s77, s63
    buffer_load_dwordx4 v4, s[44:47], s77 offen offset:0 lds
    v_mfma_f32_32x32x16_bf16 v[128:143], a[200:203], a[56:59], v[128:143]
    ds_read_b64_tr_b16 a[184:185], v68 offset:6144
    ds_read_b64_tr_b16 a[186:187], v68 offset:6656
    v_fma_f32 v252, -v247, v51, v252
    v_mfma_f32_32x32x16_bf16 v[144:159], a[204:207], a[56:59], v[144:159]
    ds_read_b64_tr_b16 a[188:189], v69 offset:6144
    ds_read_b64_tr_b16 a[190:191], v69 offset:6656
    buffer_load_dwordx4 v5, s[44:47], s77 offen offset:1024 lds
    v_fmac_f32 v253, v247, v50
    s_waitcnt lgkmcnt(10)
    v_mfma_f32_32x32x16_bf16 v[96:111], a[160:163], a[60:63], v[96:111]
    ds_read_b128 a[68:71], v73 offset:0
    ds_read_b64_tr_b16 a[192:193], v68 offset:12288
    ds_read_b64_tr_b16 a[194:195], v68 offset:12800
    v_mul_f32 v248, v48, v48
    v_mfma_f32_32x32x16_bf16 v[112:127], a[164:167], a[60:63], v[112:127]
    ds_read_b64_tr_b16 a[196:197], v69 offset:12288
    ds_read_b64_tr_b16 a[198:199], v69 offset:12800
    buffer_load_dwordx4 v6, s[44:47], s77 offen offset:2048 lds
    s_waitcnt lgkmcnt(14)
    v_lshlrev_b32 v90, 16, v84
    v_add_f32 v249, v48, v48
    v_mfma_f32_32x32x16_bf16 v[128:143], a[168:171], a[60:63], v[128:143]
    ds_read_b64_tr_b16 a[200:201], v68 offset:14336
    ds_read_b64_tr_b16 a[202:203], v68 offset:14848
    v_lshlrev_b32 v91, 16, v56
    v_and_b32 v84, 0xffff0000, v84
    v_fma_f32 v248, -v49, v49, v248
    v_mfma_f32_32x32x16_bf16 v[144:159], a[172:175], a[60:63], v[144:159]
    ds_read_b64_tr_b16 a[204:205], v69 offset:14336
    ds_read_b64_tr_b16 a[206:207], v69 offset:14848
    buffer_load_dwordx4 v7, s[44:47], s77 offen offset:3072 lds
    s_add_u32 m0, s43, 69632
    v_and_b32 v56, 0xffff0000, v56
    v_mul_f32 v90, v90, v91
    s_waitcnt lgkmcnt(9)
    v_mfma_f32_32x32x16_bf16 v[96:111], a[176:179], a[64:67], v[96:111]
    ds_read_b128 a[72:75], v74 offset:0
    ds_read_b64_tr_b16 a[160:161], v68 offset:20480
    ds_read_b64_tr_b16 a[162:163], v68 offset:20992
    v_mul_f32 v84, v84, v56
    v_cvt_pk_bf16_f32 v90, v90, v84
    v_mul_f32 v249, v249, v49
    v_mfma_f32_32x32x16_bf16 v[112:127], a[180:183], a[64:67], v[112:127]
    ds_read_b64_tr_b16 a[164:165], v69 offset:20480
    ds_read_b64_tr_b16 a[166:167], v69 offset:20992
    buffer_load_dwordx4 v10, s[48:51], s61 offen offset:0 lds
    v_lshlrev_b32 v91, 16, v90
    v_and_b32 v90, 0xffff0000, v90
    v_cndmask_b32 v50, 1.0, v248, s[68:69]
    v_mfma_f32_32x32x16_bf16 v[128:143], a[184:187], a[64:67], v[128:143]
    ds_read_b64_tr_b16 a[168:169], v68 offset:22528
    ds_read_b64_tr_b16 a[170:171], v68 offset:23040
    v_add_f32 v88, v88, v91
    v_add_f32 v88, v88, v90
    v_cndmask_b32 v51, 0, v249, s[68:69]
    v_mfma_f32_32x32x16_bf16 v[144:159], a[188:191], a[64:67], v[144:159]
    ds_read_b64_tr_b16 a[172:173], v69 offset:22528
    ds_read_b64_tr_b16 a[174:175], v69 offset:23040
    buffer_load_dwordx4 v11, s[48:51], s61 offen offset:1024 lds
    v_mul_f32 v246, v252, v50
    s_waitcnt lgkmcnt(9)
    v_mfma_f32_32x32x16_bf16 v[96:111], a[192:195], a[68:71], v[96:111]
    ds_read_b128 a[76:79], v75 offset:0
    ds_read_b64_tr_b16 a[176:177], v68 offset:28672
    ds_read_b64_tr_b16 a[178:179], v68 offset:29184
    v_mul_f32 v247, v252, v51
    v_mfma_f32_32x32x16_bf16 v[112:127], a[196:199], a[68:71], v[112:127]
    ds_read_b64_tr_b16 a[180:181], v69 offset:28672
    ds_read_b64_tr_b16 a[182:183], v69 offset:29184
    buffer_load_dwordx4 v10, s[52:55], s61 offen offset:2048 lds
    v_fma_f32 v246, -v253, v51, v246
    v_mfma_f32_32x32x16_bf16 v[128:143], a[200:203], a[68:71], v[128:143]
    ds_read_b64_tr_b16 a[184:185], v68 offset:30720
    ds_read_b64_tr_b16 a[186:187], v68 offset:31232
    v_fmac_f32 v247, v253, v50
    v_mfma_f32_32x32x16_bf16 v[144:159], a[204:207], a[68:71], v[144:159]
    ds_read_b64_tr_b16 a[188:189], v69 offset:30720
    ds_read_b64_tr_b16 a[190:191], v69 offset:31232
    buffer_load_dwordx4 v11, s[52:55], s61 offen offset:3072 lds
    v_mul_f32 v48, v248, v248
    s_waitcnt vmcnt(16)
    s_barrier
    s_waitcnt lgkmcnt(9)
    v_mfma_f32_32x32x16_bf16 v[96:111], a[160:163], a[72:75], v[96:111]
    ds_read_b32 v86, v80 offset:0
    ds_read_b128 a[80:83], v12 offset:0
    ds_read_b64_tr_b16 a[192:193], v28 offset:4096
    v_add_f32 v49, v248, v248
    v_mfma_f32_32x32x16_bf16 v[112:127], a[164:167], a[72:75], v[112:127]
    ds_read_b64_tr_b16 a[194:195], v28 offset:4608
    ds_read_b64_tr_b16 a[196:197], v29 offset:4096
    ds_read_b64_tr_b16 a[198:199], v29 offset:4608
    s_add_u32 m0, s43, 98304
    s_mul_i32 s61, s78, s63
    buffer_load_dwordx4 v4, s[44:47], s78 offen offset:0 lds
    v_mfma_f32_32x32x16_bf16 v[128:143], a[168:171], a[72:75], v[128:143]
    ds_read_b64_tr_b16 a[200:201], v28 offset:6144
    ds_read_b64_tr_b16 a[202:203], v28 offset:6656
    v_fma_f32 v48, -v249, v249, v48
    v_mfma_f32_32x32x16_bf16 v[144:159], a[172:175], a[72:75], v[144:159]
    ds_read_b64_tr_b16 a[204:205], v29 offset:6144
    ds_read_b64_tr_b16 a[206:207], v29 offset:6656
    buffer_load_dwordx4 v5, s[44:47], s78 offen offset:1024 lds
    v_mul_f32 v49, v49, v249
    s_waitcnt lgkmcnt(10)
    v_mfma_f32_32x32x16_bf16 v[96:111], a[176:179], a[76:79], v[96:111]
    ds_read_b128 a[84:87], v13 offset:0
    ds_read_b64_tr_b16 a[160:161], v28 offset:12288
    ds_read_b64_tr_b16 a[162:163], v28 offset:12800
    v_cndmask_b32 v250, 1.0, v48, s[12:13]
    v_mfma_f32_32x32x16_bf16 v[112:127], a[180:183], a[76:79], v[112:127]
    ds_read_b64_tr_b16 a[164:165], v29 offset:12288
    ds_read_b64_tr_b16 a[166:167], v29 offset:12800
    buffer_load_dwordx4 v6, s[44:47], s78 offen offset:2048 lds
    s_waitcnt lgkmcnt(14)
    v_lshlrev_b32 v90, 16, v86
    v_cndmask_b32 v251, 0, v49, s[12:13]
    v_mfma_f32_32x32x16_bf16 v[128:143], a[184:187], a[76:79], v[128:143]
    ds_read_b64_tr_b16 a[168:169], v28 offset:14336
    ds_read_b64_tr_b16 a[170:171], v28 offset:14848
    v_lshlrev_b32 v91, 16, v57
    v_and_b32 v86, 0xffff0000, v86
    v_mul_f32 v248, v48, v48
    v_mfma_f32_32x32x16_bf16 v[144:159], a[188:191], a[76:79], v[144:159]
    ds_read_b64_tr_b16 a[172:173], v29 offset:14336
    ds_read_b64_tr_b16 a[174:175], v29 offset:14848
    buffer_load_dwordx4 v7, s[44:47], s78 offen offset:3072 lds
    s_add_u32 m0, s43, 102400
    v_and_b32 v57, 0xffff0000, v57
    v_mul_f32 v90, v90, v91
    s_waitcnt lgkmcnt(9)
    v_mfma_f32_32x32x16_bf16 v[96:111], a[192:195], a[80:83], v[96:111]
    ds_read_b128 a[88:91], v14 offset:0
    ds_read_b64_tr_b16 a[176:177], v28 offset:20480
    ds_read_b64_tr_b16 a[178:179], v28 offset:20992
    v_mul_f32 v86, v86, v57
    v_cvt_pk_bf16_f32 v90, v90, v86
    v_add_f32 v249, v48, v48
    v_mfma_f32_32x32x16_bf16 v[112:127], a[196:199], a[80:83], v[112:127]
    ds_read_b64_tr_b16 a[180:181], v29 offset:20480
    ds_read_b64_tr_b16 a[182:183], v29 offset:20992
    buffer_load_dwordx4 v10, s[48:51], s61 offen offset:0 lds
    v_lshlrev_b32 v91, 16, v90
    v_and_b32 v90, 0xffff0000, v90
    v_fma_f32 v248, -v49, v49, v248
    v_mfma_f32_32x32x16_bf16 v[128:143], a[200:203], a[80:83], v[128:143]
    ds_read_b64_tr_b16 a[184:185], v28 offset:22528
    ds_read_b64_tr_b16 a[186:187], v28 offset:23040
    v_add_f32 v88, v88, v91
    v_add_f32 v88, v88, v90
    v_mul_f32 v249, v249, v49
    v_mfma_f32_32x32x16_bf16 v[144:159], a[204:207], a[80:83], v[144:159]
    ds_read_b64_tr_b16 a[188:189], v29 offset:22528
    ds_read_b64_tr_b16 a[190:191], v29 offset:23040
    buffer_load_dwordx4 v11, s[48:51], s61 offen offset:1024 lds
    v_mul_f32 v48, v248, v248
    s_waitcnt lgkmcnt(9)
    v_mfma_f32_32x32x16_bf16 v[96:111], a[160:163], a[84:87], v[96:111]
    ds_read_b128 a[92:95], v15 offset:0
    ds_read_b64_tr_b16 a[192:193], v28 offset:28672
    ds_read_b64_tr_b16 a[194:195], v28 offset:29184
    v_add_f32 v49, v248, v248
    v_mfma_f32_32x32x16_bf16 v[112:127], a[164:167], a[84:87], v[112:127]
    ds_read_b64_tr_b16 a[196:197], v29 offset:28672
    ds_read_b64_tr_b16 a[198:199], v29 offset:29184
    buffer_load_dwordx4 v10, s[52:55], s61 offen offset:2048 lds
    v_fma_f32 v48, -v249, v249, v48
    v_mfma_f32_32x32x16_bf16 v[128:143], a[168:171], a[84:87], v[128:143]
    ds_read_b64_tr_b16 a[200:201], v28 offset:30720
    ds_read_b64_tr_b16 a[202:203], v28 offset:31232
    v_mul_f32 v49, v49, v249
    v_mfma_f32_32x32x16_bf16 v[144:159], a[172:175], a[84:87], v[144:159]
    ds_read_b64_tr_b16 a[204:205], v29 offset:30720
    ds_read_b64_tr_b16 a[206:207], v29 offset:31232
    buffer_load_dwordx4 v11, s[52:55], s61 offen offset:3072 lds
    v_cndmask_b32 v50, 1.0, v48, s[66:67]
    s_waitcnt vmcnt(16)
    s_barrier
    s_waitcnt lgkmcnt(9)
    v_mfma_f32_32x32x16_bf16 v[96:111], a[176:179], a[88:91], v[96:111]
    ds_read_b32 v84, v80 offset:32768
    ds_read_b128 a[96:99], v12 offset:32768
    ds_read_b64_tr_b16 a[160:161], v28 offset:36864
    v_cndmask_b32 v51, 0, v49, s[66:67]
    v_mfma_f32_32x32x16_bf16 v[112:127], a[180:183], a[88:91], v[112:127]
    ds_read_b64_tr_b16 a[162:163], v28 offset:37376
    ds_read_b64_tr_b16 a[164:165], v29 offset:36864
    ds_read_b64_tr_b16 a[166:167], v29 offset:37376
    s_add_u32 m0, s43, 131072
    s_mul_i32 s61, s79, s63
    buffer_load_dwordx4 v4, s[44:47], s79 offen offset:0 lds
    v_mfma_f32_32x32x16_bf16 v[128:143], a[184:187], a[88:91], v[128:143]
    ds_read_b64_tr_b16 a[168:169], v28 offset:38912
    ds_read_b64_tr_b16 a[170:171], v28 offset:39424
    v_mul_f32 v252, v250, v50
    v_mfma_f32_32x32x16_bf16 v[144:159], a[188:191], a[88:91], v[144:159]
    ds_read_b64_tr_b16 a[172:173], v29 offset:38912
    ds_read_b64_tr_b16 a[174:175], v29 offset:39424
    buffer_load_dwordx4 v5, s[44:47], s79 offen offset:1024 lds
    v_mul_f32 v253, v250, v51
    s_waitcnt lgkmcnt(10)
    v_mfma_f32_32x32x16_bf16 v[96:111], a[192:195], a[92:95], v[96:111]
    ds_read_b128 a[100:103], v13 offset:32768
    ds_read_b64_tr_b16 a[176:177], v28 offset:45056
    ds_read_b64_tr_b16 a[178:179], v28 offset:45568
    v_fma_f32 v252, -v251, v51, v252
    v_mfma_f32_32x32x16_bf16 v[112:127], a[196:199], a[92:95], v[112:127]
    ds_read_b64_tr_b16 a[180:181], v29 offset:45056
    ds_read_b64_tr_b16 a[182:183], v29 offset:45568
    buffer_load_dwordx4 v6, s[44:47], s79 offen offset:2048 lds
    s_waitcnt lgkmcnt(14)
    v_lshlrev_b32 v90, 16, v84
    v_fmac_f32 v253, v251, v50
    v_mfma_f32_32x32x16_bf16 v[128:143], a[200:203], a[92:95], v[128:143]
    ds_read_b64_tr_b16 a[184:185], v28 offset:47104
    ds_read_b64_tr_b16 a[186:187], v28 offset:47616
    v_lshlrev_b32 v91, 16, v58
    v_and_b32 v84, 0xffff0000, v84
    v_mul_f32 v50, v48, v48
    v_mfma_f32_32x32x16_bf16 v[144:159], a[204:207], a[92:95], v[144:159]
    ds_read_b64_tr_b16 a[188:189], v29 offset:47104
    ds_read_b64_tr_b16 a[190:191], v29 offset:47616
    buffer_load_dwordx4 v7, s[44:47], s79 offen offset:3072 lds
    s_add_u32 m0, s43, 135168
    v_and_b32 v58, 0xffff0000, v58
    v_mul_f32 v90, v90, v91
    s_waitcnt lgkmcnt(9)
    v_mfma_f32_32x32x16_bf16 v[96:111], a[160:163], a[96:99], v[96:111]
    ds_read_b128 a[104:107], v14 offset:32768
    ds_read_b64_tr_b16 a[192:193], v28 offset:53248
    ds_read_b64_tr_b16 a[194:195], v28 offset:53760
    v_mul_f32 v84, v84, v58
    v_cvt_pk_bf16_f32 v90, v90, v84
    v_add_f32 v51, v48, v48
    v_mfma_f32_32x32x16_bf16 v[112:127], a[164:167], a[96:99], v[112:127]
    ds_read_b64_tr_b16 a[196:197], v29 offset:53248
    ds_read_b64_tr_b16 a[198:199], v29 offset:53760
    buffer_load_dwordx4 v10, s[48:51], s61 offen offset:0 lds
    v_lshlrev_b32 v91, 16, v90
    v_and_b32 v90, 0xffff0000, v90
    v_fma_f32 v50, -v49, v49, v50
    v_mfma_f32_32x32x16_bf16 v[128:143], a[168:171], a[96:99], v[128:143]
    ds_read_b64_tr_b16 a[200:201], v28 offset:55296
    ds_read_b64_tr_b16 a[202:203], v28 offset:55808
    v_add_f32 v88, v88, v91
    v_add_f32 v88, v88, v90
    v_mul_f32 v51, v51, v49
    v_mfma_f32_32x32x16_bf16 v[144:159], a[172:175], a[96:99], v[144:159]
    ds_read_b64_tr_b16 a[204:205], v29 offset:55296
    ds_read_b64_tr_b16 a[206:207], v29 offset:55808
    buffer_load_dwordx4 v11, s[48:51], s61 offen offset:1024 lds
    v_cndmask_b32 v50, 1.0, v50, s[68:69]
    s_waitcnt lgkmcnt(9)
    v_mfma_f32_32x32x16_bf16 v[96:111], a[176:179], a[100:103], v[96:111]
    ds_read_b128 a[108:111], v15 offset:32768
    ds_read_b64_tr_b16 a[160:161], v28 offset:61440
    ds_read_b64_tr_b16 a[162:163], v28 offset:61952
    v_cndmask_b32 v51, 0, v51, s[68:69]
    v_mfma_f32_32x32x16_bf16 v[112:127], a[180:183], a[100:103], v[112:127]
    ds_read_b64_tr_b16 a[164:165], v29 offset:61440
    ds_read_b64_tr_b16 a[166:167], v29 offset:61952
    buffer_load_dwordx4 v10, s[52:55], s61 offen offset:2048 lds
    v_mul_f32 v250, v252, v50
    v_mfma_f32_32x32x16_bf16 v[128:143], a[184:187], a[100:103], v[128:143]
    ds_read_b64_tr_b16 a[168:169], v28 offset:63488
    ds_read_b64_tr_b16 a[170:171], v28 offset:64000
    v_mul_f32 v251, v252, v51
    v_mfma_f32_32x32x16_bf16 v[144:159], a[188:191], a[100:103], v[144:159]
    ds_read_b64_tr_b16 a[172:173], v29 offset:63488
    ds_read_b64_tr_b16 a[174:175], v29 offset:64000
    buffer_load_dwordx4 v11, s[52:55], s61 offen offset:3072 lds
    v_fma_f32 v250, -v253, v51, v250
    s_waitcnt vmcnt(16)
    s_barrier
    s_waitcnt lgkmcnt(9)
    v_mfma_f32_32x32x16_bf16 v[96:111], a[192:195], a[104:107], v[96:111]
    ds_read_b32 v86, v81 offset:0
    ds_read_b128 a[112:115], v16 offset:0
    ds_read_b64_tr_b16 a[176:177], v30 offset:4096
    v_fmac_f32 v251, v253, v50
    v_mfma_f32_32x32x16_bf16 v[112:127], a[196:199], a[104:107], v[112:127]
    ds_read_b64_tr_b16 a[178:179], v30 offset:4608
    ds_read_b64_tr_b16 a[180:181], v31 offset:4096
    ds_read_b64_tr_b16 a[182:183], v31 offset:4608
    s_add_u32 m0, s43, 0
    s_nop 0
    buffer_load_dwordx4 v8, s[92:95], s70 offen offset:0 lds
    v_lshl_add_u32 v254, v2, 1, v3
    v_mfma_f32_32x32x16_bf16 v[128:143], a[200:203], a[104:107], v[128:143]
    ds_read_b64_tr_b16 a[184:185], v30 offset:6144
    ds_read_b64_tr_b16 a[186:187], v30 offset:6656
    s_mov_b32 s65, 0
L_sp_3:
    v_readfirstlane_b32 s80, v46
    s_nop 0
    s_cmp_lg_u32 s80, 0
    s_cbranch_scc1 L_sp_4
    s_add_u32 s65, s65, 1
    s_cmp_gt_u32 s65, 100000
    s_cbranch_scc1 L_sp_4
    global_load_dword v46, v45, s[36:37] sc1
    s_waitcnt vmcnt(0)
    s_branch L_sp_3
L_sp_4:
    v_mov_b32 v47, s80
    s_cmp_lg_u32 s86, 0
    s_cbranch_scc1 L_w0_5
    s_lshl_b32 s40, s2, 7
    s_add_u32 s40, s40, 16056320
    s_mov_b64 exec, 1
    buffer_store_dword v47, v45, s[56:59], s40 offen sc1
    s_mov_b64 exec, -1
L_w0_5:
    v_mov_b32 v252, 0
    v_mfma_f32_32x32x16_bf16 v[144:159], a[204:207], a[104:107], v[144:159]
    ds_read_b64_tr_b16 a[188:189], v31 offset:6144
    ds_read_b64_tr_b16 a[190:191], v31 offset:6656
    buffer_load_dwordx4 v9, s[92:95], s70 offen offset:1024 lds
    s_add_u32 m0, s43, 2048
    v_mov_b32 v253, 0
    s_waitcnt lgkmcnt(10)
    v_mfma_f32_32x32x16_bf16 v[96:111], a[160:163], a[108:111], v[96:111]
    ds_read_b128 a[116:119], v17 offset:0
    ds_read_b64_tr_b16 a[192:193], v30 offset:12288
    ds_read_b64_tr_b16 a[194:195], v30 offset:12800
    v_mfma_f32_32x32x16_bf16 v[112:127], a[164:167], a[108:111], v[112:127]
    ds_read_b64_tr_b16 a[196:197], v31 offset:12288
    ds_read_b64_tr_b16 a[198:199], v31 offset:12800
    buffer_load_dwordx4 v8, s[92:95], s71 offen offset:0 lds
    s_waitcnt lgkmcnt(14)
    v_lshlrev_b32 v90, 16, v86
    v_mfma_f32_32x32x16_bf16 v[128:143], a[168:171], a[108:111], v[128:143]
    ds_read_b64_tr_b16 a[200:201], v30 offset:14336
    ds_read_b64_tr_b16 a[202:203], v30 offset:14848
    v_lshlrev_b32 v91, 16, v59
    v_and_b32 v86, 0xffff0000, v86
    v_mfma_f32_32x32x16_bf16 v[144:159], a[172:175], a[108:111], v[144:159]
    ds_read_b64_tr_b16 a[204:205], v31 offset:14336
    ds_read_b64_tr_b16 a[206:207], v31 offset:14848
    buffer_load_dwordx4 v9, s[92:95], s71 offen offset:1024 lds
    s_add_u32 m0, s43, 4096
    v_and_b32 v59, 0xffff0000, v59
    v_mul_f32 v90, v90, v91
    s_waitcnt lgkmcnt(9)
    v_mfma_f32_32x32x16_bf16 v[96:111], a[176:179], a[112:115], v[96:111]
    ds_read_b128 a[120:123], v18 offset:0
    ds_read_b64_tr_b16 a[160:161], v30 offset:20480
    ds_read_b64_tr_b16 a[162:163], v30 offset:20992
    v_mul_f32 v86, v86, v59
    v_cvt_pk_bf16_f32 v90, v90, v86
    v_mfma_f32_32x32x16_bf16 v[112:127], a[180:183], a[112:115], v[112:127]
    ds_read_b64_tr_b16 a[164:165], v31 offset:20480
    ds_read_b64_tr_b16 a[166:167], v31 offset:20992
    buffer_load_dwordx4 v8, s[92:95], s72 offen offset:0 lds
    v_lshlrev_b32 v91, 16, v90
    v_and_b32 v90, 0xffff0000, v90
    v_mfma_f32_32x32x16_bf16 v[128:143], a[184:187], a[112:115], v[128:143]
    ds_read_b64_tr_b16 a[168:169], v30 offset:22528
    ds_read_b64_tr_b16 a[170:171], v30 offset:23040
    v_add_f32 v88, v88, v91
    v_add_f32 v88, v88, v90
    v_mfma_f32_32x32x16_bf16 v[144:159], a[188:191], a[112:115], v[144:159]
    ds_read_b64_tr_b16 a[172:173], v31 offset:22528
    ds_read_b64_tr_b16 a[174:175], v31 offset:23040
    buffer_load_dwordx4 v9, s[92:95], s72 offen offset:1024 lds
    s_add_u32 m0, s43, 6144
    s_waitcnt lgkmcnt(9)
    v_mfma_f32_32x32x16_bf16 v[96:111], a[192:195], a[116:119], v[96:111]
    ds_read_b128 a[124:127], v19 offset:0
    ds_read_b64_tr_b16 a[176:177], v30 offset:28672
    ds_read_b64_tr_b16 a[178:179], v30 offset:29184
    v_mfma_f32_32x32x16_bf16 v[112:127], a[196:199], a[116:119], v[112:127]
    ds_read_b64_tr_b16 a[180:181], v31 offset:28672
    ds_read_b64_tr_b16 a[182:183], v31 offset:29184
    buffer_load_dwordx4 v8, s[92:95], s73 offen offset:0 lds
    v_mfma_f32_32x32x16_bf16 v[128:143], a[200:203], a[116:119], v[128:143]
    ds_read_b64_tr_b16 a[184:185], v30 offset:30720
    ds_read_b64_tr_b16 a[186:187], v30 offset:31232
    v_mfma_f32_32x32x16_bf16 v[144:159], a[204:207], a[116:119], v[144:159]
    ds_read_b64_tr_b16 a[188:189], v31 offset:30720
    ds_read_b64_tr_b16 a[190:191], v31 offset:31232
    buffer_load_dwordx4 v9, s[92:95], s73 offen offset:1024 lds
    s_waitcnt vmcnt(16)
    s_barrier
    s_waitcnt lgkmcnt(9)
    v_mfma_f32_32x32x16_bf16 v[96:111], a[160:163], a[120:123], v[96:111]
    ds_read_b32 v84, v81 offset:32768
    ds_read_b128 a[128:131], v16 offset:32768
    ds_read_b64_tr_b16 a[192:193], v30 offset:36864
    v_mfma_f32_32x32x16_bf16 v[112:127], a[164:167], a[120:123], v[112:127]
    ds_read_b64_tr_b16 a[194:195], v30 offset:37376
    ds_read_b64_tr_b16 a[196:197], v31 offset:36864
    ds_read_b64_tr_b16 a[198:199], v31 offset:37376
    s_add_u32 m0, s43, 32768
    s_nop 0
    buffer_load_dwordx4 v8, s[92:95], s74 offen offset:0 lds
    v_mfma_f32_32x32x16_bf16 v[128:143], a[168:171], a[120:123], v[128:143]
    ds_read_b64_tr_b16 a[200:201], v30 offset:38912
    ds_read_b64_tr_b16 a[202:203], v30 offset:39424
    v_mfma_f32_32x32x16_bf16 v[144:159], a[172:175], a[120:123], v[144:159]
    ds_read_b64_tr_b16 a[204:205], v31 offset:38912
    ds_read_b64_tr_b16 a[206:207], v31 offset:39424
    buffer_load_dwordx4 v9, s[92:95], s74 offen offset:1024 lds
    s_add_u32 m0, s43, 34816
    s_waitcnt lgkmcnt(10)
    v_mfma_f32_32x32x16_bf16 v[96:111], a[176:179], a[124:127], v[96:111]
    ds_read_b128 a[132:135], v17 offset:32768
    ds_read_b64_tr_b16 a[160:161], v30 offset:45056
    ds_read_b64_tr_b16 a[162:163], v30 offset:45568
    v_mfma_f32_32x32x16_bf16 v[112:127], a[180:183], a[124:127], v[112:127]
    ds_read_b64_tr_b16 a[164:165], v31 offset:45056
    ds_read_b64_tr_b16 a[166:167], v31 offset:45568
    buffer_load_dwordx4 v8, s[92:95], s75 offen offset:0 lds
    s_waitcnt lgkmcnt(14)
    v_lshlrev_b32 v90, 16, v84
    v_mfma_f32_32x32x16_bf16 v[128:143], a[184:187], a[124:127], v[128:143]
    ds_read_b64_tr_b16 a[168:169], v30 offset:47104
    ds_read_b64_tr_b16 a[170:171], v30 offset:47616
    v_lshlrev_b32 v91, 16, v60
    v_and_b32 v84, 0xffff0000, v84
    v_mfma_f32_32x32x16_bf16 v[144:159], a[188:191], a[124:127], v[144:159]
    ds_read_b64_tr_b16 a[172:173], v31 offset:47104
    ds_read_b64_tr_b16 a[174:175], v31 offset:47616
    buffer_load_dwordx4 v9, s[92:95], s75 offen offset:1024 lds
    s_add_u32 m0, s43, 36864
    v_and_b32 v60, 0xffff0000, v60
    v_mul_f32 v90, v90, v91
    s_waitcnt lgkmcnt(9)
    v_mfma_f32_32x32x16_bf16 v[96:111], a[192:195], a[128:131], v[96:111]
    ds_read_b128 a[136:139], v18 offset:32768
    ds_read_b64_tr_b16 a[176:177], v30 offset:53248
    ds_read_b64_tr_b16 a[178:179], v30 offset:53760
    v_mul_f32 v84, v84, v60
    v_cvt_pk_bf16_f32 v90, v90, v84
    v_mfma_f32_32x32x16_bf16 v[112:127], a[196:199], a[128:131], v[112:127]
    ds_read_b64_tr_b16 a[180:181], v31 offset:53248
    ds_read_b64_tr_b16 a[182:183], v31 offset:53760
    buffer_load_dwordx4 v8, s[92:95], s76 offen offset:0 lds
    v_lshlrev_b32 v91, 16, v90
    v_and_b32 v90, 0xffff0000, v90
    v_mfma_f32_32x32x16_bf16 v[128:143], a[200:203], a[128:131], v[128:143]
    ds_read_b64_tr_b16 a[184:185], v30 offset:55296
    ds_read_b64_tr_b16 a[186:187], v30 offset:55808
    v_add_f32 v88, v88, v91
    v_add_f32 v88, v88, v90
    v_mfma_f32_32x32x16_bf16 v[144:159], a[204:207], a[128:131], v[144:159]
    ds_read_b64_tr_b16 a[188:189], v31 offset:55296
    ds_read_b64_tr_b16 a[190:191], v31 offset:55808
    buffer_load_dwordx4 v9, s[92:95], s76 offen offset:1024 lds
    s_add_u32 m0, s43, 38912
    s_waitcnt lgkmcnt(9)
    v_mfma_f32_32x32x16_bf16 v[96:111], a[160:163], a[132:135], v[96:111]
    ds_read_b128 a[140:143], v19 offset:32768
    ds_read_b64_tr_b16 a[192:193], v30 offset:61440
    ds_read_b64_tr_b16 a[194:195], v30 offset:61952
    v_mfma_f32_32x32x16_bf16 v[112:127], a[164:167], a[132:135], v[112:127]
    ds_read_b64_tr_b16 a[196:197], v31 offset:61440
    ds_read_b64_tr_b16 a[198:199], v31 offset:61952
    buffer_load_dwordx4 v8, s[92:95], s77 offen offset:0 lds
    v_mfma_f32_32x32x16_bf16 v[128:143], a[168:171], a[132:135], v[128:143]
    ds_read_b64_tr_b16 a[200:201], v30 offset:63488
    ds_read_b64_tr_b16 a[202:203], v30 offset:64000
    v_mfma_f32_32x32x16_bf16 v[144:159], a[172:175], a[132:135], v[144:159]
    ds_read_b64_tr_b16 a[204:205], v31 offset:63488
    ds_read_b64_tr_b16 a[206:207], v31 offset:64000
    buffer_load_dwordx4 v9, s[92:95], s77 offen offset:1024 lds
    s_waitcnt vmcnt(16)
    s_barrier
    s_waitcnt lgkmcnt(9)
    v_mfma_f32_32x32x16_bf16 v[96:111], a[176:179], a[136:139], v[96:111]
    ds_read_b32 v86, v78 offset:0
    ds_read_b128 a[144:147], v72 offset:0
    ds_read_b64_tr_b16 a[160:161], v68 offset:4096
    v_mfma_f32_32x32x16_bf16 v[112:127], a[180:183], a[136:139], v[112:127]
    ds_read_b64_tr_b16 a[162:163], v68 offset:4608
    ds_read_b64_tr_b16 a[164:165], v69 offset:4096
    ds_read_b64_tr_b16 a[166:167], v69 offset:4608
    s_add_u32 m0, s43, 65536
    s_nop 0
    buffer_load_dwordx4 v8, s[92:95], s78 offen offset:0 lds
    v_mfma_f32_32x32x16_bf16 v[128:143], a[184:187], a[136:139], v[128:143]
    ds_read_b64_tr_b16 a[168:169], v68 offset:6144
    ds_read_b64_tr_b16 a[170:171], v68 offset:6656
    v_mfma_f32_32x32x16_bf16 v[144:159], a[188:191], a[136:139], v[144:159]
    ds_read_b64_tr_b16 a[172:173], v69 offset:6144
    ds_read_b64_tr_b16 a[174:175], v69 offset:6656
    buffer_load_dwordx4 v9, s[92:95], s78 offen offset:1024 lds
    s_add_u32 m0, s43, 67584
    s_waitcnt lgkmcnt(10)
    v_mfma_f32_32x32x16_bf16 v[96:111], a[192:195], a[140:143], v[96:111]
    ds_read_b128 a[148:151], v73 offset:0
    ds_read_b64_tr_b16 a[176:177], v68 offset:12288
    ds_read_b64_tr_b16 a[178:179], v68 offset:12800
    v_mfma_f32_32x32x16_bf16 v[112:127], a[196:199], a[140:143], v[112:127]
    ds_read_b64_tr_b16 a[180:181], v69 offset:12288
    ds_read_b64_tr_b16 a[182:183], v69 offset:12800
    buffer_load_dwordx4 v8, s[92:95], s79 offen offset:0 lds
    s_waitcnt lgkmcnt(14)
    v_lshlrev_b32 v90, 16, v86
    v_mfma_f32_32x32x16_bf16 v[128:143], a[200:203], a[140:143], v[128:143]
    ds_read_b64_tr_b16 a[184:185], v68 offset:14336
    ds_read_b64_tr_b16 a[186:187], v68 offset:14848
    v_lshlrev_b32 v91, 16, v61
    v_and_b32 v86, 0xffff0000, v86
    v_mfma_f32_32x32x16_bf16 v[144:159], a[204:207], a[140:143], v[144:159]
    ds_read_b64_tr_b16 a[188:189], v69 offset:14336
    ds_read_b64_tr_b16 a[190:191], v69 offset:14848
    buffer_load_dwordx4 v9, s[92:95], s79 offen offset:1024 lds
    v_and_b32 v61, 0xffff0000, v61
    v_mul_f32 v90, v90, v91
    s_waitcnt lgkmcnt(9)
    v_mfma_f32_32x32x16_bf16 v[96:111], a[160:163], a[144:147], v[96:111]
    ds_read_b128 a[152:155], v74 offset:0
    ds_read_b64_tr_b16 a[192:193], v68 offset:20480
    ds_read_b64_tr_b16 a[194:195], v68 offset:20992
    v_mul_f32 v86, v86, v61
    v_cvt_pk_bf16_f32 v90, v90, v86
    v_mfma_f32_32x32x16_bf16 v[112:127], a[164:167], a[144:147], v[112:127]
    ds_read_b64_tr_b16 a[196:197], v69 offset:20480
    ds_read_b64_tr_b16 a[198:199], v69 offset:20992
    v_lshlrev_b32 v91, 16, v90
    v_and_b32 v90, 0xffff0000, v90
    v_mfma_f32_32x32x16_bf16 v[128:143], a[168:171], a[144:147], v[128:143]
    ds_read_b64_tr_b16 a[200:201], v68 offset:22528
    ds_read_b64_tr_b16 a[202:203], v68 offset:23040
    v_add_f32 v88, v88, v91
    v_add_f32 v88, v88, v90
    v_lshrrev_b32 v48, 3, v1
    v_mul_u32_u24 v48, 1280, v48
    v_mfma_f32_32x32x16_bf16 v[144:159], a[172:175], a[144:147], v[144:159]
    ds_read_b64_tr_b16 a[204:205], v69 offset:22528
    ds_read_b64_tr_b16 a[206:207], v69 offset:23040
    v_add_f32_dpp v88, v88, v88 quad_perm:[1,0,3,2] row_mask:0xf bank_mask:0xf
    s_nop 1
    v_add_f32_dpp v88, v88, v88 quad_perm:[2,3,0,1] row_mask:0xf bank_mask:0xf
    v_and_b32 v49, 7, v1
    v_lshrrev_b32 v50, 4, v1
    s_waitcnt lgkmcnt(9)
    v_mfma_f32_32x32x16_bf16 v[96:111], a[176:179], a[148:151], v[96:111]
    ds_read_b128 a[156:159], v75 offset:0
    ds_read_b64_tr_b16 a[160:161], v68 offset:28672
    ds_read_b64_tr_b16 a[162:163], v68 offset:29184
    v_add_f32_dpp v88, v88, v88 row_half_mirror row_mask:0xf bank_mask:0xf
    s_nop 1
    v_add_f32_dpp v88, v88, v88 row_mirror row_mask:0xf bank_mask:0xf
    v_xor_b32 v49, v49, v50
    v_mfma_f32_32x32x16_bf16 v[112:127], a[180:183], a[148:151], v[112:127]
    ds_read_b64_tr_b16 a[164:165], v69 offset:28672
    ds_read_b64_tr_b16 a[166:167], v69 offset:29184
    v_mov_b32 v90, v88
    s_nop 1
    v_permlane16_swap_b32 v90, v88
    v_lshl_add_u32 v4, v49, 4, v48
    v_xor_b32 v5, 64, v4
    v_mfma_f32_32x32x16_bf16 v[128:143], a[184:187], a[148:151], v[128:143]
    ds_read_b64_tr_b16 a[168:169], v68 offset:30720
    ds_read_b64_tr_b16 a[170:171], v68 offset:31232
    v_add_f32 v88, v88, v90
    v_cvt_pk_bf16_f32 v88, v88, v88
    v_add_u32 v5, 9216, v5
    v_and_b32 v48, 15, v1
    v_mfma_f32_32x32x16_bf16 v[144:159], a[188:191], a[148:151], v[144:159]
    ds_read_b64_tr_b16 a[172:173], v69 offset:30720
    ds_read_b64_tr_b16 a[174:175], v69 offset:31232
    v_lshlrev_b32 v88, 16, v88
    v_mul_f32 v88, 0xbfb8aa3b, v88
    v_lshrrev_b32 v49, 1, v48
    v_xor_b32 v49, v49, v50
    s_waitcnt lgkmcnt(9)
    v_mfma_f32_32x32x16_bf16 v[96:111], a[192:195], a[152:155], v[96:111]
    v_lshlrev_b32 v49, 4, v49
    v_mfma_f32_32x32x16_bf16 v[112:127], a[196:199], a[152:155], v[112:127]
    v_lshl_add_u32 v48, v48, 7, v49
    v_mfma_f32_32x32x16_bf16 v[128:143], a[200:203], a[152:155], v[128:143]
    v_add_u32 v6, s43, v48
    v_mfma_f32_32x32x16_bf16 v[144:159], a[204:207], a[152:155], v[144:159]
    s_waitcnt vmcnt(12) lgkmcnt(0)
    s_barrier
    ds_read_b128 a[208:211], v20 offset:0
    v_xor_b32 v7, 64, v6
    v_mfma_f32_32x32x16_bf16 v[96:111], a[160:163], a[156:159], v[96:111]
    ds_read_b128 a[212:215], v20 offset:16384
    v_add_u32 v8, 98304, v6
    v_mfma_f32_32x32x16_bf16 v[112:127], a[164:167], a[156:159], v[112:127]
    ds_read_b128 a[216:219], v21 offset:0
    v_exp_f32 v88, v88
    s_nop 0
    v_add_f32 v88, 1.0, v88
    v_add_u32 v9, 98304, v7
    v_mfma_f32_32x32x16_bf16 v[128:143], a[168:171], a[156:159], v[128:143]
    ds_read_b128 a[220:223], v21 offset:16384
    v_rcp_f32 v88, v88
    s_nop 0
    v_cvt_pk_bf16_f32 v88, v88, v88
    v_mfma_f32_32x32x16_bf16 v[144:159], a[172:175], a[156:159], v[144:159]
    ds_read_b128 a[224:227], v22 offset:0
    v_lshlrev_b32 v90, 16, v88
    v_sub_f32 v91, 1.0, v90
    v_cvt_pk_bf16_f32 v91, v91, v91
    v_lshlrev_b32 v91, 16, v91
    s_mov_b32 s40, 15990784
    s_mov_b32 exec_lo, 1
    s_mov_b32 exec_hi, 1
    buffer_store_dwordx2 v[90:91], v89, s[56:59], s40 offen sc1
    s_mov_b64 exec, -1
    s_bitcmp1_b32 s86, 0
    s_cselect_b32 s92, s16, s14
    s_cselect_b32 s93, s17, s15
    s_mul_i32 s40, s88, 102400
    s_add_u32 s92, s92, s40
    s_addc_u32 s93, s93, 0
    s_mov_b32 s94, 102400
    s_mov_b32 s95, 0x20000
    s_lshr_b32 s91, s86, 1
    s_lshl_b32 s91, s91, 7
    s_waitcnt lgkmcnt(3)
    v_mfma_f32_32x32x16_bf16 v[176:191], a[0:3], a[208:211], 0
    ds_read_b128 a[228:231], v22 offset:16384
    v_mfma_f32_32x32x16_bf16 v[192:207], a[0:3], a[212:215], 0
    ds_read_b128 a[208:211], v23 offset:0
    s_add_u32 m0, s43, 98304
    s_bfe_u32 s23, 0x100, s89
    s_lshl_b32 s23, s23, 8
    s_add_u32 s23, s23, s91
    buffer_load_dwordx4 v4, s[92:95], s23 offen offset:0 lds
    v_mul_f32 v96, v96, |v96|
    v_mul_f32 v97, v97, |v97|
    v_cvt_pk_bf16_f32 v96, v96, v97
    s_waitcnt lgkmcnt(3)
    v_mfma_f32_32x32x16_bf16 v[176:191], a[4:7], a[216:219], v[176:191]
    ds_read_b128 a[212:215], v23 offset:16384
    v_pk_max_i16 v96, v96, 0
    v_mul_f32 v98, v98, |v98|
    v_mul_f32 v99, v99, |v99|
    v_cvt_pk_bf16_f32 v97, v98, v99
    v_pk_max_i16 v97, v97, 0
    v_mfma_f32_32x32x16_bf16 v[192:207], a[4:7], a[220:223], v[192:207]
    ds_read_b128 a[216:219], v20 offset:2048
    buffer_load_dwordx4 v5, s[92:95], s23 offen offset:1024 lds
    v_mul_f32 v100, v100, |v100|
    v_mul_f32 v101, v101, |v101|
    v_cvt_pk_bf16_f32 v98, v100, v101
    s_waitcnt lgkmcnt(3)
    v_mfma_f32_32x32x16_bf16 v[176:191], a[8:11], a[224:227], v[176:191]
    ds_read_b128 a[220:223], v20 offset:18432
    v_pk_max_i16 v98, v98, 0
    v_mul_f32 v102, v102, |v102|
    v_mul_f32 v103, v103, |v103|
    v_cvt_pk_bf16_f32 v99, v102, v103
    v_pk_max_i16 v99, v99, 0
    v_mfma_f32_32x32x16_bf16 v[192:207], a[8:11], a[228:231], v[192:207]
    ds_read_b128 a[224:227], v21 offset:2048
    s_add_u32 m0, s43, 100352
    s_add_u32 s23, s23, 20480
    buffer_load_dwordx4 v4, s[92:95], s23 offen offset:0 lds
    v_mul_f32 v104, v104, |v104|
    v_mul_f32 v105, v105, |v105|
    v_cvt_pk_bf16_f32 v100, v104, v105
    s_waitcnt lgkmcnt(3)
    v_mfma_f32_32x32x16_bf16 v[176:191], a[12:15], a[208:211], v[176:191]
    ds_read_b128 a[228:231], v21 offset:18432
    v_pk_max_i16 v100, v100, 0
    v_mul_f32 v106, v106, |v106|
    v_mul_f32 v107, v107, |v107|
    v_cvt_pk_bf16_f32 v101, v106, v107
    v_pk_max_i16 v101, v101, 0
    v_mfma_f32_32x32x16_bf16 v[192:207], a[12:15], a[212:215], v[192:207]
    ds_read_b128 a[208:211], v22 offset:2048
    buffer_load_dwordx4 v5, s[92:95], s23 offen offset:1024 lds
    v_mul_f32 v108, v108, |v108|
    v_mul_f32 v109, v109, |v109|
    v_cvt_pk_bf16_f32 v102, v108, v109
    s_waitcnt lgkmcnt(3)
    v_mfma_f32_32x32x16_bf16 v[176:191], a[16:19], a[216:219], v[176:191]
    ds_read_b128 a[212:215], v22 offset:18432
    s_cmp_lg_u32 s86, 0
    s_cbranch_scc1 L_w0_6
    s_mov_b32 s40, 0
    s_mov_b32 exec_hi, 0
    buffer_load_dword v46, v92, s[56:59], s40 offen sc1
    s_mov_b32 exec_hi, -1
L_w0_6:
    v_pk_max_i16 v102, v102, 0
    v_mul_f32 v110, v110, |v110|
    v_mul_f32 v111, v111, |v111|
    v_cvt_pk_bf16_f32 v103, v110, v111
    v_mfma_f32_32x32x16_bf16 v[192:207], a[16:19], a[220:223], v[192:207]
    ds_read_b128 a[216:219], v23 offset:2048
    s_add_u32 m0, s43, 102400
    s_add_u32 s23, s23, 20480
    buffer_load_dwordx4 v4, s[92:95], s23 offen offset:0 lds
    v_pk_max_i16 v103, v103, 0
    v_mul_f32 v112, v112, |v112|
    v_mul_f32 v113, v113, |v113|
    s_waitcnt lgkmcnt(3)
    v_mfma_f32_32x32x16_bf16 v[176:191], a[20:23], a[224:227], v[176:191]
    ds_read_b128 a[220:223], v23 offset:18432
    v_cvt_pk_bf16_f32 v112, v112, v113
    v_pk_max_i16 v112, v112, 0
    v_mul_f32 v114, v114, |v114|
    v_mul_f32 v115, v115, |v115|
    v_cvt_pk_bf16_f32 v113, v114, v115
    v_mfma_f32_32x32x16_bf16 v[192:207], a[20:23], a[228:231], v[192:207]
    ds_read_b128 a[224:227], v20 offset:4096
    buffer_load_dwordx4 v5, s[92:95], s23 offen offset:1024 lds
    v_pk_max_i16 v113, v113, 0
    v_mul_f32 v116, v116, |v116|
    v_mul_f32 v117, v117, |v117|
    s_waitcnt lgkmcnt(3)
    v_mfma_f32_32x32x16_bf16 v[176:191], a[24:27], a[208:211], v[176:191]
    ds_read_b128 a[228:231], v20 offset:20480
    v_cvt_pk_bf16_f32 v114, v116, v117
    v_pk_max_i16 v114, v114, 0
    v_mul_f32 v118, v118, |v118|
    v_mul_f32 v119, v119, |v119|
    v_cvt_pk_bf16_f32 v115, v118, v119
    v_mfma_f32_32x32x16_bf16 v[192:207], a[24:27], a[212:215], v[192:207]
    ds_read_b128 a[208:211], v21 offset:4096
    s_add_u32 m0, s43, 104448
    s_add_u32 s23, s23, 20480
    buffer_load_dwordx4 v4, s[92:95], s23 offen offset:0 lds
    v_pk_max_i16 v115, v115, 0
    v_mul_f32 v120, v120, |v120|
    v_mul_f32 v121, v121, |v121|
    s_waitcnt lgkmcnt(3)
    v_mfma_f32_32x32x16_bf16 v[176:191], a[28:31], a[216:219], v[176:191]
    ds_read_b128 a[212:215], v21 offset:20480
    v_cvt_pk_bf16_f32 v116, v120, v121
    v_pk_max_i16 v116, v116, 0
    v_mul_f32 v122, v122, |v122|
    v_mul_f32 v123, v123, |v123|
    v_cvt_pk_bf16_f32 v117, v122, v123
    v_mfma_f32_32x32x16_bf16 v[192:207], a[28:31], a[220:223], v[192:207]
    ds_read_b128 a[216:219], v22 offset:4096
    buffer_load_dwordx4 v5, s[92:95], s23 offen offset:1024 lds
    v_pk_max_i16 v117, v117, 0
    v_mul_f32 v124, v124, |v124|
    v_mul_f32 v125, v125, |v125|
    s_waitcnt lgkmcnt(3)
    v_mfma_f32_32x32x16_bf16 v[176:191], a[32:35], a[224:227], v[176:191]
    ds_read_b128 a[220:223], v22 offset:20480
    v_cvt_pk_bf16_f32 v118, v124, v125
    v_pk_max_i16 v118, v118, 0
    v_mul_f32 v126, v126, |v126|
    v_mul_f32 v127, v127, |v127|
    v_cvt_pk_bf16_f32 v119, v126, v127
    v_mfma_f32_32x32x16_bf16 v[192:207], a[32:35], a[228:231], v[192:207]
    ds_read_b128 a[224:227], v23 offset:4096
    s_add_u32 m0, s43, 131072
    s_add_u32 s23, s23, 20480
    buffer_load_dwordx4 v4, s[92:95], s23 offen offset:0 lds
    v_pk_max_i16 v119, v119, 0
    v_mul_f32 v128, v128, |v128|
    v_mul_f32 v129, v129, |v129|
    s_waitcnt lgkmcnt(3)
    v_mfma_f32_32x32x16_bf16 v[176:191], a[36:39], a[208:211], v[176:191]
    ds_read_b128 a[228:231], v23 offset:20480
    v_cvt_pk_bf16_f32 v128, v128, v129
    v_pk_max_i16 v128, v128, 0
    v_mul_f32 v130, v130, |v130|
    v_mul_f32 v131, v131, |v131|
    v_cvt_pk_bf16_f32 v129, v130, v131
    v_mfma_f32_32x32x16_bf16 v[192:207], a[36:39], a[212:215], v[192:207]
    ds_read_b128 a[208:211], v20 offset:6144
    buffer_load_dwordx4 v5, s[92:95], s23 offen offset:1024 lds
    v_pk_max_i16 v129, v129, 0
    v_mul_f32 v132, v132, |v132|
    v_mul_f32 v133, v133, |v133|
    s_waitcnt lgkmcnt(3)
    v_mfma_f32_32x32x16_bf16 v[176:191], a[40:43], a[216:219], v[176:191]
    ds_read_b128 a[212:215], v20 offset:22528
    v_cvt_pk_bf16_f32 v130, v132, v133
    v_pk_max_i16 v130, v130, 0
    v_mul_f32 v134, v134, |v134|
    v_mul_f32 v135, v135, |v135|
    v_cvt_pk_bf16_f32 v131, v134, v135
    v_mfma_f32_32x32x16_bf16 v[192:207], a[40:43], a[220:223], v[192:207]
    ds_read_b128 a[216:219], v21 offset:6144
    s_add_u32 m0, s43, 133120
    s_bfe_u32 s23, 0x1020001, s89
    s_lshl_b32 s23, s23, 8
    s_add_u32 s23, s23, s91
    buffer_load_dwordx4 v4, s[92:95], s23 offen offset:0 lds
    v_pk_max_i16 v131, v131, 0
    v_mul_f32 v136, v136, |v136|
    v_mul_f32 v137, v137, |v137|
    s_waitcnt lgkmcnt(3)
    v_mfma_f32_32x32x16_bf16 v[176:191], a[44:47], a[224:227], v[176:191]
    ds_read_b128 a[220:223], v21 offset:22528
    v_cvt_pk_bf16_f32 v132, v136, v137
    v_pk_max_i16 v132, v132, 0
    v_mul_f32 v138, v138, |v138|
    v_mul_f32 v139, v139, |v139|
    v_cvt_pk_bf16_f32 v133, v138, v139
    v_mfma_f32_32x32x16_bf16 v[192:207], a[44:47], a[228:231], v[192:207]
    ds_read_b128 a[224:227], v22 offset:6144
    buffer_load_dwordx4 v5, s[92:95], s23 offen offset:1024 lds
    v_pk_max_i16 v133, v133, 0
    v_mul_f32 v140, v140, |v140|
    v_mul_f32 v141, v141, |v141|
    s_waitcnt lgkmcnt(3)
    v_mfma_f32_32x32x16_bf16 v[176:191], a[48:51], a[208:211], v[176:191]
    ds_read_b128 a[228:231], v22 offset:22528
    v_cvt_pk_bf16_f32 v134, v140, v141
    v_pk_max_i16 v134, v134, 0
    v_mul_f32 v142, v142, |v142|
    v_mul_f32 v143, v143, |v143|
    v_cvt_pk_bf16_f32 v135, v142, v143
    v_mfma_f32_32x32x16_bf16 v[192:207], a[48:51], a[212:215], v[192:207]
    ds_read_b128 a[208:211], v23 offset:6144
    s_add_u32 m0, s43, 135168
    s_add_u32 s23, s23, 20480
    buffer_load_dwordx4 v4, s[92:95], s23 offen offset:0 lds
    v_pk_max_i16 v135, v135, 0
    v_mul_f32 v144, v144, |v144|
    v_mul_f32 v145, v145, |v145|
    s_waitcnt lgkmcnt(3)
    v_mfma_f32_32x32x16_bf16 v[176:191], a[52:55], a[216:219], v[176:191]
    ds_read_b128 a[212:215], v23 offset:22528
    v_cvt_pk_bf16_f32 v144, v144, v145
    v_pk_max_i16 v144, v144, 0
    v_mul_f32 v146, v146, |v146|
    v_mul_f32 v147, v147, |v147|
    v_cvt_pk_bf16_f32 v145, v146, v147
    v_mfma_f32_32x32x16_bf16 v[192:207], a[52:55], a[220:223], v[192:207]
    s_cmp_lg_u32 s86, 0
    s_cbranch_scc1 L_w0_7
    s_waitcnt vmcnt(9)
    s_mov_b32 s65, 0
L_sp_8:
    v_cmp_ne_u32 vcc, s80, v46
    s_nop 0
    s_cmp_eq_u32 vcc_lo, 0
    s_cbranch_scc1 L_sp_9
    s_add_u32 s65, s65, 1
    s_cmp_gt_u32 s65, 100000
    s_cbranch_scc1 L_sp_9
    s_mov_b32 s40, 0
    s_mov_b32 exec_hi, 0
    buffer_load_dword v46, v92, s[56:59], s40 offen sc1
    s_mov_b32 exec_hi, -1
    s_waitcnt vmcnt(0)
    s_branch L_sp_8
L_sp_9:
L_w0_7:
    s_waitcnt vmcnt(18) lgkmcnt(0)
    s_barrier
    ds_read_b128 a[216:219], v20 offset:32768
    buffer_load_dwordx4 v5, s[92:95], s23 offen offset:1024 lds
    v_pk_max_i16 v145, v145, 0
    v_mul_f32 v148, v148, |v148|
    v_mul_f32 v149, v149, |v149|
    v_mfma_f32_32x32x16_bf16 v[176:191], a[56:59], a[224:227], v[176:191]
    ds_read_b128 a[220:223], v20 offset:49152
    v_cvt_pk_bf16_f32 v146, v148, v149
    v_pk_max_i16 v146, v146, 0
    v_mul_f32 v150, v150, |v150|
    v_mul_f32 v151, v151, |v151|
    v_cvt_pk_bf16_f32 v147, v150, v151
    v_mfma_f32_32x32x16_bf16 v[192:207], a[56:59], a[228:231], v[192:207]
    ds_read_b128 a[224:227], v21 offset:32768
    s_add_u32 m0, s43, 137216
    s_add_u32 s23, s23, 20480
    buffer_load_dwordx4 v4, s[92:95], s23 offen offset:0 lds
    v_pk_max_i16 v147, v147, 0
    v_mul_f32 v152, v152, |v152|
    v_mul_f32 v153, v153, |v153|
    v_mfma_f32_32x32x16_bf16 v[176:191], a[60:63], a[208:211], v[176:191]
    ds_read_b128 a[228:231], v21 offset:49152
    v_cvt_pk_bf16_f32 v148, v152, v153
    v_pk_max_i16 v148, v148, 0
    v_mul_f32 v154, v154, |v154|
    v_mul_f32 v155, v155, |v155|
    v_cvt_pk_bf16_f32 v149, v154, v155
    v_mfma_f32_32x32x16_bf16 v[192:207], a[60:63], a[212:215], v[192:207]
    ds_read_b128 a[208:211], v22 offset:32768
    buffer_load_dwordx4 v5, s[92:95], s23 offen offset:1024 lds
    v_pk_max_i16 v149, v149, 0
    v_mul_f32 v156, v156, |v156|
    v_mul_f32 v157, v157, |v157|
    s_waitcnt lgkmcnt(3)
    v_mfma_f32_32x32x16_bf16 v[176:191], a[64:67], a[216:219], v[176:191]
    ds_read_b128 a[212:215], v22 offset:49152
    v_cvt_pk_bf16_f32 v150, v156, v157
    v_pk_max_i16 v150, v150, 0
    v_mul_f32 v158, v158, |v158|
    v_mul_f32 v159, v159, |v159|
    v_cvt_pk_bf16_f32 v151, v158, v159
    v_mfma_f32_32x32x16_bf16 v[192:207], a[64:67], a[220:223], v[192:207]
    ds_read_b128 a[216:219], v23 offset:32768
    s_add_u32 m0, s43, 0
    s_add_u32 s23, s23, 20480
    buffer_load_dwordx4 v4, s[92:95], s23 offen offset:0 lds
    v_pk_max_i16 v151, v151, 0
    v_subrev_u32 v84, 0, v40
    s_waitcnt lgkmcnt(3)
    v_mfma_f32_32x32x16_bf16 v[176:191], a[68:71], a[224:227], v[176:191]
    ds_read_b128 a[220:223], v23 offset:49152
    v_ashrrev_i32 v84, 31, v84
    v_bfi_b32 v84, v84, 0, v47
    v_subrev_u32 v85, 1024, v40
    v_ashrrev_i32 v85, 31, v85
    v_bfi_b32 v85, v85, 0, v47
    v_mfma_f32_32x32x16_bf16 v[192:207], a[68:71], a[228:231], v[192:207]
    ds_read_b128 a[224:227], v20 offset:34816
    buffer_load_dwordx4 v5, s[92:95], s23 offen offset:1024 lds
    s_mul_i32 s40, s87, 360448
    s_add_u32 s48, s38, s40
    s_addc_u32 s49, s39, 0
    s_mov_b32 s50, 360448
    s_mov_b32 s51, 0x20000
    s_mul_i32 s40, s88, 450560
    s_add_u32 s40, s40, 11534336
    s_add_u32 s8, s38, s40
    s_addc_u32 s9, s39, 0
    s_mov_b32 s10, 450560
    s_mov_b32 s11, 0x20000
    s_waitcnt lgkmcnt(3)
    v_mfma_f32_32x32x16_bf16 v[176:191], a[72:75], a[208:211], v[176:191]
    ds_read_b128 a[228:231], v20 offset:51200
    s_lshl_b32 s40, s85, 12
    s_add_u32 s40, s40, s64
    s_add_u32 s40, s40, 0
    buffer_store_dwordx4 v[96:99], v32, s[56:59], s40 offen offset:0 sc1
    v_mfma_f32_32x32x16_bf16 v[192:207], a[72:75], a[212:215], v[192:207]
    ds_read_b128 a[208:211], v21 offset:34816
    s_waitcnt lgkmcnt(3)
    v_mfma_f32_32x32x16_bf16 v[176:191], a[76:79], a[216:219], v[176:191]
    ds_read_b128 a[212:215], v21 offset:51200
    s_lshl_b32 s40, s85, 12
    s_add_u32 s40, s40, s64
    s_add_u32 s40, s40, 0
    buffer_store_dwordx4 v[100:103], v32, s[56:59], s40 offen offset:256 sc1
    v_mfma_f32_32x32x16_bf16 v[192:207], a[76:79], a[220:223], v[192:207]
    ds_read_b128 a[216:219], v22 offset:34816
    s_waitcnt lgkmcnt(3)
    v_mfma_f32_32x32x16_bf16 v[176:191], a[80:83], a[224:227], v[176:191]
    ds_read_b128 a[220:223], v22 offset:51200
    s_lshl_b32 s40, s85, 12
    s_add_u32 s40, s40, s64
    s_add_u32 s40, s40, 4096
    buffer_store_dwordx4 v[112:115], v32, s[56:59], s40 offen offset:0 sc1
    v_mfma_f32_32x32x16_bf16 v[192:207], a[80:83], a[228:231], v[192:207]
    ds_read_b128 a[224:227], v23 offset:34816
    s_waitcnt lgkmcnt(3)
    v_mfma_f32_32x32x16_bf16 v[176:191], a[84:87], a[208:211], v[176:191]
    ds_read_b128 a[228:231], v23 offset:51200
    s_lshl_b32 s40, s85, 12
    s_add_u32 s40, s40, s64
    s_add_u32 s40, s40, 4096
    buffer_store_dwordx4 v[116:119], v32, s[56:59], s40 offen offset:256 sc1
    v_mfma_f32_32x32x16_bf16 v[192:207], a[84:87], a[212:215], v[192:207]
    ds_read_b128 a[208:211], v20 offset:36864
    s_waitcnt lgkmcnt(3)
    v_mfma_f32_32x32x16_bf16 v[176:191], a[88:91], a[216:219], v[176:191]
    ds_read_b128 a[212:215], v20 offset:53248
    s_lshl_b32 s40, s85, 12
    s_add_u32 s40, s40, s64
    s_add_u32 s40, s40, 98304
    buffer_store_dwordx4 v[128:131], v32, s[56:59], s40 offen offset:0 sc1
    v_mfma_f32_32x32x16_bf16 v[192:207], a[88:91], a[220:223], v[192:207]
    ds_read_b128 a[216:219], v21 offset:36864
    s_waitcnt lgkmcnt(3)
    v_mfma_f32_32x32x16_bf16 v[176:191], a[92:95], a[224:227], v[176:191]
    ds_read_b128 a[220:223], v21 offset:53248
    s_lshl_b32 s40, s85, 12
    s_add_u32 s40, s40, s64
    s_add_u32 s40, s40, 98304
    buffer_store_dwordx4 v[132:135], v32, s[56:59], s40 offen offset:256 sc1
    v_mfma_f32_32x32x16_bf16 v[192:207], a[92:95], a[228:231], v[192:207]
    ds_read_b128 a[224:227], v22 offset:36864
    s_waitcnt lgkmcnt(3)
    v_mfma_f32_32x32x16_bf16 v[176:191], a[96:99], a[208:211], v[176:191]
    ds_read_b128 a[228:231], v22 offset:53248
    s_lshl_b32 s40, s85, 12
    s_add_u32 s40, s40, s64
    s_add_u32 s40, s40, 102400
    buffer_store_dwordx4 v[144:147], v32, s[56:59], s40 offen offset:0 sc1
    v_mfma_f32_32x32x16_bf16 v[192:207], a[96:99], a[212:215], v[192:207]
    ds_read_b128 a[208:211], v23 offset:36864
    s_waitcnt lgkmcnt(3)
    v_mfma_f32_32x32x16_bf16 v[176:191], a[100:103], a[216:219], v[176:191]
    ds_read_b128 a[212:215], v23 offset:53248
    s_lshl_b32 s40, s85, 12
    s_add_u32 s40, s40, s64
    s_add_u32 s40, s40, 102400
    buffer_store_dwordx4 v[148:151], v32, s[56:59], s40 offen offset:256 sc1
    v_mfma_f32_32x32x16_bf16 v[192:207], a[100:103], a[220:223], v[192:207]
    ds_read_b128 a[216:219], v20 offset:38912
    s_waitcnt lgkmcnt(3)
    v_mfma_f32_32x32x16_bf16 v[176:191], a[104:107], a[224:227], v[176:191]
    ds_read_b128 a[220:223], v20 offset:55296
    v_mfma_f32_32x32x16_bf16 v[192:207], a[104:107], a[228:231], v[192:207]
    ds_read_b128 a[224:227], v21 offset:38912
    s_add_u32 m0, s43, 2048
    s_add_u32 s23, s23, 20480
    buffer_load_dwordx4 v4, s[92:95], s23 offen offset:0 lds
    s_waitcnt lgkmcnt(3)
    v_mfma_f32_32x32x16_bf16 v[176:191], a[108:111], a[208:211], v[176:191]
    ds_read_b128 a[228:231], v21 offset:55296
    v_mfma_f32_32x32x16_bf16 v[192:207], a[108:111], a[212:215], v[192:207]
    ds_read_b128 a[208:211], v22 offset:38912
    buffer_load_dwordx4 v5, s[92:95], s23 offen offset:1024 lds
    s_waitcnt lgkmcnt(3)
    v_mfma_f32_32x32x16_bf16 v[176:191], a[112:115], a[216:219], v[176:191]
    ds_read_b128 a[212:215], v22 offset:55296
    v_mfma_f32_32x32x16_bf16 v[192:207], a[112:115], a[220:223], v[192:207]
    ds_read_b128 a[216:219], v23 offset:38912
    s_add_u32 m0, s43, 4096
    s_bfe_u32 s23, 0x3010202, s89
    s_lshl_b32 s23, s23, 8
    s_add_u32 s23, s23, s91
    buffer_load_dwordx4 v4, s[92:95], s23 offen offset:0 lds
    s_waitcnt lgkmcnt(3)
    v_mfma_f32_32x32x16_bf16 v[176:191], a[116:119], a[224:227], v[176:191]
    ds_read_b128 a[220:223], v23 offset:55296
    v_mfma_f32_32x32x16_bf16 v[192:207], a[116:119], a[228:231], v[192:207]
    s_waitcnt vmcnt(30) lgkmcnt(0)
    s_barrier
    ds_read_b128 a[224:227], v24 offset:0
    buffer_load_dwordx4 v5, s[92:95], s23 offen offset:1024 lds
    v_mfma_f32_32x32x16_bf16 v[176:191], a[120:123], a[208:211], v[176:191]
    ds_read_b128 a[228:231], v24 offset:16384
    v_mfma_f32_32x32x16_bf16 v[192:207], a[120:123], a[212:215], v[192:207]
    ds_read_b128 a[208:211], v25 offset:0
    s_add_u32 m0, s43, 6144
    s_add_u32 s23, s23, 20480
    buffer_load_dwordx4 v4, s[92:95], s23 offen offset:0 lds
    v_mfma_f32_32x32x16_bf16 v[176:191], a[124:127], a[216:219], v[176:191]
    ds_read_b128 a[212:215], v25 offset:16384
    v_mfma_f32_32x32x16_bf16 v[192:207], a[124:127], a[220:223], v[192:207]
    ds_read_b128 a[216:219], v26 offset:0
    buffer_load_dwordx4 v5, s[92:95], s23 offen offset:1024 lds
    s_waitcnt lgkmcnt(3)
    v_mfma_f32_32x32x16_bf16 v[176:191], a[128:131], a[224:227], v[176:191]
    ds_read_b128 a[220:223], v26 offset:16384
    v_mfma_f32_32x32x16_bf16 v[192:207], a[128:131], a[228:231], v[192:207]
    ds_read_b128 a[224:227], v27 offset:0
    s_add_u32 m0, s43, 32768
    s_add_u32 s23, s23, 20480
    buffer_load_dwordx4 v4, s[92:95], s23 offen offset:0 lds
    s_waitcnt lgkmcnt(3)
    v_mfma_f32_32x32x16_bf16 v[176:191], a[132:135], a[208:211], v[176:191]
    ds_read_b128 a[228:231], v27 offset:16384
    v_mfma_f32_32x32x16_bf16 v[192:207], a[132:135], a[212:215], v[192:207]
    ds_read_b128 a[208:211], v24 offset:2048
    buffer_load_dwordx4 v5, s[92:95], s23 offen offset:1024 lds
    s_waitcnt lgkmcnt(3)
    v_mfma_f32_32x32x16_bf16 v[176:191], a[136:139], a[216:219], v[176:191]
    ds_read_b128 a[212:215], v24 offset:18432
    v_mfma_f32_32x32x16_bf16 v[192:207], a[136:139], a[220:223], v[192:207]
    ds_read_b128 a[216:219], v25 offset:2048
    s_add_u32 m0, s43, 34816
    s_add_u32 s23, s23, 20480
    buffer_load_dwordx4 v4, s[92:95], s23 offen offset:0 lds
    s_waitcnt lgkmcnt(3)
    v_mfma_f32_32x32x16_bf16 v[176:191], a[140:143], a[224:227], v[176:191]
    ds_read_b128 a[220:223], v25 offset:18432
    v_mfma_f32_32x32x16_bf16 v[192:207], a[140:143], a[228:231], v[192:207]
    ds_read_b128 a[224:227], v26 offset:2048
    buffer_load_dwordx4 v5, s[92:95], s23 offen offset:1024 lds
    s_waitcnt lgkmcnt(3)
    v_mfma_f32_32x32x16_bf16 v[176:191], a[144:147], a[208:211], v[176:191]
    ds_read_b128 a[228:231], v26 offset:18432
    v_mfma_f32_32x32x16_bf16 v[192:207], a[144:147], a[212:215], v[192:207]
    ds_read_b128 a[208:211], v27 offset:2048
    s_add_u32 m0, s43, 36864
    s_add_u32 s23, s23, 20480
    buffer_load_dwordx4 v4, s[92:95], s23 offen offset:0 lds
    s_waitcnt lgkmcnt(3)
    v_mfma_f32_32x32x16_bf16 v[176:191], a[148:151], a[216:219], v[176:191]
    ds_read_b128 a[212:215], v27 offset:18432
    v_mfma_f32_32x32x16_bf16 v[192:207], a[148:151], a[220:223], v[192:207]
    buffer_load_dwordx4 v5, s[92:95], s23 offen offset:1024 lds
    s_waitcnt lgkmcnt(2)
    v_mfma_f32_32x32x16_bf16 v[176:191], a[152:155], a[224:227], v[176:191]
    v_mfma_f32_32x32x16_bf16 v[192:207], a[152:155], a[228:231], v[192:207]
    s_add_u32 m0, s43, 38912
    s_bfe_u32 s23, 0x2030304, s89
    s_lshl_b32 s23, s23, 8
    s_add_u32 s23, s23, s91
    buffer_load_dwordx4 v4, s[92:95], s23 offen offset:0 lds
    s_waitcnt lgkmcnt(0)
    v_mfma_f32_32x32x16_bf16 v[176:191], a[156:159], a[208:211], v[176:191]
    v_mfma_f32_32x32x16_bf16 v[192:207], a[156:159], a[212:215], v[192:207]
    buffer_load_dwordx4 v5, s[92:95], s23 offen offset:1024 lds
    s_waitcnt vmcnt(14)
    s_add_u32 s65, s90, 0
    s_mov_b64 exec, 1
    buffer_store_dword v47, v45, s[56:59], s65 offen sc1
    s_mov_b64 exec, -1
    s_nop 4
    v_fmac_f32 v177, v240, v176
    v_fmac_f32 v193, v240, v192
    v_fma_f32 v177, -v241, v192, v177
    v_fmac_f32 v193, v241, v176
    v_fmac_f32 v178, v240, v177
    v_fmac_f32 v194, v240, v193
    s_bfe_u32 s61, 0x20100, s89
    s_mul_i32 s61, s61, 20480
    buffer_load_dwordx4 a[208:211], v41, s[8:11], s61 offen offset:0 sc1
    v_fma_f32 v178, -v241, v193, v178
    v_fmac_f32 v194, v241, v177
    v_fmac_f32 v179, v240, v178
    v_fmac_f32 v195, v240, v194
    v_fma_f32 v179, -v241, v194, v179
    v_fmac_f32 v195, v241, v178
    buffer_load_dwordx4 a[212:215], v41, s[8:11], s61 offen offset:1024 sc1
    v_fmac_f32 v180, v240, v179
    v_fmac_f32 v196, v240, v195
    v_fma_f32 v180, -v241, v195, v180
    v_fmac_f32 v196, v241, v179
    v_fmac_f32 v181, v240, v180
    v_fmac_f32 v197, v240, v196
    buffer_load_dwordx4 a[216:219], v41, s[8:11], s61 offen offset:2048 sc1
    v_fma_f32 v181, -v241, v196, v181
    v_fmac_f32 v197, v241, v180
    v_fmac_f32 v182, v240, v181
    v_fmac_f32 v198, v240, v197
    v_fma_f32 v182, -v241, v197, v182
    v_fmac_f32 v198, v241, v181
    buffer_load_dwordx4 a[220:223], v41, s[8:11], s61 offen offset:3072 sc1
    v_fmac_f32 v183, v240, v182
    v_fmac_f32 v199, v240, v198
    v_fma_f32 v183, -v241, v198, v183
    v_fmac_f32 v199, v241, v182
    v_fmac_f32 v184, v240, v183
    v_fmac_f32 v200, v240, v199
    buffer_load_dwordx4 a[224:227], v42, s[8:11], s61 offen sc1
    v_fma_f32 v184, -v241, v199, v184
    v_fmac_f32 v200, v241, v183
    v_fmac_f32 v185, v240, v184
    v_fmac_f32 v201, v240, v200
    v_fma_f32 v185, -v241, v200, v185
    v_fmac_f32 v201, v241, v184
    s_bfe_u32 s61, 0x3000001, s89
    s_mul_i32 s61, s61, 20480
    buffer_load_dwordx4 a[228:231], v41, s[8:11], s61 offen offset:0 sc1
    v_fmac_f32 v186, v240, v185
    v_fmac_f32 v202, v240, v201
    v_fma_f32 v186, -v241, v201, v186
    v_fmac_f32 v202, v241, v185
    v_fmac_f32 v187, v240, v186
    v_fmac_f32 v203, v240, v202
    buffer_load_dwordx4 a[232:235], v41, s[8:11], s61 offen offset:1024 sc1
    v_fma_f32 v187, -v241, v202, v187
    v_fmac_f32 v203, v241, v186
    v_fmac_f32 v188, v240, v187
    v_fmac_f32 v204, v240, v203
    v_fma_f32 v188, -v241, v203, v188
    v_fmac_f32 v204, v241, v187
    buffer_load_dwordx4 a[236:239], v41, s[8:11], s61 offen offset:2048 sc1
    v_fmac_f32 v189, v240, v188
    v_fmac_f32 v205, v240, v204
    v_fma_f32 v189, -v241, v204, v189
    v_fmac_f32 v205, v241, v188
    v_fmac_f32 v190, v240, v189
    v_fmac_f32 v206, v240, v205
    v_fma_f32 v190, -v241, v205, v190
    v_fmac_f32 v206, v241, v189
    v_fmac_f32 v191, v240, v190
    v_fmac_f32 v207, v240, v206
    v_fma_f32 v191, -v241, v206, v191
    v_fmac_f32 v207, v241, v190
    v_mov_b32 v48, v191
    v_mov_b32 v49, v207
    ds_write_b64 v34, v[48:49] offset:0
    s_waitcnt lgkmcnt(0)
    s_barrier
    ds_read_b64 v[52:53], v35 offset:0
    ds_read_b64 v[54:55], v35 offset:256
    ds_read_b64 v[56:57], v35 offset:512
    ds_read_b64 v[58:59], v35 offset:768
    ds_read_b64 v[60:61], v35 offset:1024
    ds_read_b64 v[62:63], v35 offset:1280
    ds_read_b64 v[64:65], v35 offset:1536
    ds_read_b64 v[66:67], v35 offset:1792
    s_waitcnt lgkmcnt(0)
    v_pk_fma_f32 v[54:55], v[244:245], v[52:53], v[54:55] op_sel:[0,0,0] op_sel_hi:[0,1,1]
    v_pk_fma_f32 v[54:55], v[244:245], v[52:53], v[54:55] op_sel:[1,1,0] op_sel_hi:[1,0,1] neg_lo:[1,0,0]
    v_pk_fma_f32 v[56:57], v[244:245], v[54:55], v[56:57] op_sel:[0,0,0] op_sel_hi:[0,1,1]
    v_pk_fma_f32 v[56:57], v[244:245], v[54:55], v[56:57] op_sel:[1,1,0] op_sel_hi:[1,0,1] neg_lo:[1,0,0]
    v_pk_fma_f32 v[58:59], v[244:245], v[56:57], v[58:59] op_sel:[0,0,0] op_sel_hi:[0,1,1]
    v_pk_fma_f32 v[58:59], v[244:245], v[56:57], v[58:59] op_sel:[1,1,0] op_sel_hi:[1,0,1] neg_lo:[1,0,0]
    v_pk_fma_f32 v[60:61], v[244:245], v[58:59], v[60:61] op_sel:[0,0,0] op_sel_hi:[0,1,1]
    v_pk_fma_f32 v[60:61], v[244:245], v[58:59], v[60:61] op_sel:[1,1,0] op_sel_hi:[1,0,1] neg_lo:[1,0,0]
    v_pk_fma_f32 v[62:63], v[244:245], v[60:61], v[62:63] op_sel:[0,0,0] op_sel_hi:[0,1,1]
    v_pk_fma_f32 v[62:63], v[244:245], v[60:61], v[62:63] op_sel:[1,1,0] op_sel_hi:[1,0,1] neg_lo:[1,0,0]
    v_pk_fma_f32 v[64:65], v[244:245], v[62:63], v[64:65] op_sel:[0,0,0] op_sel_hi:[0,1,1]
    v_pk_fma_f32 v[64:65], v[244:245], v[62:63], v[64:65] op_sel:[1,1,0] op_sel_hi:[1,0,1] neg_lo:[1,0,0]
    v_pk_fma_f32 v[66:67], v[244:245], v[64:65], v[66:67] op_sel:[0,0,0] op_sel_hi:[0,1,1]
    v_pk_fma_f32 v[66:67], v[244:245], v[64:65], v[66:67] op_sel:[1,1,0] op_sel_hi:[1,0,1] neg_lo:[1,0,0]
    v_mov_b32 v68, v67
    v_mov_b32 v69, v47
    v_mov_b32 v67, v47
    s_add_u32 s40, s84, 0
    s_lshl_b32 s40, s40, 4
    s_add_u32 s40, s40, s82
    s_lshl_b32 s40, s40, 9
    s_add_u32 s40, s40, 15728640
    s_lshl_b32 s41, s86, 3
    s_lshl_b32 exec_lo, 0xff, s41
    s_mov_b32 exec_hi, 0
    buffer_store_dwordx4 v[66:69], v33, s[56:59], s40 offen sc1
    s_mov_b64 exec, -1
    ds_read_b128 a[0:3], v8 offset:0
    ds_read_b128 a[4:7], v9 offset:0
    ds_read_b128 a[8:11], v8 offset:2048
    ds_read_b128 a[12:15], v9 offset:2048
    ds_read_b128 a[16:19], v8 offset:4096
    ds_read_b128 a[20:23], v9 offset:4096
    ds_read_b128 a[24:27], v8 offset:6144
    ds_read_b128 a[28:31], v9 offset:6144
    ds_read_b128 a[32:35], v8 offset:32768
    ds_read_b128 a[36:39], v9 offset:32768
    ds_read_b128 a[40:43], v8 offset:34816
    ds_read_b128 a[44:47], v9 offset:34816
    ds_read_b128 a[48:51], v8 offset:36864
    ds_read_b128 a[52:55], v9 offset:36864
    ds_read_b128 a[56:59], v8 offset:38912
    buffer_load_dwordx4 a[240:243], v41, s[8:11], s61 offen offset:3072 sc1
    ds_read_b128 a[60:63], v9 offset:38912
    ds_read_b128 a[64:67], v6 offset:0
    ds_read_b128 a[68:71], v7 offset:0
    buffer_load_dwordx4 a[244:247], v42, s[8:11], s61 offen sc1
    s_waitcnt vmcnt(24)
    ds_read_b128 a[72:75], v6 offset:2048
    ds_read_b128 a[76:79], v7 offset:2048
    s_waitcnt vmcnt(22)
    ds_read_b128 a[80:83], v6 offset:4096
    s_bfe_u32 s61, 0x1010204, s89
    s_mul_i32 s61, s61, 20480
    buffer_load_dwordx4 v[12:15], v41, s[8:11], s61 offen offset:0 sc1
    ds_read_b128 a[84:87], v7 offset:4096
    s_waitcnt vmcnt(21)
    ds_read_b128 a[88:91], v6 offset:6144
    ds_read_b128 a[92:95], v7 offset:6144
    buffer_load_dwordx4 v[16:19], v41, s[8:11], s61 offen offset:1024 sc1
    s_waitcnt vmcnt(20)
    ds_read_b128 a[96:99], v6 offset:32768
    ds_read_b128 a[100:103], v7 offset:32768
    s_waitcnt vmcnt(18)
    ds_read_b128 a[104:107], v6 offset:34816
    buffer_load_dwordx4 v[20:23], v41, s[8:11], s61 offen offset:2048 sc1
    ds_read_b128 a[108:111], v7 offset:34816
    s_waitcnt vmcnt(17)
    ds_read_b128 a[112:115], v6 offset:36864
    ds_read_b128 a[116:119], v7 offset:36864
    buffer_load_dwordx4 v[24:27], v41, s[8:11], s61 offen offset:3072 sc1
    s_waitcnt vmcnt(16)
    ds_read_b128 a[120:123], v6 offset:38912
    ds_read_b128 a[124:127], v7 offset:38912
    v_cmp_eq_u32 s[14:15], 1, v254
    buffer_load_dwordx4 v[28:31], v42, s[8:11], s61 offen sc1
    v_cmp_eq_u32 s[12:13], 2, v254
    v_cndmask_b32 v252, v252, v52, s[14:15]
    v_cndmask_b32 v253, v253, v53, s[14:15]
    s_waitcnt lgkmcnt(15)
    s_add_u32 m0, s43, 98304
    s_add_u32 s23, s23, 20480
    buffer_load_dwordx4 v4, s[92:95], s23 offen offset:0 lds
    v_cmp_eq_u32 s[14:15], 3, v254
    v_cndmask_b32 v252, v252, v54, s[12:13]
    v_cndmask_b32 v253, v253, v55, s[12:13]
    buffer_load_dwordx4 v5, s[92:95], s23 offen offset:1024 lds
    v_cmp_eq_u32 s[12:13], 4, v254
    v_cndmask_b32 v252, v252, v56, s[14:15]
    v_cndmask_b32 v253, v253, v57, s[14:15]
    s_add_u32 m0, s43, 100352
    s_add_u32 s23, s23, 20480
    buffer_load_dwordx4 v4, s[92:95], s23 offen offset:0 lds
    v_cmp_eq_u32 s[14:15], 5, v254
    v_cndmask_b32 v252, v252, v58, s[12:13]
    v_cndmask_b32 v253, v253, v59, s[12:13]
    buffer_load_dwordx4 v5, s[92:95], s23 offen offset:1024 lds
    v_cmp_eq_u32 s[12:13], 6, v254
    v_cndmask_b32 v252, v252, v60, s[14:15]
    v_cndmask_b32 v253, v253, v61, s[14:15]
    s_cmp_lg_u32 s86, 0
    s_cbranch_scc1 L_w0_10
    s_mov_b32 s40, 0
    s_mov_b32 exec_hi, 0
    buffer_load_dword v46, v43, s[56:59], s40 offen sc1
    s_mov_b32 exec_hi, -1
L_w0_10:
    v_cmp_eq_u32 s[14:15], 7, v254
    v_cndmask_b32 v252, v252, v62, s[12:13]
    v_cndmask_b32 v253, v253, v63, s[12:13]
    s_add_u32 m0, s43, 102400
    s_add_u32 s23, s23, 20480
    buffer_load_dwordx4 v4, s[92:95], s23 offen offset:0 lds
    v_cndmask_b32 v48, v252, v64, s[14:15]
    v_cndmask_b32 v49, v253, v65, s[14:15]
    v_mul_f32 v252, v242, v48
    buffer_load_dwordx4 v5, s[92:95], s23 offen offset:1024 lds
    v_mul_f32 v253, v242, v49
    v_fma_f32 v252, -v243, v49, v252
    v_fmac_f32 v253, v243, v48
    s_add_u32 m0, s43, 104448
    s_add_u32 s23, s23, 20480
    buffer_load_dwordx4 v4, s[92:95], s23 offen offset:0 lds
    v_pk_mul_f32 v[48:49], v[242:243], v[176:177] op_sel:[1,0] op_sel_hi:[1,1]
    v_pk_mul_f32 v[176:177], v[242:243], v[176:177] op_sel:[0,0] op_sel_hi:[0,1]
    v_pk_fma_f32 v[176:177], v[242:243], v[192:193], v[176:177] op_sel:[1,0,0] op_sel_hi:[1,1,1] neg_lo:[1,0,0] neg_hi:[1,0,0]
    buffer_load_dwordx4 v5, s[92:95], s23 offen offset:1024 lds
    v_pk_fma_f32 v[192:193], v[242:243], v[192:193], v[48:49] op_sel:[0,0,0] op_sel_hi:[0,1,1]
    v_pk_mul_f32 v[50:51], v[242:243], v[178:179] op_sel:[1,0] op_sel_hi:[1,1]
    v_pk_mul_f32 v[178:179], v[242:243], v[178:179] op_sel:[0,0] op_sel_hi:[0,1]
    s_add_u32 m0, s43, 131072
    s_bfe_u32 s23, 0x4040403, s89
    s_lshl_b32 s23, s23, 8
    s_add_u32 s23, s23, s91
    buffer_load_dwordx4 v4, s[92:95], s23 offen offset:0 lds
    v_pk_fma_f32 v[178:179], v[242:243], v[194:195], v[178:179] op_sel:[1,0,0] op_sel_hi:[1,1,1] neg_lo:[1,0,0] neg_hi:[1,0,0]
    v_pk_fma_f32 v[194:195], v[242:243], v[194:195], v[50:51] op_sel:[0,0,0] op_sel_hi:[0,1,1]
    v_pk_mul_f32 v[48:49], v[242:243], v[180:181] op_sel:[1,0] op_sel_hi:[1,1]
    buffer_load_dwordx4 v5, s[92:95], s23 offen offset:1024 lds
    v_pk_mul_f32 v[180:181], v[242:243], v[180:181] op_sel:[0,0] op_sel_hi:[0,1]
    v_pk_fma_f32 v[180:181], v[242:243], v[196:197], v[180:181] op_sel:[1,0,0] op_sel_hi:[1,1,1] neg_lo:[1,0,0] neg_hi:[1,0,0]
    v_pk_fma_f32 v[196:197], v[242:243], v[196:197], v[48:49] op_sel:[0,0,0] op_sel_hi:[0,1,1]
    s_add_u32 m0, s43, 133120
    s_add_u32 s23, s23, 20480
    buffer_load_dwordx4 v4, s[92:95], s23 offen offset:0 lds
    v_pk_mul_f32 v[50:51], v[242:243], v[182:183] op_sel:[1,0] op_sel_hi:[1,1]
    v_pk_mul_f32 v[182:183], v[242:243], v[182:183] op_sel:[0,0] op_sel_hi:[0,1]
    v_pk_fma_f32 v[182:183], v[242:243], v[198:199], v[182:183] op_sel:[1,0,0] op_sel_hi:[1,1,1] neg_lo:[1,0,0] neg_hi:[1,0,0]
    buffer_load_dwordx4 v5, s[92:95], s23 offen offset:1024 lds
    v_pk_fma_f32 v[198:199], v[242:243], v[198:199], v[50:51] op_sel:[0,0,0] op_sel_hi:[0,1,1]
    v_pk_mul_f32 v[48:49], v[242:243], v[184:185] op_sel:[1,0] op_sel_hi:[1,1]
    v_pk_mul_f32 v[184:185], v[242:243], v[184:185] op_sel:[0,0] op_sel_hi:[0,1]
    v_pk_fma_f32 v[184:185], v[242:243], v[200:201], v[184:185] op_sel:[1,0,0] op_sel_hi:[1,1,1] neg_lo:[1,0,0] neg_hi:[1,0,0]
    v_pk_fma_f32 v[200:201], v[242:243], v[200:201], v[48:49] op_sel:[0,0,0] op_sel_hi:[0,1,1]
    v_pk_mul_f32 v[50:51], v[242:243], v[186:187] op_sel:[1,0] op_sel_hi:[1,1]
    v_pk_mul_f32 v[186:187], v[242:243], v[186:187] op_sel:[0,0] op_sel_hi:[0,1]
    v_pk_fma_f32 v[186:187], v[242:243], v[202:203], v[186:187] op_sel:[1,0,0] op_sel_hi:[1,1,1] neg_lo:[1,0,0] neg_hi:[1,0,0]
    v_pk_fma_f32 v[202:203], v[242:243], v[202:203], v[50:51] op_sel:[0,0,0] op_sel_hi:[0,1,1]
    v_pk_mul_f32 v[48:49], v[242:243], v[188:189] op_sel:[1,0] op_sel_hi:[1,1]
    v_pk_mul_f32 v[188:189], v[242:243], v[188:189] op_sel:[0,0] op_sel_hi:[0,1]
    v_pk_fma_f32 v[188:189], v[242:243], v[204:205], v[188:189] op_sel:[1,0,0] op_sel_hi:[1,1,1] neg_lo:[1,0,0] neg_hi:[1,0,0]
    v_pk_fma_f32 v[204:205], v[242:243], v[204:205], v[48:49] op_sel:[0,0,0] op_sel_hi:[0,1,1]
    v_pk_mul_f32 v[50:51], v[242:243], v[190:191] op_sel:[1,0] op_sel_hi:[1,1]
    v_pk_mul_f32 v[190:191], v[242:243], v[190:191] op_sel:[0,0] op_sel_hi:[0,1]
    v_pk_fma_f32 v[190:191], v[242:243], v[206:207], v[190:191] op_sel:[1,0,0] op_sel_hi:[1,1,1] neg_lo:[1,0,0] neg_hi:[1,0,0]
    v_pk_fma_f32 v[206:207], v[242:243], v[206:207], v[50:51] op_sel:[0,0,0] op_sel_hi:[0,1,1]
    s_add_u32 s40, s84, 0
    s_lshl_b32 s40, s40, 13
    s_add_u32 s40, s40, 15728640
    s_add_u32 s44, s38, s40
    s_addc_u32 s45, s39, 0
    s_mov_b32 s46, 8192
    s_mov_b32 s47, 0x20000
    buffer_load_dwordx4 v[52:55], v40, s[44:47], 0 offen sc1
    v_subrev_u32 v48, 1024, v40
    buffer_load_dwordx4 v[56:59], v48, s[44:47], 0 offen sc1
    s_cmp_lg_u32 s86, 0
    s_cbranch_scc1 L_w0_11
    s_waitcnt vmcnt(10)
    s_mov_b32 s65, 0
L_sp_12:
    v_cmp_ne_u32 vcc, s80, v46
    s_nop 0
    s_cmp_eq_u32 vcc_lo, 0
    s_cbranch_scc1 L_sp_13
    s_add_u32 s65, s65, 1
    s_cmp_gt_u32 s65, 100000
    s_cbranch_scc1 L_sp_13
    s_mov_b32 s40, 0
    s_mov_b32 exec_hi, 0
    buffer_load_dword v46, v43, s[56:59], s40 offen sc1
    s_mov_b32 exec_hi, -1
    s_waitcnt vmcnt(0)
    s_branch L_sp_12
L_sp_13:
L_w0_11:
    s_barrier
    s_bfe_u32 s60, 0x20100, s89
    s_lshl_b32 s60, s60, 14
    buffer_load_dwordx4 a[160:163], v44, s[48:51], s60 offen offset:0 sc1
    buffer_load_dwordx4 a[164:167], v44, s[48:51], s60 offen offset:1024 sc1
    buffer_load_dwordx4 a[168:171], v44, s[48:51], s60 offen offset:2048 sc1
    buffer_load_dwordx4 a[172:175], v44, s[48:51], s60 offen offset:3072 sc1
    s_bfe_u32 s60, 0x3000001, s89
    s_lshl_b32 s60, s60, 14
    buffer_load_dwordx4 a[176:179], v44, s[48:51], s60 offen offset:0 sc1
    buffer_load_dwordx4 a[180:183], v44, s[48:51], s60 offen offset:1024 sc1
    buffer_load_dwordx4 a[184:187], v44, s[48:51], s60 offen offset:2048 sc1
    buffer_load_dwordx4 a[188:191], v44, s[48:51], s60 offen offset:3072 sc1
    s_add_u32 m0, s43, 135168
    s_add_u32 s23, s23, 20480
    buffer_load_dwordx4 v4, s[92:95], s23 offen offset:0 lds
    buffer_load_dwordx4 v5, s[92:95], s23 offen offset:1024 lds
    s_add_u32 m0, s43, 137216
    s_add_u32 s23, s23, 20480
    buffer_load_dwordx4 v4, s[92:95], s23 offen offset:0 lds
    buffer_load_dwordx4 v5, s[92:95], s23 offen offset:1024 lds
    s_waitcnt lgkmcnt(14)
    s_add_u32 m0, s43, 0
    s_add_u32 s23, s23, 20480
    buffer_load_dwordx4 v4, s[92:95], s23 offen offset:0 lds
    buffer_load_dwordx4 v5, s[92:95], s23 offen offset:1024 lds
    v_add_u32 v10, s43, v33
    v_add_u32 v11, 0x10000, v10
    s_waitcnt vmcnt(14)
    s_mov_b32 s65, 0
L_sp_14:
    v_xor_b32 v53, v53, v84
    v_xor_b32 v55, v55, v84
    v_xor_b32 v57, v57, v85
    v_xor_b32 v59, v59, v85
    v_or3_b32 v48, v53, v55, v57
    v_or_b32 v48, v48, v59
    v_cmp_ne_u32 vcc, 0, v48
    s_cbranch_vccz L_sp_15
    s_add_u32 s65, s65, 1
    s_cmp_gt_u32 s65, 100000
    s_cbranch_scc1 L_sp_15
    s_add_u32 s40, s84, 0
    s_lshl_b32 s40, s40, 13
    s_add_u32 s40, s40, 15728640
    s_add_u32 s44, s38, s40
    s_addc_u32 s45, s39, 0
    s_mov_b32 s46, 8192
    s_mov_b32 s47, 0x20000
    buffer_load_dwordx4 v[52:55], v40, s[44:47], 0 offen sc1
    v_subrev_u32 v48, 1024, v40
    buffer_load_dwordx4 v[56:59], v48, s[44:47], 0 offen sc1
    s_waitcnt vmcnt(0)
    s_branch L_sp_14
L_sp_15:
    v_mov_b32 v53, v54
    v_mov_b32 v57, v58
    v_pk_fma_f32 v[52:53], v[248:249], v[56:57], v[52:53] op_sel:[0,0,0] op_sel_hi:[0,1,1]
    v_pk_fma_f32 v[52:53], v[248:249], v[56:57], v[52:53] op_sel:[1,1,0] op_sel_hi:[1,0,1] neg_lo:[1,0,0]
    v_pk_mul_f32 v[48:49], v[250:251], v[52:53] op_sel:[0,0] op_sel_hi:[0,1]
    v_pk_fma_f32 v[48:49], v[250:251], v[52:53], v[48:49] op_sel:[1,1,0] op_sel_hi:[1,0,1] neg_lo:[1,0,0]
    v_cmp_ne_u32 vcc, 0, v84
    s_nop 1
    v_cndmask_b32 v48, 0, v48, vcc
    v_cndmask_b32 v49, 0, v49, vcc
    ds_write_b64 v34, v[48:49] offset:0
    s_waitcnt lgkmcnt(0)
    s_barrier
    ds_read_b64 v[60:61], v35 offset:0
    ds_read_b64 v[62:63], v35 offset:256
    ds_read_b64 v[64:65], v35 offset:512
    ds_read_b64 v[66:67], v35 offset:768
    ds_read_b64 v[68:69], v35 offset:1024
    ds_read_b64 v[70:71], v35 offset:1280
    ds_read_b64 v[72:73], v35 offset:1536
    ds_read_b64 v[74:75], v35 offset:1792
    s_waitcnt lgkmcnt(6)
    v_pk_add_f32 v[60:61], v[60:61], v[62:63]
    s_waitcnt lgkmcnt(4)
    v_pk_add_f32 v[64:65], v[64:65], v[66:67]
    s_waitcnt lgkmcnt(2)
    v_pk_add_f32 v[68:69], v[68:69], v[70:71]
    s_waitcnt lgkmcnt(0)
    v_pk_add_f32 v[72:73], v[72:73], v[74:75]
    v_pk_add_f32 v[60:61], v[60:61], v[64:65]
    v_pk_add_f32 v[68:69], v[68:69], v[72:73]
    v_pk_add_f32 v[48:49], v[60:61], v[68:69]
    v_pk_fma_f32 v[252:253], v[246:247], v[48:49], v[252:253] op_sel:[0,0,0] op_sel_hi:[0,1,1]
    v_pk_fma_f32 v[252:253], v[246:247], v[48:49], v[252:253] op_sel:[1,1,0] op_sel_hi:[1,0,1] neg_lo:[1,0,0]
    v_pk_fma_f32 v[176:177], v[208:209], v[252:253], v[176:177] op_sel:[0,0,0] op_sel_hi:[1,0,1]
    v_pk_fma_f32 v[192:193], v[208:209], v[252:253], v[192:193] op_sel:[0,1,0] op_sel_hi:[1,1,1]
    v_pk_fma_f32 v[176:177], v[224:225], v[252:253], v[176:177] op_sel:[0,1,0] op_sel_hi:[1,1,1] neg_lo:[1,0,0] neg_hi:[1,0,0]
    v_pk_fma_f32 v[192:193], v[224:225], v[252:253], v[192:193] op_sel:[0,0,0] op_sel_hi:[1,0,1]
    s_add_u32 m0, s43, 2048
    s_bfe_u32 s26, 0x2030502, s89
    s_mul_i32 s26, s26, 20480
    buffer_load_dwordx4 v41, s[8:11], s26 offen sc1 lds
    v_pk_fma_f32 v[178:179], v[210:211], v[252:253], v[178:179] op_sel:[0,0,0] op_sel_hi:[1,0,1]
    v_pk_fma_f32 v[194:195], v[210:211], v[252:253], v[194:195] op_sel:[0,1,0] op_sel_hi:[1,1,1]
    v_pk_fma_f32 v[178:179], v[226:227], v[252:253], v[178:179] op_sel:[0,1,0] op_sel_hi:[1,1,1] neg_lo:[1,0,0] neg_hi:[1,0,0]
    v_pk_fma_f32 v[194:195], v[226:227], v[252:253], v[194:195] op_sel:[0,0,0] op_sel_hi:[1,0,1]
    buffer_load_dwordx4 v41, s[8:11], s26 offen offset:1024 sc1 lds
    v_pk_fma_f32 v[180:181], v[212:213], v[252:253], v[180:181] op_sel:[0,0,0] op_sel_hi:[1,0,1]
    v_pk_fma_f32 v[196:197], v[212:213], v[252:253], v[196:197] op_sel:[0,1,0] op_sel_hi:[1,1,1]
    v_pk_fma_f32 v[180:181], v[228:229], v[252:253], v[180:181] op_sel:[0,1,0] op_sel_hi:[1,1,1] neg_lo:[1,0,0] neg_hi:[1,0,0]
    v_pk_fma_f32 v[196:197], v[228:229], v[252:253], v[196:197] op_sel:[0,0,0] op_sel_hi:[1,0,1]
    buffer_load_dwordx4 v41, s[8:11], s26 offen offset:2048 sc1 lds
    v_pk_fma_f32 v[182:183], v[214:215], v[252:253], v[182:183] op_sel:[0,0,0] op_sel_hi:[1,0,1]
    v_pk_fma_f32 v[198:199], v[214:215], v[252:253], v[198:199] op_sel:[0,1,0] op_sel_hi:[1,1,1]
    v_pk_fma_f32 v[182:183], v[230:231], v[252:253], v[182:183] op_sel:[0,1,0] op_sel_hi:[1,1,1] neg_lo:[1,0,0] neg_hi:[1,0,0]
    v_pk_fma_f32 v[198:199], v[230:231], v[252:253], v[198:199] op_sel:[0,0,0] op_sel_hi:[1,0,1]
    buffer_load_dwordx4 v41, s[8:11], s26 offen offset:3072 sc1 lds
    v_pk_fma_f32 v[184:185], v[216:217], v[252:253], v[184:185] op_sel:[0,0,0] op_sel_hi:[1,0,1]
    v_pk_fma_f32 v[200:201], v[216:217], v[252:253], v[200:201] op_sel:[0,1,0] op_sel_hi:[1,1,1]
    v_pk_fma_f32 v[184:185], v[232:233], v[252:253], v[184:185] op_sel:[0,1,0] op_sel_hi:[1,1,1] neg_lo:[1,0,0] neg_hi:[1,0,0]
    v_pk_fma_f32 v[200:201], v[232:233], v[252:253], v[200:201] op_sel:[0,0,0] op_sel_hi:[1,0,1]
    s_add_u32 m0, s43, 6144
    s_nop 0
    buffer_load_dwordx4 v42, s[8:11], s26 offen sc1 lds
    v_pk_fma_f32 v[186:187], v[218:219], v[252:253], v[186:187] op_sel:[0,0,0] op_sel_hi:[1,0,1]
    v_pk_fma_f32 v[202:203], v[218:219], v[252:253], v[202:203] op_sel:[0,1,0] op_sel_hi:[1,1,1]
    v_pk_fma_f32 v[186:187], v[234:235], v[252:253], v[186:187] op_sel:[0,1,0] op_sel_hi:[1,1,1] neg_lo:[1,0,0] neg_hi:[1,0,0]
    v_pk_fma_f32 v[202:203], v[234:235], v[252:253], v[202:203] op_sel:[0,0,0] op_sel_hi:[1,0,1]
    s_add_u32 m0, s43, 32768
    s_bfe_u32 s26, 0x4060303, s89
    s_mul_i32 s26, s26, 20480
    buffer_load_dwordx4 v41, s[8:11], s26 offen sc1 lds
    v_pk_fma_f32 v[188:189], v[220:221], v[252:253], v[188:189] op_sel:[0,0,0] op_sel_hi:[1,0,1]
    v_pk_fma_f32 v[204:205], v[220:221], v[252:253], v[204:205] op_sel:[0,1,0] op_sel_hi:[1,1,1]
    v_pk_fma_f32 v[188:189], v[236:237], v[252:253], v[188:189] op_sel:[0,1,0] op_sel_hi:[1,1,1] neg_lo:[1,0,0] neg_hi:[1,0,0]
    v_pk_fma_f32 v[204:205], v[236:237], v[252:253], v[204:205] op_sel:[0,0,0] op_sel_hi:[1,0,1]
    buffer_load_dwordx4 v41, s[8:11], s26 offen offset:1024 sc1 lds
    v_pk_fma_f32 v[190:191], v[222:223], v[252:253], v[190:191] op_sel:[0,0,0] op_sel_hi:[1,0,1]
    v_pk_fma_f32 v[206:207], v[222:223], v[252:253], v[206:207] op_sel:[0,1,0] op_sel_hi:[1,1,1]
    v_pk_fma_f32 v[190:191], v[238:239], v[252:253], v[190:191] op_sel:[0,1,0] op_sel_hi:[1,1,1] neg_lo:[1,0,0] neg_hi:[1,0,0]
    v_pk_fma_f32 v[206:207], v[238:239], v[252:253], v[206:207] op_sel:[0,0,0] op_sel_hi:[1,0,1]
    buffer_load_dwordx4 v41, s[8:11], s26 offen offset:2048 sc1 lds
    v_cvt_pk_bf16_f32 v176, v176, v177
    v_cvt_pk_bf16_f32 v177, v178, v179
    v_cvt_pk_bf16_f32 v178, v180, v181
    v_cvt_pk_bf16_f32 v179, v182, v183
    buffer_load_dwordx4 v41, s[8:11], s26 offen offset:3072 sc1 lds
    ds_write_b128 v36, v[176:179]
    v_cvt_pk_bf16_f32 v184, v184, v185
    v_cvt_pk_bf16_f32 v185, v186, v187
    v_cvt_pk_bf16_f32 v186, v188, v189
    s_add_u32 m0, s43, 36864
    s_nop 0
    buffer_load_dwordx4 v42, s[8:11], s26 offen sc1 lds
    v_cvt_pk_bf16_f32 v187, v190, v191
    ds_write_b128 v37, v[184:187]
    ds_read_b64_tr_b16 v[180:181], v38 offset:0
    ds_read_b64_tr_b16 v[182:183], v39 offset:0
    s_add_u32 m0, s43, 65536
    s_bfe_u32 s26, 0x7040405, s89
    s_mul_i32 s26, s26, 20480
    buffer_load_dwordx4 v41, s[8:11], s26 offen sc1 lds
    ds_read_b64_tr_b16 v[188:189], v38 offset:1024
    ds_read_b64_tr_b16 v[190:191], v39 offset:1024
    v_cvt_pk_bf16_f32 v192, -v192, -v193
    v_cvt_pk_bf16_f32 v193, -v194, -v195
    buffer_load_dwordx4 v41, s[8:11], s26 offen offset:1024 sc1 lds
    v_cvt_pk_bf16_f32 v194, -v196, -v197
    v_cvt_pk_bf16_f32 v195, -v198, -v199
    ds_write_b128 v36, v[192:195]
    v_cvt_pk_bf16_f32 v200, -v200, -v201
    buffer_load_dwordx4 v41, s[8:11], s26 offen offset:2048 sc1 lds
    v_cvt_pk_bf16_f32 v201, -v202, -v203
    v_cvt_pk_bf16_f32 v202, -v204, -v205
    v_cvt_pk_bf16_f32 v203, -v206, -v207
    ds_write_b128 v37, v[200:203]
    buffer_load_dwordx4 v41, s[8:11], s26 offen offset:3072 sc1 lds
    ds_read_b64_tr_b16 v[196:197], v38 offset:0
    ds_read_b64_tr_b16 v[198:199], v39 offset:0
    ds_read_b64_tr_b16 v[204:205], v38 offset:1024
    ds_read_b64_tr_b16 v[206:207], v39 offset:1024
    s_add_u32 m0, s43, 37888
    s_nop 0
    buffer_load_dwordx4 v42, s[8:11], s26 offen sc1 lds
    s_add_u32 s41, s84, 0
    s_lshr_b32 s40, s41, 2
    s_lshl_b32 s40, s40, 1
    s_and_b32 s65, s41, 1
    s_add_u32 s40, s40, s65
    s_lshl_b32 s40, s40, 1
    s_bfe_u32 s65, s41, 0x10001
    s_add_u32 s40, s40, s65
    s_lshl_b32 s40, s40, 13
    s_add_u32 s40, s40, s64
    s_add_u32 s40, s40, 196608
    s_waitcnt lgkmcnt(6)
    buffer_store_dwordx4 v[180:183], v33, s[56:59], s40 offen offset:0 sc1
    buffer_store_dwordx4 v[188:191], v33, s[56:59], s40 offen offset:1024 sc1
    s_add_u32 s41, s84, 0
    s_lshr_b32 s40, s41, 2
    s_lshl_b32 s40, s40, 1
    s_and_b32 s65, s41, 1
    s_add_u32 s40, s40, s65
    s_lshl_b32 s40, s40, 1
    s_bfe_u32 s65, s41, 0x10001
    s_add_u32 s40, s40, s65
    s_lshl_b32 s40, s40, 13
    s_add_u32 s40, s40, s64
    s_add_u32 s40, s40, 200704
    s_waitcnt lgkmcnt(0)
    buffer_store_dwordx4 v[196:199], v33, s[56:59], s40 offen offset:0 sc1
    buffer_store_dwordx4 v[204:207], v33, s[56:59], s40 offen offset:1024 sc1
    s_mov_b32 s66, 88064
    s_waitcnt vmcnt(29)
    v_mfma_f32_16x16x32_bf16 v[96:99], a[208:211], a[160:163], 0
    s_bfe_u32 s60, 0x1010204, s89
    s_lshl_b32 s60, s60, 14
    buffer_load_dwordx4 a[192:195], v44, s[48:51], s60 offen offset:0 sc1
    v_mfma_f32_16x16x32_bf16 v[116:119], a[208:211], a[164:167], 0
    v_mfma_f32_16x16x32_bf16 v[136:139], a[208:211], a[168:171], 0
    buffer_load_dwordx4 a[196:199], v44, s[48:51], s60 offen offset:1024 sc1
    v_mfma_f32_16x16x32_bf16 v[156:159], a[208:211], a[172:175], 0
    v_mfma_f32_16x16x32_bf16 v[100:103], a[212:215], a[160:163], 0
    buffer_load_dwordx4 a[200:203], v44, s[48:51], s60 offen offset:2048 sc1
    v_mfma_f32_16x16x32_bf16 v[120:123], a[212:215], a[164:167], 0
    v_mfma_f32_16x16x32_bf16 v[140:143], a[212:215], a[168:171], 0
    buffer_load_dwordx4 a[204:207], v44, s[48:51], s60 offen offset:3072 sc1
    v_mfma_f32_16x16x32_bf16 v[160:163], a[212:215], a[172:175], 0
    v_mfma_f32_16x16x32_bf16 v[104:107], a[216:219], a[160:163], 0
    v_mfma_f32_16x16x32_bf16 v[124:127], a[216:219], a[164:167], 0
    v_mfma_f32_16x16x32_bf16 v[144:147], a[216:219], a[168:171], 0
    v_mfma_f32_16x16x32_bf16 v[164:167], a[216:219], a[172:175], 0
    v_mfma_f32_16x16x32_bf16 v[108:111], a[220:223], a[160:163], 0
    v_mfma_f32_16x16x32_bf16 v[128:131], a[220:223], a[164:167], 0
    v_mfma_f32_16x16x32_bf16 v[148:151], a[220:223], a[168:171], 0
    v_mfma_f32_16x16x32_bf16 v[168:171], a[220:223], a[172:175], 0
    v_mfma_f32_16x16x32_bf16 v[112:115], a[224:227], a[160:163], 0
    v_mfma_f32_16x16x32_bf16 v[132:135], a[224:227], a[164:167], 0
    v_mfma_f32_16x16x32_bf16 v[152:155], a[224:227], a[168:171], 0
    v_mfma_f32_16x16x32_bf16 v[172:175], a[224:227], a[172:175], 0
    s_waitcnt vmcnt(29)
    v_mfma_f32_16x16x32_bf16 v[96:99], a[228:231], a[176:179], v[96:99]
    s_bfe_u32 s60, 0x2030502, s89
    s_lshl_b32 s60, s60, 14
    buffer_load_dwordx4 a[160:163], v44, s[48:51], s60 offen offset:0 sc1
    s_waitcnt vmcnt(19)
    ds_read_b128 a[208:211], v10 offset:2048
    ds_read_b128 a[212:215], v10 offset:3072
    v_mfma_f32_16x16x32_bf16 v[116:119], a[228:231], a[180:183], v[116:119]
    ds_read_b128 a[216:219], v10 offset:4096
    ds_read_b128 a[220:223], v10 offset:5120
    ds_read_b128 a[224:227], v10 offset:6144
    v_mfma_f32_16x16x32_bf16 v[136:139], a[228:231], a[184:187], v[136:139]
    buffer_load_dwordx4 a[164:167], v44, s[48:51], s60 offen offset:1024 sc1
    s_mul_i32 s40, s88, 160
    s_mul_i32 s41, s87, 81920
    s_add_u32 s41, s41, s40
    s_add_u32 s44, s4, s41
    s_addc_u32 s45, s5, 0
    s_mov_b32 s46, 80800
    s_mov_b32 s47, 0x20000
    s_lshl_b32 s41, s41, 1
    s_add_u32 s16, s34, s41
    s_addc_u32 s17, s35, 0
    s_mov_b32 s18, 161600
    s_mov_b32 s19, 0x20000
    s_lshl_b32 s41, s87, 9
    s_add_u32 s41, s41, 15990784
    s_cmp_eq_u32 s86, 1
    s_cselect_b32 s65, 256, 0
    s_add_u32 s41, s41, s65
    s_cmp_eq_u32 s86, 2
    s_cselect_b32 s52, s20, s30
    s_cselect_b32 s53, s21, s31
    s_cmp_lt_u32 s86, 2
    s_cselect_b32 s52, s38, s52
    s_cselect_b32 s53, s39, s53
    s_cselect_b32 s40, s41, s40
    s_mov_b32 s65, 160
    s_cselect_b32 s54, 256, s65
    s_add_u32 s52, s52, s40
    s_addc_u32 s53, s53, 0
    s_mov_b32 s55, 0x20000
    v_add_u32 v84, 0, v0
    v_mul_u32_u24 v85, 0xcccd, v84
    v_mfma_f32_16x16x32_bf16 v[156:159], a[228:231], a[188:191], v[156:159]
    v_lshrrev_b32 v85, 20, v85
    v_mul_u32_u24 v86, 20, v85
    v_sub_u32 v86, v84, v86
    v_mfma_f32_16x16x32_bf16 v[100:103], a[232:235], a[176:179], v[100:103]
    buffer_load_dwordx4 a[168:171], v44, s[48:51], s60 offen offset:2048 sc1
    v_mul_u32_u24 v87, 1280, v85
    v_lshl_add_u32 v87, v86, 3, v87
    buffer_load_dwordx2 v[52:53], v87, s[44:47], 0 offen
    v_mfma_f32_16x16x32_bf16 v[120:123], a[232:235], a[180:183], v[120:123]
    v_lshlrev_b32 v67, 1, v87
    v_bfe_u32 v87, v85, 1, 2
    v_xor_b32 v87, v87, v86
    v_mfma_f32_16x16x32_bf16 v[140:143], a[232:235], a[184:187], v[140:143]
    buffer_load_dwordx4 a[172:175], v44, s[48:51], s60 offen offset:3072 sc1
    v_mul_u32_u24 v62, 320, v85
    v_add_u32 v62, 0, v62
    v_lshl_add_u32 v62, v87, 4, v62
    v_mfma_f32_16x16x32_bf16 v[160:163], a[232:235], a[188:191], v[160:163]
    v_lshl_add_u32 v72, v86, 3, s66
    v_lshl_add_u32 v73, v85, 3, s66
    v_add_u32 v84, 256, v0
    v_mfma_f32_16x16x32_bf16 v[104:107], a[236:239], a[176:179], v[104:107]
    v_mul_u32_u24 v85, 0xcccd, v84
    v_lshrrev_b32 v85, 20, v85
    v_mul_u32_u24 v86, 20, v85
    v_mfma_f32_16x16x32_bf16 v[124:127], a[236:239], a[180:183], v[124:127]
    v_sub_u32 v86, v84, v86
    v_mul_u32_u24 v87, 1280, v85
    v_lshl_add_u32 v87, v86, 3, v87
    v_mfma_f32_16x16x32_bf16 v[144:147], a[236:239], a[184:187], v[144:147]
    buffer_load_dwordx2 v[54:55], v87, s[44:47], 0 offen
    v_lshlrev_b32 v68, 1, v87
    v_bfe_u32 v87, v85, 1, 2
    v_mfma_f32_16x16x32_bf16 v[164:167], a[236:239], a[188:191], v[164:167]
    v_xor_b32 v87, v87, v86
    v_mul_u32_u24 v63, 320, v85
    v_add_u32 v63, 0, v63
    v_mfma_f32_16x16x32_bf16 v[108:111], a[240:243], a[176:179], v[108:111]
    v_lshl_add_u32 v63, v87, 4, v63
    v_lshl_add_u32 v74, v86, 3, s66
    v_lshl_add_u32 v75, v85, 3, s66
    v_mfma_f32_16x16x32_bf16 v[128:131], a[240:243], a[180:183], v[128:131]
    v_add_u32 v84, 512, v0
    v_mul_u32_u24 v85, 0xcccd, v84
    v_lshrrev_b32 v85, 20, v85
    v_mfma_f32_16x16x32_bf16 v[148:151], a[240:243], a[184:187], v[148:151]
    v_mul_u32_u24 v86, 20, v85
    v_sub_u32 v86, v84, v86
    v_mul_u32_u24 v87, 1280, v85
    v_mfma_f32_16x16x32_bf16 v[168:171], a[240:243], a[188:191], v[168:171]
    v_lshl_add_u32 v87, v86, 3, v87
    buffer_load_dwordx2 v[56:57], v87, s[44:47], 0 offen
    v_lshlrev_b32 v69, 1, v87
    v_mfma_f32_16x16x32_bf16 v[112:115], a[244:247], a[176:179], v[112:115]
    v_bfe_u32 v87, v85, 1, 2
    v_xor_b32 v87, v87, v86
    v_mul_u32_u24 v64, 320, v85
    v_mfma_f32_16x16x32_bf16 v[132:135], a[244:247], a[180:183], v[132:135]
    v_add_u32 v64, 0, v64
    v_lshl_add_u32 v64, v87, 4, v64
    v_lshl_add_u32 v76, v86, 3, s66
    v_mfma_f32_16x16x32_bf16 v[152:155], a[244:247], a[184:187], v[152:155]
    v_lshl_add_u32 v77, v85, 3, s66
    v_add_u32 v84, 768, v0
    v_mul_u32_u24 v85, 0xcccd, v84
    v_mfma_f32_16x16x32_bf16 v[172:175], a[244:247], a[188:191], v[172:175]
    v_lshrrev_b32 v85, 20, v85
    v_mul_u32_u24 v86, 20, v85
    v_sub_u32 v86, v84, v86
    s_waitcnt vmcnt(7)
    v_mfma_f32_16x16x32_bf16 v[96:99], v[12:15], a[192:195], v[96:99]
    s_add_u32 s65, s90, 131072
    s_mov_b64 exec, 1
    buffer_store_dword v47, v45, s[56:59], s65 offen sc1
    s_mov_b64 exec, -1
    s_bfe_u32 s60, 0x4060303, s89
    s_lshl_b32 s60, s60, 14
    buffer_load_dwordx4 a[176:179], v44, s[48:51], s60 offen offset:0 sc1
    ds_read_b128 a[228:231], v10 offset:32768
    ds_read_b128 a[232:235], v10 offset:33792
    v_mfma_f32_16x16x32_bf16 v[116:119], v[12:15], a[196:199], v[116:119]
    ds_read_b128 a[236:239], v10 offset:34816
    ds_read_b128 a[240:243], v10 offset:35840
    ds_read_b128 a[244:247], v10 offset:36864
    v_mfma_f32_16x16x32_bf16 v[136:139], v[12:15], a[200:203], v[136:139]
    buffer_load_dwordx4 a[180:183], v44, s[48:51], s60 offen offset:1024 sc1
    v_mul_u32_u24 v87, 1280, v85
    v_lshl_add_u32 v87, v86, 3, v87
    buffer_load_dwordx2 v[58:59], v87, s[44:47], 0 offen
    v_mfma_f32_16x16x32_bf16 v[156:159], v[12:15], a[204:207], v[156:159]
    v_lshlrev_b32 v70, 1, v87
    v_bfe_u32 v87, v85, 1, 2
    v_xor_b32 v87, v87, v86
    v_mfma_f32_16x16x32_bf16 v[100:103], v[16:19], a[192:195], v[100:103]
    buffer_load_dwordx4 a[184:187], v44, s[48:51], s60 offen offset:2048 sc1
    v_mul_u32_u24 v65, 320, v85
    v_add_u32 v65, 0, v65
    v_lshl_add_u32 v65, v87, 4, v65
    v_mfma_f32_16x16x32_bf16 v[120:123], v[16:19], a[196:199], v[120:123]
    v_lshl_add_u32 v78, v86, 3, s66
    v_lshl_add_u32 v79, v85, 3, s66
    v_add_u32 v84, 1024, v0
    v_mfma_f32_16x16x32_bf16 v[140:143], v[16:19], a[200:203], v[140:143]
    buffer_load_dwordx4 a[188:191], v44, s[48:51], s60 offen offset:3072 sc1
    v_mul_u32_u24 v85, 0xcccd, v84
    v_lshrrev_b32 v85, 20, v85
    v_mul_u32_u24 v86, 20, v85
    v_mfma_f32_16x16x32_bf16 v[160:163], v[16:19], a[204:207], v[160:163]
    v_sub_u32 v86, v84, v86
    v_mul_u32_u24 v87, 1280, v85
    v_lshl_add_u32 v87, v86, 3, v87
    v_mfma_f32_16x16x32_bf16 v[104:107], v[20:23], a[192:195], v[104:107]
    buffer_load_dwordx2 v[60:61], v87, s[44:47], 0 offen
    v_lshlrev_b32 v71, 1, v87
    v_bfe_u32 v87, v85, 1, 2
    v_mfma_f32_16x16x32_bf16 v[124:127], v[20:23], a[196:199], v[124:127]
    v_xor_b32 v87, v87, v86
    v_mul_u32_u24 v66, 320, v85
    v_add_u32 v66, 0, v66
    v_mfma_f32_16x16x32_bf16 v[144:147], v[20:23], a[200:203], v[144:147]
    v_lshl_add_u32 v66, v87, 4, v66
    v_lshl_add_u32 v80, v86, 3, s66
    v_lshl_add_u32 v81, v85, 3, s66
    v_mfma_f32_16x16x32_bf16 v[164:167], v[20:23], a[204:207], v[164:167]
    v_and_b32 v84, 15, v1
    v_mul_u32_u24 v82, 320, v84
    v_lshrrev_b32 v85, 4, v1
    v_mfma_f32_16x16x32_bf16 v[108:111], v[24:27], a[192:195], v[108:111]
    v_bfe_u32 v86, v84, 1, 2
    v_xor_b32 v85, v85, v86
    v_lshl_add_u32 v82, v85, 4, v82
    v_mfma_f32_16x16x32_bf16 v[128:131], v[24:27], a[196:199], v[128:131]
    v_mul_u32_u24 v85, 20480, v2
    v_add_u32 v82, v82, v85
    v_add_u32 v82, 0, v82
    v_mfma_f32_16x16x32_bf16 v[148:151], v[24:27], a[200:203], v[148:151]
    v_lshl_add_u32 v83, v84, 3, s66
    v_lshlrev_b32 v48, 2, v1
    s_lshl_b32 s40, s86, 8
    s_add_u32 m0, s40, 88064
    s_nop 0
    buffer_load_dword v48, s[52:55], 0 offen sc1 lds
    v_mfma_f32_16x16x32_bf16 v[168:171], v[24:27], a[204:207], v[168:171]
    v_mfma_f32_16x16x32_bf16 v[112:115], v[28:31], a[192:195], v[112:115]
    v_mfma_f32_16x16x32_bf16 v[132:135], v[28:31], a[196:199], v[132:135]
    v_mfma_f32_16x16x32_bf16 v[152:155], v[28:31], a[200:203], v[152:155]
    v_mfma_f32_16x16x32_bf16 v[172:175], v[28:31], a[204:207], v[172:175]
    s_waitcnt vmcnt(10)
    s_waitcnt lgkmcnt(5)
    v_mfma_f32_16x16x32_bf16 v[96:99], a[208:211], a[160:163], v[96:99]
    s_bfe_u32 s60, 0x7040405, s89
    s_lshl_b32 s60, s60, 14
    buffer_load_dwordx4 a[192:195], v44, s[48:51], s60 offen offset:0 sc1
    ds_read_b128 v[12:15], v11 offset:0
    ds_read_b128 v[16:19], v11 offset:1024
    v_mfma_f32_16x16x32_bf16 v[116:119], a[208:211], a[164:167], v[116:119]
    ds_read_b128 v[20:23], v11 offset:2048
    ds_read_b128 v[24:27], v11 offset:3072
    ds_read_b128 v[28:31], v10 offset:37888
    v_mfma_f32_16x16x32_bf16 v[136:139], a[208:211], a[168:171], v[136:139]
    buffer_load_dwordx4 a[196:199], v44, s[48:51], s60 offen offset:1024 sc1
    v_mfma_f32_16x16x32_bf16 v[156:159], a[208:211], a[172:175], v[156:159]
    v_mfma_f32_16x16x32_bf16 v[100:103], a[212:215], a[160:163], v[100:103]
    buffer_load_dwordx4 a[200:203], v44, s[48:51], s60 offen offset:2048 sc1
    v_mfma_f32_16x16x32_bf16 v[120:123], a[212:215], a[164:167], v[120:123]
    v_mfma_f32_16x16x32_bf16 v[140:143], a[212:215], a[168:171], v[140:143]
    buffer_load_dwordx4 a[204:207], v44, s[48:51], s60 offen offset:3072 sc1
    v_mfma_f32_16x16x32_bf16 v[160:163], a[212:215], a[172:175], v[160:163]
    v_mfma_f32_16x16x32_bf16 v[104:107], a[216:219], a[160:163], v[104:107]
    v_mfma_f32_16x16x32_bf16 v[124:127], a[216:219], a[164:167], v[124:127]
    v_mfma_f32_16x16x32_bf16 v[144:147], a[216:219], a[168:171], v[144:147]
    v_mfma_f32_16x16x32_bf16 v[164:167], a[216:219], a[172:175], v[164:167]
    v_mfma_f32_16x16x32_bf16 v[108:111], a[220:223], a[160:163], v[108:111]
    v_mfma_f32_16x16x32_bf16 v[128:131], a[220:223], a[164:167], v[128:131]
    v_mfma_f32_16x16x32_bf16 v[148:151], a[220:223], a[168:171], v[148:151]
    v_mfma_f32_16x16x32_bf16 v[168:171], a[220:223], a[172:175], v[168:171]
    v_mfma_f32_16x16x32_bf16 v[112:115], a[224:227], a[160:163], v[112:115]
    v_mfma_f32_16x16x32_bf16 v[132:135], a[224:227], a[164:167], v[132:135]
    v_mfma_f32_16x16x32_bf16 v[152:155], a[224:227], a[168:171], v[152:155]
    v_mfma_f32_16x16x32_bf16 v[172:175], a[224:227], a[172:175], v[172:175]
    s_waitcnt vmcnt(6)
    s_waitcnt lgkmcnt(5)
    v_mfma_f32_16x16x32_bf16 v[96:99], a[228:231], a[176:179], v[96:99]
    s_bfe_u32 s60, 0x5050608, s89
    s_lshl_b32 s60, s60, 14
    buffer_load_dwordx4 a[160:163], v44, s[48:51], s60 offen offset:0 sc1
    s_waitcnt vmcnt(5)
    s_barrier
    ds_read_b64 v[32:33], v83 offset:0
    ds_read_b64 v[34:35], v83 offset:128
    v_mfma_f32_16x16x32_bf16 v[116:119], a[228:231], a[180:183], v[116:119]
    ds_read_b64 v[36:37], v83 offset:256
    ds_read_b64 v[38:39], v83 offset:384
    ds_read_b64 v[84:85], v73
    v_mfma_f32_16x16x32_bf16 v[136:139], a[228:231], a[184:187], v[136:139]
    buffer_load_dwordx4 a[164:167], v44, s[48:51], s60 offen offset:1024 sc1
    ds_read_b64 v[86:87], v72 offset:512
    ds_read_b64 v[88:89], v72 offset:768
    v_lshlrev_b32 v90, 16, v52
    v_mfma_f32_16x16x32_bf16 v[156:159], a[228:231], a[188:191], v[156:159]
    v_and_b32 v91, 0xffff0000, v52
    v_lshlrev_b32 v92, 16, v53
    v_and_b32 v93, 0xffff0000, v53
    v_mfma_f32_16x16x32_bf16 v[100:103], a[232:235], a[176:179], v[100:103]
    buffer_load_dwordx4 a[168:171], v44, s[48:51], s60 offen offset:2048 sc1
    s_waitcnt lgkmcnt(0)
    v_lshlrev_b32 v48, 16, v86
    v_and_b32 v49, 0xffff0000, v86
    v_mfma_f32_16x16x32_bf16 v[120:123], a[232:235], a[180:183], v[120:123]
    v_lshlrev_b32 v50, 16, v88
    v_and_b32 v51, 0xffff0000, v88
    v_mul_f32 v48, v48, v90
    v_mfma_f32_16x16x32_bf16 v[140:143], a[232:235], a[184:187], v[140:143]
    buffer_load_dwordx4 a[172:175], v44, s[48:51], s60 offen offset:3072 sc1
    v_mul_f32 v52, v85, v50
    v_fmac_f32 v52, v84, v48
    v_mul_f32 v49, v49, v91
    v_mfma_f32_16x16x32_bf16 v[160:163], a[232:235], a[188:191], v[160:163]
    v_mul_f32 v53, v85, v51
    v_fmac_f32 v53, v84, v49
    v_lshlrev_b32 v48, 16, v87
    v_mfma_f32_16x16x32_bf16 v[104:107], a[236:239], a[176:179], v[104:107]
    s_bfe_u32 s61, 0x5050608, s89
    s_mul_i32 s61, s61, 20480
    buffer_load_dwordx4 a[208:211], v41, s[8:11], s61 offen offset:0 sc1
    v_and_b32 v49, 0xffff0000, v87
    v_lshlrev_b32 v50, 16, v89
    v_and_b32 v51, 0xffff0000, v89
    v_mfma_f32_16x16x32_bf16 v[124:127], a[236:239], a[180:183], v[124:127]
    v_mul_f32 v48, v48, v92
    v_mul_f32 v72, v85, v50
    v_fmac_f32 v72, v84, v48
    v_mfma_f32_16x16x32_bf16 v[144:147], a[236:239], a[184:187], v[144:147]
    buffer_load_dwordx4 a[212:215], v41, s[8:11], s61 offen offset:1024 sc1
    v_mul_f32 v49, v49, v93
    v_mul_f32 v73, v85, v51
    v_fmac_f32 v73, v84, v49
    v_mfma_f32_16x16x32_bf16 v[164:167], a[236:239], a[188:191], v[164:167]
    ds_read_b64 v[84:85], v75
    ds_read_b64 v[86:87], v74 offset:512
    ds_read_b64 v[88:89], v74 offset:768
    v_mfma_f32_16x16x32_bf16 v[108:111], a[240:243], a[176:179], v[108:111]
    buffer_load_dwordx4 a[216:219], v41, s[8:11], s61 offen offset:2048 sc1
    v_lshlrev_b32 v90, 16, v54
    v_and_b32 v91, 0xffff0000, v54
    v_lshlrev_b32 v92, 16, v55
    v_mfma_f32_16x16x32_bf16 v[128:131], a[240:243], a[180:183], v[128:131]
    v_and_b32 v93, 0xffff0000, v55
    s_waitcnt lgkmcnt(0)
    v_lshlrev_b32 v48, 16, v86
    v_mfma_f32_16x16x32_bf16 v[148:151], a[240:243], a[184:187], v[148:151]
    buffer_load_dwordx4 a[220:223], v41, s[8:11], s61 offen offset:3072 sc1
    v_and_b32 v49, 0xffff0000, v86
    v_lshlrev_b32 v50, 16, v88
    v_and_b32 v51, 0xffff0000, v88
    v_mfma_f32_16x16x32_bf16 v[168:171], a[240:243], a[188:191], v[168:171]
    v_mul_f32 v48, v48, v90
    v_mul_f32 v54, v85, v50
    v_fmac_f32 v54, v84, v48
    v_mfma_f32_16x16x32_bf16 v[112:115], a[244:247], a[176:179], v[112:115]
    buffer_load_dwordx4 a[224:227], v42, s[8:11], s61 offen sc1
    v_mul_f32 v49, v49, v91
    v_mul_f32 v55, v85, v51
    v_fmac_f32 v55, v84, v49
    v_mfma_f32_16x16x32_bf16 v[132:135], a[244:247], a[180:183], v[132:135]
    v_lshlrev_b32 v48, 16, v87
    v_and_b32 v49, 0xffff0000, v87
    v_lshlrev_b32 v50, 16, v89
    v_mfma_f32_16x16x32_bf16 v[152:155], a[244:247], a[184:187], v[152:155]
    v_and_b32 v51, 0xffff0000, v89
    v_mul_f32 v48, v48, v92
    v_mul_f32 v74, v85, v50
    v_mfma_f32_16x16x32_bf16 v[172:175], a[244:247], a[188:191], v[172:175]
    v_fmac_f32 v74, v84, v48
    v_mul_f32 v49, v49, v93
    v_mul_f32 v75, v85, v51
    s_waitcnt vmcnt(9)
    v_mfma_f32_16x16x32_bf16 v[96:99], v[12:15], a[192:195], v[96:99]
    s_bfe_u32 s60, 0x6070906, s89
    s_lshl_b32 s60, s60, 14
    buffer_load_dwordx4 a[176:179], v44, s[48:51], s60 offen offset:0 sc1
    v_fmac_f32 v75, v84, v49
    ds_read_b64 v[84:85], v77
    ds_read_b64 v[86:87], v76 offset:512
    v_mfma_f32_16x16x32_bf16 v[116:119], v[12:15], a[196:199], v[116:119]
    ds_read_b64 v[88:89], v76 offset:768
    v_lshlrev_b32 v90, 16, v56
    v_and_b32 v91, 0xffff0000, v56
    v_mfma_f32_16x16x32_bf16 v[136:139], v[12:15], a[200:203], v[136:139]
    buffer_load_dwordx4 a[180:183], v44, s[48:51], s60 offen offset:1024 sc1
    v_lshlrev_b32 v92, 16, v57
    v_and_b32 v93, 0xffff0000, v57
    s_waitcnt lgkmcnt(0)
    v_mfma_f32_16x16x32_bf16 v[156:159], v[12:15], a[204:207], v[156:159]
    v_lshlrev_b32 v48, 16, v86
    v_and_b32 v49, 0xffff0000, v86
    v_lshlrev_b32 v50, 16, v88
    v_mfma_f32_16x16x32_bf16 v[100:103], v[16:19], a[192:195], v[100:103]
    buffer_load_dwordx4 a[184:187], v44, s[48:51], s60 offen offset:2048 sc1
    v_and_b32 v51, 0xffff0000, v88
    v_mul_f32 v48, v48, v90
    v_mul_f32 v56, v85, v50
    v_mfma_f32_16x16x32_bf16 v[120:123], v[16:19], a[196:199], v[120:123]
    v_fmac_f32 v56, v84, v48
    v_mul_f32 v49, v49, v91
    v_mul_f32 v57, v85, v51
    v_mfma_f32_16x16x32_bf16 v[140:143], v[16:19], a[200:203], v[140:143]
    buffer_load_dwordx4 a[188:191], v44, s[48:51], s60 offen offset:3072 sc1
    v_fmac_f32 v57, v84, v49
    v_lshlrev_b32 v48, 16, v87
    v_and_b32 v49, 0xffff0000, v87
    v_mfma_f32_16x16x32_bf16 v[160:163], v[16:19], a[204:207], v[160:163]
    v_lshlrev_b32 v50, 16, v89
    v_and_b32 v51, 0xffff0000, v89
    v_mul_f32 v48, v48, v92
    v_mfma_f32_16x16x32_bf16 v[104:107], v[20:23], a[192:195], v[104:107]
    s_bfe_u32 s61, 0x6070906, s89
    s_mul_i32 s61, s61, 20480
    buffer_load_dwordx4 a[228:231], v41, s[8:11], s61 offen offset:0 sc1
    v_mul_f32 v76, v85, v50
    v_fmac_f32 v76, v84, v48
    v_mul_f32 v49, v49, v93
    v_mfma_f32_16x16x32_bf16 v[124:127], v[20:23], a[196:199], v[124:127]
    v_mul_f32 v77, v85, v51
    v_fmac_f32 v77, v84, v49
    ds_read_b64 v[84:85], v79
    v_mfma_f32_16x16x32_bf16 v[144:147], v[20:23], a[200:203], v[144:147]
    buffer_load_dwordx4 a[232:235], v41, s[8:11], s61 offen offset:1024 sc1
    ds_read_b64 v[86:87], v78 offset:512
    ds_read_b64 v[88:89], v78 offset:768
    v_lshlrev_b32 v90, 16, v58
    v_mfma_f32_16x16x32_bf16 v[164:167], v[20:23], a[204:207], v[164:167]
    v_and_b32 v91, 0xffff0000, v58
    v_lshlrev_b32 v92, 16, v59
    v_and_b32 v93, 0xffff0000, v59
    v_mfma_f32_16x16x32_bf16 v[108:111], v[24:27], a[192:195], v[108:111]
    buffer_load_dwordx4 a[236:239], v41, s[8:11], s61 offen offset:2048 sc1
    s_waitcnt lgkmcnt(0)
    v_lshlrev_b32 v48, 16, v86
    v_and_b32 v49, 0xffff0000, v86
    v_mfma_f32_16x16x32_bf16 v[128:131], v[24:27], a[196:199], v[128:131]
    v_lshlrev_b32 v50, 16, v88
    v_and_b32 v51, 0xffff0000, v88
    v_mul_f32 v48, v48, v90
    v_mfma_f32_16x16x32_bf16 v[148:151], v[24:27], a[200:203], v[148:151]
    buffer_load_dwordx4 a[240:243], v41, s[8:11], s61 offen offset:3072 sc1
    v_mul_f32 v58, v85, v50
    v_fmac_f32 v58, v84, v48
    v_mul_f32 v49, v49, v91
    v_mfma_f32_16x16x32_bf16 v[168:171], v[24:27], a[204:207], v[168:171]
    v_mul_f32 v59, v85, v51
    v_fmac_f32 v59, v84, v49
    v_lshlrev_b32 v48, 16, v87
    v_mfma_f32_16x16x32_bf16 v[112:115], v[28:31], a[192:195], v[112:115]
    buffer_load_dwordx4 a[244:247], v42, s[8:11], s61 offen sc1
    v_and_b32 v49, 0xffff0000, v87
    v_lshlrev_b32 v50, 16, v89
    v_and_b32 v51, 0xffff0000, v89
    v_mfma_f32_16x16x32_bf16 v[132:135], v[28:31], a[196:199], v[132:135]
    v_mul_f32 v48, v48, v92
    v_mul_f32 v78, v85, v50
    v_fmac_f32 v78, v84, v48
    v_mfma_f32_16x16x32_bf16 v[152:155], v[28:31], a[200:203], v[152:155]
    v_mul_f32 v49, v49, v93
    v_mul_f32 v79, v85, v51
    v_fmac_f32 v79, v84, v49
    v_mfma_f32_16x16x32_bf16 v[172:175], v[28:31], a[204:207], v[172:175]
    ds_read_b64 v[84:85], v81
    ds_read_b64 v[86:87], v80 offset:512
    ds_read_b64 v[88:89], v80 offset:768
    s_waitcnt vmcnt(9)
    v_mfma_f32_16x16x32_bf16 v[96:99], a[208:211], a[160:163], v[96:99]
    s_bfe_u32 s60, 0x80a0707, s89
    s_lshl_b32 s60, s60, 14
    buffer_load_dwordx4 a[192:195], v44, s[48:51], s60 offen offset:0 sc1
    v_lshlrev_b32 v90, 16, v60
    v_and_b32 v91, 0xffff0000, v60
    v_lshlrev_b32 v92, 16, v61
    v_mfma_f32_16x16x32_bf16 v[116:119], a[208:211], a[164:167], v[116:119]
    v_and_b32 v93, 0xffff0000, v61
    s_waitcnt lgkmcnt(0)
    v_lshlrev_b32 v48, 16, v86
    v_mfma_f32_16x16x32_bf16 v[136:139], a[208:211], a[168:171], v[136:139]
    buffer_load_dwordx4 a[196:199], v44, s[48:51], s60 offen offset:1024 sc1
    v_and_b32 v49, 0xffff0000, v86
    v_lshlrev_b32 v50, 16, v88
    v_and_b32 v51, 0xffff0000, v88
    v_mfma_f32_16x16x32_bf16 v[156:159], a[208:211], a[172:175], v[156:159]
    v_mul_f32 v48, v48, v90
    v_mul_f32 v60, v85, v50
    v_fmac_f32 v60, v84, v48
    v_mfma_f32_16x16x32_bf16 v[100:103], a[212:215], a[160:163], v[100:103]
    buffer_load_dwordx4 a[200:203], v44, s[48:51], s60 offen offset:2048 sc1
    v_mul_f32 v49, v49, v91
    v_mul_f32 v61, v85, v51
    v_fmac_f32 v61, v84, v49
    v_mfma_f32_16x16x32_bf16 v[120:123], a[212:215], a[164:167], v[120:123]
    v_lshlrev_b32 v48, 16, v87
    v_and_b32 v49, 0xffff0000, v87
    v_lshlrev_b32 v50, 16, v89
    v_mfma_f32_16x16x32_bf16 v[140:143], a[212:215], a[168:171], v[140:143]
    buffer_load_dwordx4 a[204:207], v44, s[48:51], s60 offen offset:3072 sc1
    v_and_b32 v51, 0xffff0000, v89
    v_mul_f32 v48, v48, v92
    v_mul_f32 v80, v85, v50
    v_mfma_f32_16x16x32_bf16 v[160:163], a[212:215], a[172:175], v[160:163]
    v_fmac_f32 v80, v84, v48
    v_mul_f32 v49, v49, v93
    v_mul_f32 v81, v85, v51
    v_mfma_f32_16x16x32_bf16 v[104:107], a[216:219], a[160:163], v[104:107]
    s_bfe_u32 s61, 0x80a0707, s89
    s_mul_i32 s61, s61, 20480
    buffer_load_dwordx4 v[12:15], v41, s[8:11], s61 offen offset:0 sc1
    v_fmac_f32 v81, v84, v49
    v_add_f32 v32, v32, v32
    v_add_f32 v34, v34, v34
    v_mfma_f32_16x16x32_bf16 v[124:127], a[216:219], a[164:167], v[124:127]
    v_add_f32 v36, v36, v36
    v_add_f32 v38, v38, v38
    v_mfma_f32_16x16x32_bf16 v[144:147], a[216:219], a[168:171], v[144:147]
    buffer_load_dwordx4 v[16:19], v41, s[8:11], s61 offen offset:1024 sc1
    v_mfma_f32_16x16x32_bf16 v[164:167], a[216:219], a[172:175], v[164:167]
    v_mfma_f32_16x16x32_bf16 v[108:111], a[220:223], a[160:163], v[108:111]
    buffer_load_dwordx4 v[20:23], v41, s[8:11], s61 offen offset:2048 sc1
    v_mfma_f32_16x16x32_bf16 v[128:131], a[220:223], a[164:167], v[128:131]
    v_mfma_f32_16x16x32_bf16 v[148:151], a[220:223], a[168:171], v[148:151]
    buffer_load_dwordx4 v[24:27], v41, s[8:11], s61 offen offset:3072 sc1
    v_mfma_f32_16x16x32_bf16 v[168:171], a[220:223], a[172:175], v[168:171]
    v_mfma_f32_16x16x32_bf16 v[112:115], a[224:227], a[160:163], v[112:115]
    buffer_load_dwordx4 v[28:31], v42, s[8:11], s61 offen sc1
    v_mfma_f32_16x16x32_bf16 v[132:135], a[224:227], a[164:167], v[132:135]
    v_mfma_f32_16x16x32_bf16 v[152:155], a[224:227], a[168:171], v[152:155]
    v_mfma_f32_16x16x32_bf16 v[172:175], a[224:227], a[172:175], v[172:175]
    s_waitcnt vmcnt(9)
    v_mfma_f32_16x16x32_bf16 v[96:99], a[228:231], a[176:179], v[96:99]
    s_cmp_lg_u32 s86, 0
    s_cbranch_scc1 L_w0_16
    s_mov_b32 s40, 131072
    s_mov_b32 exec_hi, 0
    buffer_load_dword v46, v43, s[56:59], s40 offen sc1
    s_mov_b32 exec_hi, -1
L_w0_16:
    s_bfe_u32 s60, 0xb080809, s89
    s_lshl_b32 s60, s60, 14
    buffer_load_dwordx4 a[160:163], v44, s[48:51], s60 offen offset:0 sc1
    v_mfma_f32_16x16x32_bf16 v[116:119], a[228:231], a[180:183], v[116:119]
    v_mfma_f32_16x16x32_bf16 v[136:139], a[228:231], a[184:187], v[136:139]
    buffer_load_dwordx4 a[164:167], v44, s[48:51], s60 offen offset:1024 sc1
    v_mfma_f32_16x16x32_bf16 v[156:159], a[228:231], a[188:191], v[156:159]
    v_mfma_f32_16x16x32_bf16 v[100:103], a[232:235], a[176:179], v[100:103]
    buffer_load_dwordx4 a[168:171], v44, s[48:51], s60 offen offset:2048 sc1
    v_mfma_f32_16x16x32_bf16 v[120:123], a[232:235], a[180:183], v[120:123]
    v_mfma_f32_16x16x32_bf16 v[140:143], a[232:235], a[184:187], v[140:143]
    buffer_load_dwordx4 a[172:175], v44, s[48:51], s60 offen offset:3072 sc1
    v_mfma_f32_16x16x32_bf16 v[160:163], a[232:235], a[188:191], v[160:163]
    v_mfma_f32_16x16x32_bf16 v[104:107], a[236:239], a[176:179], v[104:107]
    s_bfe_u32 s61, 0xb080809, s89
    s_mul_i32 s61, s61, 20480
    buffer_load_dwordx4 a[208:211], v41, s[8:11], s61 offen offset:0 sc1
    v_mfma_f32_16x16x32_bf16 v[124:127], a[236:239], a[180:183], v[124:127]
    v_mfma_f32_16x16x32_bf16 v[144:147], a[236:239], a[184:187], v[144:147]
    buffer_load_dwordx4 a[212:215], v41, s[8:11], s61 offen offset:1024 sc1
    v_mfma_f32_16x16x32_bf16 v[164:167], a[236:239], a[188:191], v[164:167]
    v_mfma_f32_16x16x32_bf16 v[108:111], a[240:243], a[176:179], v[108:111]
    buffer_load_dwordx4 a[216:219], v41, s[8:11], s61 offen offset:2048 sc1
    v_mfma_f32_16x16x32_bf16 v[128:131], a[240:243], a[180:183], v[128:131]
    v_mfma_f32_16x16x32_bf16 v[148:151], a[240:243], a[184:187], v[148:151]
    buffer_load_dwordx4 a[220:223], v41, s[8:11], s61 offen offset:3072 sc1
    v_mfma_f32_16x16x32_bf16 v[168:171], a[240:243], a[188:191], v[168:171]
    v_mfma_f32_16x16x32_bf16 v[112:115], a[244:247], a[176:179], v[112:115]
    buffer_load_dwordx4 a[224:227], v42, s[8:11], s61 offen sc1
    v_mfma_f32_16x16x32_bf16 v[132:135], a[244:247], a[180:183], v[132:135]
    v_mfma_f32_16x16x32_bf16 v[152:155], a[244:247], a[184:187], v[152:155]
    v_mfma_f32_16x16x32_bf16 v[172:175], a[244:247], a[188:191], v[172:175]
    s_waitcnt vmcnt(9)
    v_mfma_f32_16x16x32_bf16 v[96:99], v[12:15], a[192:195], v[96:99]
    s_cmp_lg_u32 s86, 0
    s_cbranch_scc1 L_w0_17
    s_waitcnt vmcnt(9)
    s_mov_b32 s65, 0
L_sp_18:
    v_cmp_ne_u32 vcc, s80, v46
    s_nop 0
    s_cmp_eq_u32 vcc_lo, 0
    s_cbranch_scc1 L_sp_19
    s_add_u32 s65, s65, 1
    s_cmp_gt_u32 s65, 100000
    s_cbranch_scc1 L_sp_19
    s_mov_b32 s40, 131072
    s_mov_b32 exec_hi, 0
    buffer_load_dword v46, v43, s[56:59], s40 offen sc1
    s_mov_b32 exec_hi, -1
    s_waitcnt vmcnt(0)
    s_branch L_sp_18
L_sp_19:
L_w0_17:
    s_barrier
    s_bfe_u32 s60, 0x100, s89
    s_lshl_b32 s60, s60, 15
    s_add_u32 s60, s60, 196608
    buffer_load_dwordx4 a[176:179], v44, s[48:51], s60 offen offset:0 sc1
    ds_read_b128 a[128:131], v8 offset:0
    ds_read_b128 a[132:135], v9 offset:0
    ds_read_b128 a[136:139], v8 offset:2048
    v_mfma_f32_16x16x32_bf16 v[116:119], v[12:15], a[196:199], v[116:119]
    ds_read_b128 a[140:143], v9 offset:2048
    ds_read_b128 a[144:147], v8 offset:4096
    ds_read_b128 a[148:151], v9 offset:4096
    v_mfma_f32_16x16x32_bf16 v[136:139], v[12:15], a[200:203], v[136:139]
    buffer_load_dwordx4 a[180:183], v44, s[48:51], s60 offen offset:1024 sc1
    ds_read_b128 a[152:155], v8 offset:6144
    ds_read_b128 a[156:159], v9 offset:6144
    v_mfma_f32_16x16x32_bf16 v[156:159], v[12:15], a[204:207], v[156:159]
    v_mfma_f32_16x16x32_bf16 v[100:103], v[16:19], a[192:195], v[100:103]
    buffer_load_dwordx4 a[184:187], v44, s[48:51], s60 offen offset:2048 sc1
    v_mfma_f32_16x16x32_bf16 v[120:123], v[16:19], a[196:199], v[120:123]
    v_mfma_f32_16x16x32_bf16 v[140:143], v[16:19], a[200:203], v[140:143]
    buffer_load_dwordx4 a[188:191], v44, s[48:51], s60 offen offset:3072 sc1
    v_mfma_f32_16x16x32_bf16 v[160:163], v[16:19], a[204:207], v[160:163]
    v_mfma_f32_16x16x32_bf16 v[104:107], v[20:23], a[192:195], v[104:107]
    s_bfe_u32 s61, 0x9090a0a, s89
    s_mul_i32 s61, s61, 20480
    buffer_load_dwordx4 a[228:231], v41, s[8:11], s61 offen offset:0 sc1
    v_mfma_f32_16x16x32_bf16 v[124:127], v[20:23], a[196:199], v[124:127]
    v_mfma_f32_16x16x32_bf16 v[144:147], v[20:23], a[200:203], v[144:147]
    v_mfma_f32_16x16x32_bf16 v[164:167], v[20:23], a[204:207], v[164:167]
    v_mfma_f32_16x16x32_bf16 v[108:111], v[24:27], a[192:195], v[108:111]
    v_mfma_f32_16x16x32_bf16 v[128:131], v[24:27], a[196:199], v[128:131]
    v_mfma_f32_16x16x32_bf16 v[148:151], v[24:27], a[200:203], v[148:151]
    v_mfma_f32_16x16x32_bf16 v[168:171], v[24:27], a[204:207], v[168:171]
    v_mfma_f32_16x16x32_bf16 v[112:115], v[28:31], a[192:195], v[112:115]
    v_mfma_f32_16x16x32_bf16 v[132:135], v[28:31], a[196:199], v[132:135]
    v_mfma_f32_16x16x32_bf16 v[152:155], v[28:31], a[200:203], v[152:155]
    v_mfma_f32_16x16x32_bf16 v[172:175], v[28:31], a[204:207], v[172:175]
    s_waitcnt vmcnt(5)
    v_mfma_f32_16x16x32_bf16 v[96:99], a[208:211], a[160:163], v[96:99]
    s_bfe_u32 s60, 0x100, s89
    s_lshl_b32 s60, s60, 15
    s_add_u32 s60, s60, 212992
    buffer_load_dwordx4 a[192:195], v44, s[48:51], s60 offen offset:0 sc1
    v_mfma_f32_16x16x32_bf16 v[116:119], a[208:211], a[164:167], v[116:119]
    v_mfma_f32_16x16x32_bf16 v[136:139], a[208:211], a[168:171], v[136:139]
    buffer_load_dwordx4 a[196:199], v44, s[48:51], s60 offen offset:1024 sc1
    v_mfma_f32_16x16x32_bf16 v[156:159], a[208:211], a[172:175], v[156:159]
    v_mfma_f32_16x16x32_bf16 v[100:103], a[212:215], a[160:163], v[100:103]
    buffer_load_dwordx4 a[200:203], v44, s[48:51], s60 offen offset:2048 sc1
    v_mfma_f32_16x16x32_bf16 v[120:123], a[212:215], a[164:167], v[120:123]
    v_mfma_f32_16x16x32_bf16 v[140:143], a[212:215], a[168:171], v[140:143]
    buffer_load_dwordx4 a[204:207], v44, s[48:51], s60 offen offset:3072 sc1
    v_mfma_f32_16x16x32_bf16 v[160:163], a[212:215], a[172:175], v[160:163]
    v_mfma_f32_16x16x32_bf16 v[104:107], a[216:219], a[160:163], v[104:107]
    buffer_load_dwordx4 a[232:235], v41, s[8:11], s61 offen offset:1024 sc1
    v_mfma_f32_16x16x32_bf16 v[124:127], a[216:219], a[164:167], v[124:127]
    v_mfma_f32_16x16x32_bf16 v[144:147], a[216:219], a[168:171], v[144:147]
    v_mfma_f32_16x16x32_bf16 v[164:167], a[216:219], a[172:175], v[164:167]
    v_mfma_f32_16x16x32_bf16 v[108:111], a[220:223], a[160:163], v[108:111]
    v_mfma_f32_16x16x32_bf16 v[128:131], a[220:223], a[164:167], v[128:131]
    v_mfma_f32_16x16x32_bf16 v[148:151], a[220:223], a[168:171], v[148:151]
    v_mfma_f32_16x16x32_bf16 v[168:171], a[220:223], a[172:175], v[168:171]
    v_mfma_f32_16x16x32_bf16 v[112:115], a[224:227], a[160:163], v[112:115]
    v_mfma_f32_16x16x32_bf16 v[132:135], a[224:227], a[164:167], v[132:135]
    v_mfma_f32_16x16x32_bf16 v[152:155], a[224:227], a[168:171], v[152:155]
    v_mfma_f32_16x16x32_bf16 v[172:175], a[224:227], a[172:175], v[172:175]
    s_waitcnt vmcnt(6)
    v_mfma_f32_16x16x32_bf16 v[176:179], a[0:3], a[176:179], 0
    s_bfe_u32 s60, 0x1020001, s89
    s_lshl_b32 s60, s60, 15
    s_add_u32 s60, s60, 196608
    buffer_load_dwordx4 a[160:163], v44, s[48:51], s60 offen offset:0 sc1
    v_mfma_f32_16x16x32_bf16 v[196:199], a[0:3], a[180:183], 0
    v_mfma_f32_16x16x32_bf16 v[216:219], a[0:3], a[184:187], 0
    buffer_load_dwordx4 a[164:167], v44, s[48:51], s60 offen offset:1024 sc1
    v_mfma_f32_16x16x32_bf16 v[236:239], a[0:3], a[188:191], 0
    v_mfma_f32_16x16x32_bf16 v[180:183], a[8:11], a[176:179], 0
    buffer_load_dwordx4 a[168:171], v44, s[48:51], s60 offen offset:2048 sc1
    v_mfma_f32_16x16x32_bf16 v[200:203], a[8:11], a[180:183], 0
    v_mfma_f32_16x16x32_bf16 v[220:223], a[8:11], a[184:187], 0
    buffer_load_dwordx4 a[172:175], v44, s[48:51], s60 offen offset:3072 sc1
    v_mfma_f32_16x16x32_bf16 v[240:243], a[8:11], a[188:191], 0
    v_mfma_f32_16x16x32_bf16 v[184:187], a[16:19], a[176:179], 0
    buffer_load_dwordx4 a[236:239], v41, s[8:11], s61 offen offset:2048 sc1
    v_mfma_f32_16x16x32_bf16 v[204:207], a[16:19], a[180:183], 0
    v_mfma_f32_16x16x32_bf16 v[224:227], a[16:19], a[184:187], 0
    v_mfma_f32_16x16x32_bf16 v[244:247], a[16:19], a[188:191], 0
    v_mfma_f32_16x16x32_bf16 v[188:191], a[24:27], a[176:179], 0
    v_mfma_f32_16x16x32_bf16 v[208:211], a[24:27], a[180:183], 0
    v_mfma_f32_16x16x32_bf16 v[228:231], a[24:27], a[184:187], 0
    v_mfma_f32_16x16x32_bf16 v[248:251], a[24:27], a[188:191], 0
    v_mfma_f32_16x16x32_bf16 v[192:195], a[32:35], a[176:179], 0
    v_mfma_f32_16x16x32_bf16 v[212:215], a[32:35], a[180:183], 0
    v_mfma_f32_16x16x32_bf16 v[232:235], a[32:35], a[184:187], 0
    v_mfma_f32_16x16x32_bf16 v[252:255], a[32:35], a[188:191], 0
    s_waitcnt vmcnt(6)
    v_mfma_f32_16x16x32_bf16 v[176:179], a[4:7], a[192:195], v[176:179]
    s_bfe_u32 s60, 0x1020001, s89
    s_lshl_b32 s60, s60, 15
    s_add_u32 s60, s60, 212992
    buffer_load_dwordx4 a[176:179], v44, s[48:51], s60 offen offset:0 sc1
    v_mfma_f32_16x16x32_bf16 v[196:199], a[4:7], a[196:199], v[196:199]
    v_mfma_f32_16x16x32_bf16 v[216:219], a[4:7], a[200:203], v[216:219]
    buffer_load_dwordx4 a[180:183], v44, s[48:51], s60 offen offset:1024 sc1
    v_mfma_f32_16x16x32_bf16 v[236:239], a[4:7], a[204:207], v[236:239]
    v_mfma_f32_16x16x32_bf16 v[180:183], a[12:15], a[192:195], v[180:183]
    buffer_load_dwordx4 a[184:187], v44, s[48:51], s60 offen offset:2048 sc1
    v_mfma_f32_16x16x32_bf16 v[200:203], a[12:15], a[196:199], v[200:203]
    v_mfma_f32_16x16x32_bf16 v[220:223], a[12:15], a[200:203], v[220:223]
    buffer_load_dwordx4 a[188:191], v44, s[48:51], s60 offen offset:3072 sc1
    v_mfma_f32_16x16x32_bf16 v[240:243], a[12:15], a[204:207], v[240:243]
    v_mfma_f32_16x16x32_bf16 v[184:187], a[20:23], a[192:195], v[184:187]
    buffer_load_dwordx4 a[240:243], v41, s[8:11], s61 offen offset:3072 sc1
    v_mfma_f32_16x16x32_bf16 v[204:207], a[20:23], a[196:199], v[204:207]
    v_mfma_f32_16x16x32_bf16 v[224:227], a[20:23], a[200:203], v[224:227]
    v_mfma_f32_16x16x32_bf16 v[244:247], a[20:23], a[204:207], v[244:247]
    v_mfma_f32_16x16x32_bf16 v[188:191], a[28:31], a[192:195], v[188:191]
    v_mfma_f32_16x16x32_bf16 v[208:211], a[28:31], a[196:199], v[208:211]
    v_mfma_f32_16x16x32_bf16 v[228:231], a[28:31], a[200:203], v[228:231]
    v_mfma_f32_16x16x32_bf16 v[248:251], a[28:31], a[204:207], v[248:251]
    v_mfma_f32_16x16x32_bf16 v[192:195], a[36:39], a[192:195], v[192:195]
    v_mfma_f32_16x16x32_bf16 v[212:215], a[36:39], a[196:199], v[212:215]
    v_mfma_f32_16x16x32_bf16 v[232:235], a[36:39], a[200:203], v[232:235]
    v_mfma_f32_16x16x32_bf16 v[252:255], a[36:39], a[204:207], v[252:255]
    s_waitcnt vmcnt(6)
    v_mfma_f32_16x16x32_bf16 v[176:179], a[40:43], a[160:163], v[176:179]
    s_bfe_u32 s60, 0x9090a0a, s89
    s_lshl_b32 s60, s60, 14
    buffer_load_dwordx4 a[192:195], v44, s[48:51], s60 offen offset:0 sc1
    ds_read_b128 a[0:3], v8 offset:32768
    ds_read_b128 a[4:7], v9 offset:32768
    v_mfma_f32_16x16x32_bf16 v[196:199], a[40:43], a[164:167], v[196:199]
    ds_read_b128 a[8:11], v8 offset:34816
    ds_read_b128 a[12:15], v9 offset:34816
    v_mfma_f32_16x16x32_bf16 v[216:219], a[40:43], a[168:171], v[216:219]
    buffer_load_dwordx4 a[196:199], v44, s[48:51], s60 offen offset:1024 sc1
    ds_read_b128 a[16:19], v8 offset:36864
    ds_read_b128 a[20:23], v9 offset:36864
    v_mfma_f32_16x16x32_bf16 v[236:239], a[40:43], a[172:175], v[236:239]
    ds_read_b128 a[24:27], v8 offset:38912
    ds_read_b128 a[28:31], v9 offset:38912
    v_mfma_f32_16x16x32_bf16 v[180:183], a[48:51], a[160:163], v[180:183]
    buffer_load_dwordx4 a[200:203], v44, s[48:51], s60 offen offset:2048 sc1
    ds_read_b128 a[32:35], v6 offset:0
    ds_read_b128 a[36:39], v7 offset:0
    v_mfma_f32_16x16x32_bf16 v[200:203], a[48:51], a[164:167], v[200:203]
    v_mfma_f32_16x16x32_bf16 v[220:223], a[48:51], a[168:171], v[220:223]
    buffer_load_dwordx4 a[204:207], v44, s[48:51], s60 offen offset:3072 sc1
    v_mfma_f32_16x16x32_bf16 v[240:243], a[48:51], a[172:175], v[240:243]
    v_mfma_f32_16x16x32_bf16 v[184:187], a[56:59], a[160:163], v[184:187]
    buffer_load_dwordx4 a[244:247], v42, s[8:11], s61 offen sc1
    v_mfma_f32_16x16x32_bf16 v[204:207], a[56:59], a[164:167], v[204:207]
    v_mfma_f32_16x16x32_bf16 v[224:227], a[56:59], a[168:171], v[224:227]
    v_mfma_f32_16x16x32_bf16 v[244:247], a[56:59], a[172:175], v[244:247]
    v_mfma_f32_16x16x32_bf16 v[188:191], a[64:67], a[160:163], v[188:191]
    v_mfma_f32_16x16x32_bf16 v[208:211], a[64:67], a[164:167], v[208:211]
    v_mfma_f32_16x16x32_bf16 v[228:231], a[64:67], a[168:171], v[228:231]
    v_mfma_f32_16x16x32_bf16 v[248:251], a[64:67], a[172:175], v[248:251]
    v_mfma_f32_16x16x32_bf16 v[192:195], a[72:75], a[160:163], v[192:195]
    v_mfma_f32_16x16x32_bf16 v[212:215], a[72:75], a[164:167], v[212:215]
    v_mfma_f32_16x16x32_bf16 v[232:235], a[72:75], a[168:171], v[232:235]
    v_mfma_f32_16x16x32_bf16 v[252:255], a[72:75], a[172:175], v[252:255]
    s_waitcnt vmcnt(6)
    v_mfma_f32_16x16x32_bf16 v[176:179], a[44:47], a[176:179], v[176:179]
    s_bfe_u32 s60, 0x3010202, s89
    s_lshl_b32 s60, s60, 15
    s_add_u32 s60, s60, 196608
    buffer_load_dwordx4 a[160:163], v44, s[48:51], s60 offen offset:0 sc1
    v_mfma_f32_16x16x32_bf16 v[196:199], a[44:47], a[180:183], v[196:199]
    v_mfma_f32_16x16x32_bf16 v[216:219], a[44:47], a[184:187], v[216:219]
    buffer_load_dwordx4 a[164:167], v44, s[48:51], s60 offen offset:1024 sc1
    v_mfma_f32_16x16x32_bf16 v[236:239], a[44:47], a[188:191], v[236:239]
    v_mfma_f32_16x16x32_bf16 v[180:183], a[52:55], a[176:179], v[180:183]
    buffer_load_dwordx4 a[168:171], v44, s[48:51], s60 offen offset:2048 sc1
    v_mfma_f32_16x16x32_bf16 v[200:203], a[52:55], a[180:183], v[200:203]
    v_mfma_f32_16x16x32_bf16 v[220:223], a[52:55], a[184:187], v[220:223]
    buffer_load_dwordx4 a[172:175], v44, s[48:51], s60 offen offset:3072 sc1
    v_mfma_f32_16x16x32_bf16 v[240:243], a[52:55], a[188:191], v[240:243]
    v_mfma_f32_16x16x32_bf16 v[184:187], a[60:63], a[176:179], v[184:187]
    s_bfe_u32 s61, 0xa0b0b0b, s89
    s_mul_i32 s61, s61, 20480
    buffer_load_dwordx4 v[12:15], v41, s[8:11], s61 offen offset:0 sc1
    v_mfma_f32_16x16x32_bf16 v[204:207], a[60:63], a[180:183], v[204:207]
    v_mfma_f32_16x16x32_bf16 v[224:227], a[60:63], a[184:187], v[224:227]
    buffer_load_dwordx4 v[16:19], v41, s[8:11], s61 offen offset:1024 sc1
    v_mfma_f32_16x16x32_bf16 v[244:247], a[60:63], a[188:191], v[244:247]
    v_mfma_f32_16x16x32_bf16 v[188:191], a[68:71], a[176:179], v[188:191]
    v_mfma_f32_16x16x32_bf16 v[208:211], a[68:71], a[180:183], v[208:211]
    v_mfma_f32_16x16x32_bf16 v[228:231], a[68:71], a[184:187], v[228:231]
    v_mfma_f32_16x16x32_bf16 v[248:251], a[68:71], a[188:191], v[248:251]
    v_mfma_f32_16x16x32_bf16 v[192:195], a[76:79], a[176:179], v[192:195]
    v_mfma_f32_16x16x32_bf16 v[212:215], a[76:79], a[180:183], v[212:215]
    v_mfma_f32_16x16x32_bf16 v[232:235], a[76:79], a[184:187], v[232:235]
    v_mfma_f32_16x16x32_bf16 v[252:255], a[76:79], a[188:191], v[252:255]
    s_waitcnt vmcnt(6)
    v_mfma_f32_16x16x32_bf16 v[96:99], a[228:231], a[192:195], v[96:99]
    s_waitcnt lgkmcnt(0)
    s_barrier
    s_bfe_u32 s60, 0x3010202, s89
    s_lshl_b32 s60, s60, 15
    s_add_u32 s60, s60, 212992
    buffer_load_dwordx4 a[176:179], v44, s[48:51], s60 offen offset:0 sc1
    v_mfma_f32_16x16x32_bf16 v[116:119], a[228:231], a[196:199], v[116:119]
    v_mfma_f32_16x16x32_bf16 v[136:139], a[228:231], a[200:203], v[136:139]
    buffer_load_dwordx4 a[180:183], v44, s[48:51], s60 offen offset:1024 sc1
    v_mfma_f32_16x16x32_bf16 v[156:159], a[228:231], a[204:207], v[156:159]
    v_mfma_f32_16x16x32_bf16 v[100:103], a[232:235], a[192:195], v[100:103]
    buffer_load_dwordx4 a[184:187], v44, s[48:51], s60 offen offset:2048 sc1
    v_mfma_f32_16x16x32_bf16 v[120:123], a[232:235], a[196:199], v[120:123]
    v_mfma_f32_16x16x32_bf16 v[140:143], a[232:235], a[200:203], v[140:143]
    buffer_load_dwordx4 a[188:191], v44, s[48:51], s60 offen offset:3072 sc1
    v_mfma_f32_16x16x32_bf16 v[160:163], a[232:235], a[204:207], v[160:163]
    v_mfma_f32_16x16x32_bf16 v[104:107], a[236:239], a[192:195], v[104:107]
    buffer_load_dwordx4 v[20:23], v41, s[8:11], s61 offen offset:2048 sc1
    v_mfma_f32_16x16x32_bf16 v[124:127], a[236:239], a[196:199], v[124:127]
    v_mfma_f32_16x16x32_bf16 v[144:147], a[236:239], a[200:203], v[144:147]
    v_mfma_f32_16x16x32_bf16 v[164:167], a[236:239], a[204:207], v[164:167]
    v_mfma_f32_16x16x32_bf16 v[108:111], a[240:243], a[192:195], v[108:111]
    v_mfma_f32_16x16x32_bf16 v[128:131], a[240:243], a[196:199], v[128:131]
    v_mfma_f32_16x16x32_bf16 v[148:151], a[240:243], a[200:203], v[148:151]
    v_mfma_f32_16x16x32_bf16 v[168:171], a[240:243], a[204:207], v[168:171]
    v_mfma_f32_16x16x32_bf16 v[112:115], a[244:247], a[192:195], v[112:115]
    v_mfma_f32_16x16x32_bf16 v[132:135], a[244:247], a[196:199], v[132:135]
    v_mfma_f32_16x16x32_bf16 v[152:155], a[244:247], a[200:203], v[152:155]
    v_mfma_f32_16x16x32_bf16 v[172:175], a[244:247], a[204:207], v[172:175]
    s_waitcnt vmcnt(7)
    v_mfma_f32_16x16x32_bf16 v[176:179], a[80:83], a[160:163], v[176:179]
    s_bfe_u32 s60, 0x2030304, s89
    s_lshl_b32 s60, s60, 15
    s_add_u32 s60, s60, 196608
    buffer_load_dwordx4 a[192:195], v44, s[48:51], s60 offen offset:0 sc1
    v_mfma_f32_16x16x32_bf16 v[196:199], a[80:83], a[164:167], v[196:199]
    v_mfma_f32_16x16x32_bf16 v[216:219], a[80:83], a[168:171], v[216:219]
    buffer_load_dwordx4 a[196:199], v44, s[48:51], s60 offen offset:1024 sc1
    v_mfma_f32_16x16x32_bf16 v[236:239], a[80:83], a[172:175], v[236:239]
    v_mfma_f32_16x16x32_bf16 v[180:183], a[88:91], a[160:163], v[180:183]
    buffer_load_dwordx4 a[200:203], v44, s[48:51], s60 offen offset:2048 sc1
    v_mfma_f32_16x16x32_bf16 v[200:203], a[88:91], a[164:167], v[200:203]
    v_mfma_f32_16x16x32_bf16 v[220:223], a[88:91], a[168:171], v[220:223]
    buffer_load_dwordx4 a[204:207], v44, s[48:51], s60 offen offset:3072 sc1
    v_mfma_f32_16x16x32_bf16 v[240:243], a[88:91], a[172:175], v[240:243]
    v_mfma_f32_16x16x32_bf16 v[184:187], a[96:99], a[160:163], v[184:187]
    buffer_load_dwordx4 v[24:27], v41, s[8:11], s61 offen offset:3072 sc1
    v_mfma_f32_16x16x32_bf16 v[204:207], a[96:99], a[164:167], v[204:207]
    v_mfma_f32_16x16x32_bf16 v[224:227], a[96:99], a[168:171], v[224:227]
    v_mfma_f32_16x16x32_bf16 v[244:247], a[96:99], a[172:175], v[244:247]
    v_mfma_f32_16x16x32_bf16 v[188:191], a[104:107], a[160:163], v[188:191]
    v_mfma_f32_16x16x32_bf16 v[208:211], a[104:107], a[164:167], v[208:211]
    v_mfma_f32_16x16x32_bf16 v[228:231], a[104:107], a[168:171], v[228:231]
    v_mfma_f32_16x16x32_bf16 v[248:251], a[104:107], a[172:175], v[248:251]
    v_mfma_f32_16x16x32_bf16 v[192:195], a[112:115], a[160:163], v[192:195]
    v_mfma_f32_16x16x32_bf16 v[212:215], a[112:115], a[164:167], v[212:215]
    v_mfma_f32_16x16x32_bf16 v[232:235], a[112:115], a[168:171], v[232:235]
    v_mfma_f32_16x16x32_bf16 v[252:255], a[112:115], a[172:175], v[252:255]
    s_waitcnt vmcnt(6)
    v_mfma_f32_16x16x32_bf16 v[176:179], a[84:87], a[176:179], v[176:179]
    s_bfe_u32 s60, 0xa0b0b0b, s89
    s_lshl_b32 s60, s60, 14
    buffer_load_dwordx4 a[160:163], v44, s[48:51], s60 offen offset:0 sc1
    v_mfma_f32_16x16x32_bf16 v[196:199], a[84:87], a[180:183], v[196:199]
    v_mfma_f32_16x16x32_bf16 v[216:219], a[84:87], a[184:187], v[216:219]
    buffer_load_dwordx4 a[164:167], v44, s[48:51], s60 offen offset:1024 sc1
    v_mfma_f32_16x16x32_bf16 v[236:239], a[84:87], a[188:191], v[236:239]
    v_mfma_f32_16x16x32_bf16 v[180:183], a[92:95], a[176:179], v[180:183]
    buffer_load_dwordx4 a[168:171], v44, s[48:51], s60 offen offset:2048 sc1
    v_mfma_f32_16x16x32_bf16 v[200:203], a[92:95], a[180:183], v[200:203]
    v_mfma_f32_16x16x32_bf16 v[220:223], a[92:95], a[184:187], v[220:223]
    buffer_load_dwordx4 a[172:175], v44, s[48:51], s60 offen offset:3072 sc1
    v_mfma_f32_16x16x32_bf16 v[240:243], a[92:95], a[188:191], v[240:243]
    v_mfma_f32_16x16x32_bf16 v[184:187], a[100:103], a[176:179], v[184:187]
    buffer_load_dwordx4 v[28:31], v42, s[8:11], s61 offen sc1
    v_mfma_f32_16x16x32_bf16 v[204:207], a[100:103], a[180:183], v[204:207]
    v_mfma_f32_16x16x32_bf16 v[224:227], a[100:103], a[184:187], v[224:227]
    v_mfma_f32_16x16x32_bf16 v[244:247], a[100:103], a[188:191], v[244:247]
    v_mfma_f32_16x16x32_bf16 v[188:191], a[108:111], a[176:179], v[188:191]
    v_mfma_f32_16x16x32_bf16 v[208:211], a[108:111], a[180:183], v[208:211]
    v_mfma_f32_16x16x32_bf16 v[228:231], a[108:111], a[184:187], v[228:231]
    v_mfma_f32_16x16x32_bf16 v[248:251], a[108:111], a[188:191], v[248:251]
    v_mfma_f32_16x16x32_bf16 v[192:195], a[116:119], a[176:179], v[192:195]
    v_mfma_f32_16x16x32_bf16 v[212:215], a[116:119], a[180:183], v[212:215]
    v_mfma_f32_16x16x32_bf16 v[232:235], a[116:119], a[184:187], v[232:235]
    v_mfma_f32_16x16x32_bf16 v[252:255], a[116:119], a[188:191], v[252:255]
    s_waitcnt vmcnt(6)
    v_mfma_f32_16x16x32_bf16 v[176:179], a[120:123], a[192:195], v[176:179]
    s_bfe_u32 s60, 0x2030304, s89
    s_lshl_b32 s60, s60, 15
    s_add_u32 s60, s60, 212992
    buffer_load_dwordx4 a[176:179], v44, s[48:51], s60 offen offset:0 sc1
    v_mfma_f32_16x16x32_bf16 v[196:199], a[120:123], a[196:199], v[196:199]
    v_mfma_f32_16x16x32_bf16 v[216:219], a[120:123], a[200:203], v[216:219]
    buffer_load_dwordx4 a[180:183], v44, s[48:51], s60 offen offset:1024 sc1
    v_mfma_f32_16x16x32_bf16 v[236:239], a[120:123], a[204:207], v[236:239]
    v_mfma_f32_16x16x32_bf16 v[180:183], a[128:131], a[192:195], v[180:183]
    buffer_load_dwordx4 a[184:187], v44, s[48:51], s60 offen offset:2048 sc1
    v_mfma_f32_16x16x32_bf16 v[200:203], a[128:131], a[196:199], v[200:203]
    v_mfma_f32_16x16x32_bf16 v[220:223], a[128:131], a[200:203], v[220:223]
    buffer_load_dwordx4 a[188:191], v44, s[48:51], s60 offen offset:3072 sc1
    v_mfma_f32_16x16x32_bf16 v[240:243], a[128:131], a[204:207], v[240:243]
    v_mfma_f32_16x16x32_bf16 v[184:187], a[136:139], a[192:195], v[184:187]
    v_mfma_f32_16x16x32_bf16 v[204:207], a[136:139], a[196:199], v[204:207]
    v_mfma_f32_16x16x32_bf16 v[224:227], a[136:139], a[200:203], v[224:227]
    v_mfma_f32_16x16x32_bf16 v[244:247], a[136:139], a[204:207], v[244:247]
    v_mfma_f32_16x16x32_bf16 v[188:191], a[144:147], a[192:195], v[188:191]
    v_mfma_f32_16x16x32_bf16 v[208:211], a[144:147], a[196:199], v[208:211]
    v_mfma_f32_16x16x32_bf16 v[228:231], a[144:147], a[200:203], v[228:231]
    v_mfma_f32_16x16x32_bf16 v[248:251], a[144:147], a[204:207], v[248:251]
    v_mfma_f32_16x16x32_bf16 v[192:195], a[152:155], a[192:195], v[192:195]
    v_mfma_f32_16x16x32_bf16 v[212:215], a[152:155], a[196:199], v[212:215]
    v_mfma_f32_16x16x32_bf16 v[232:235], a[152:155], a[200:203], v[232:235]
    v_mfma_f32_16x16x32_bf16 v[252:255], a[152:155], a[204:207], v[252:255]
    s_waitcnt vmcnt(4)
    v_mfma_f32_16x16x32_bf16 v[96:99], v[12:15], a[160:163], v[96:99]
    s_bfe_u32 s60, 0x4040403, s89
    s_lshl_b32 s60, s60, 15
    s_add_u32 s60, s60, 196608
    buffer_load_dwordx4 a[192:195], v44, s[48:51], s60 offen offset:0 sc1
    v_mfma_f32_16x16x32_bf16 v[116:119], v[12:15], a[164:167], v[116:119]
    v_mfma_f32_16x16x32_bf16 v[136:139], v[12:15], a[168:171], v[136:139]
    buffer_load_dwordx4 a[196:199], v44, s[48:51], s60 offen offset:1024 sc1
    v_mfma_f32_16x16x32_bf16 v[156:159], v[12:15], a[172:175], v[156:159]
    v_mfma_f32_16x16x32_bf16 v[100:103], v[16:19], a[160:163], v[100:103]
    buffer_load_dwordx4 a[200:203], v44, s[48:51], s60 offen offset:2048 sc1
    v_mfma_f32_16x16x32_bf16 v[120:123], v[16:19], a[164:167], v[120:123]
    v_mfma_f32_16x16x32_bf16 v[140:143], v[16:19], a[168:171], v[140:143]
    buffer_load_dwordx4 a[204:207], v44, s[48:51], s60 offen offset:3072 sc1
    v_mfma_f32_16x16x32_bf16 v[160:163], v[16:19], a[172:175], v[160:163]
    v_mfma_f32_16x16x32_bf16 v[104:107], v[20:23], a[160:163], v[104:107]
    v_mfma_f32_16x16x32_bf16 v[124:127], v[20:23], a[164:167], v[124:127]
    v_mfma_f32_16x16x32_bf16 v[144:147], v[20:23], a[168:171], v[144:147]
    v_mfma_f32_16x16x32_bf16 v[164:167], v[20:23], a[172:175], v[164:167]
    v_mfma_f32_16x16x32_bf16 v[108:111], v[24:27], a[160:163], v[108:111]
    v_mfma_f32_16x16x32_bf16 v[128:131], v[24:27], a[164:167], v[128:131]
    v_mfma_f32_16x16x32_bf16 v[148:151], v[24:27], a[168:171], v[148:151]
    v_mfma_f32_16x16x32_bf16 v[168:171], v[24:27], a[172:175], v[168:171]
    v_mfma_f32_16x16x32_bf16 v[112:115], v[28:31], a[160:163], v[112:115]
    v_mfma_f32_16x16x32_bf16 v[132:135], v[28:31], a[164:167], v[132:135]
    v_mfma_f32_16x16x32_bf16 v[152:155], v[28:31], a[168:171], v[152:155]
    v_mfma_f32_16x16x32_bf16 v[172:175], v[28:31], a[172:175], v[172:175]
    s_waitcnt vmcnt(4)
    v_mfma_f32_16x16x32_bf16 v[176:179], a[124:127], a[176:179], v[176:179]
    s_bfe_u32 s60, 0x4040403, s89
    s_lshl_b32 s60, s60, 15
    s_add_u32 s60, s60, 212992
    buffer_load_dwordx4 a[160:163], v44, s[48:51], s60 offen offset:0 sc1
    v_mul_f32 v96, v33, v96
    v_mul_f32 v97, v33, v97
    v_mfma_f32_16x16x32_bf16 v[196:199], a[124:127], a[180:183], v[196:199]
    v_mul_f32 v98, v33, v98
    v_mul_f32 v99, v33, v99
    v_mfma_f32_16x16x32_bf16 v[216:219], a[124:127], a[184:187], v[216:219]
    buffer_load_dwordx4 a[164:167], v44, s[48:51], s60 offen offset:1024 sc1
    v_mul_f32 v100, v33, v100
    v_mul_f32 v101, v33, v101
    v_mfma_f32_16x16x32_bf16 v[236:239], a[124:127], a[188:191], v[236:239]
    v_mul_f32 v102, v33, v102
    v_mul_f32 v103, v33, v103
    v_mfma_f32_16x16x32_bf16 v[180:183], a[132:135], a[176:179], v[180:183]
    buffer_load_dwordx4 a[168:171], v44, s[48:51], s60 offen offset:2048 sc1
    v_mul_f32 v104, v33, v104
    v_mul_f32 v105, v33, v105
    v_mfma_f32_16x16x32_bf16 v[200:203], a[132:135], a[180:183], v[200:203]
    v_mul_f32 v106, v33, v106
    v_mul_f32 v107, v33, v107
    v_mfma_f32_16x16x32_bf16 v[220:223], a[132:135], a[184:187], v[220:223]
    buffer_load_dwordx4 a[172:175], v44, s[48:51], s60 offen offset:3072 sc1
    v_mul_f32 v108, v33, v108
    v_mul_f32 v109, v33, v109
    v_mfma_f32_16x16x32_bf16 v[240:243], a[132:135], a[188:191], v[240:243]
    v_mul_f32 v110, v33, v110
    v_mul_f32 v111, v33, v111
    v_mfma_f32_16x16x32_bf16 v[184:187], a[140:143], a[176:179], v[184:187]
    v_mul_f32 v112, v33, v112
    v_mul_f32 v113, v33, v113
    v_mfma_f32_16x16x32_bf16 v[204:207], a[140:143], a[180:183], v[204:207]
    v_mul_f32 v114, v33, v114
    v_mul_f32 v115, v33, v115
    v_mfma_f32_16x16x32_bf16 v[224:227], a[140:143], a[184:187], v[224:227]
    v_mul_f32 v116, v35, v116
    v_mul_f32 v117, v35, v117
    v_mfma_f32_16x16x32_bf16 v[244:247], a[140:143], a[188:191], v[244:247]
    v_mul_f32 v118, v35, v118
    v_mul_f32 v119, v35, v119
    v_mfma_f32_16x16x32_bf16 v[188:191], a[148:151], a[176:179], v[188:191]
    v_mul_f32 v120, v35, v120
    v_mul_f32 v121, v35, v121
    v_mfma_f32_16x16x32_bf16 v[208:211], a[148:151], a[180:183], v[208:211]
    v_mul_f32 v122, v35, v122
    v_mul_f32 v123, v35, v123
    v_mfma_f32_16x16x32_bf16 v[228:231], a[148:151], a[184:187], v[228:231]
    v_mul_f32 v124, v35, v124
    v_mul_f32 v125, v35, v125
    v_mfma_f32_16x16x32_bf16 v[248:251], a[148:151], a[188:191], v[248:251]
    v_mul_f32 v126, v35, v126
    v_mul_f32 v127, v35, v127
    v_mfma_f32_16x16x32_bf16 v[192:195], a[156:159], a[176:179], v[192:195]
    v_mul_f32 v128, v35, v128
    v_mul_f32 v129, v35, v129
    v_mfma_f32_16x16x32_bf16 v[212:215], a[156:159], a[180:183], v[212:215]
    v_mul_f32 v130, v35, v130
    v_mul_f32 v131, v35, v131
    v_mfma_f32_16x16x32_bf16 v[232:235], a[156:159], a[184:187], v[232:235]
    v_mul_f32 v132, v35, v132
    v_mul_f32 v133, v35, v133
    v_mfma_f32_16x16x32_bf16 v[252:255], a[156:159], a[188:191], v[252:255]
    v_mul_f32 v134, v35, v134
    v_mul_f32 v135, v35, v135
    s_waitcnt vmcnt(4)
    v_mfma_f32_16x16x32_bf16 v[176:179], a[0:3], a[192:195], v[176:179]
    v_mul_f32 v136, v37, v136
    v_mul_f32 v137, v37, v137
    v_mfma_f32_16x16x32_bf16 v[196:199], a[0:3], a[196:199], v[196:199]
    v_mul_f32 v138, v37, v138
    v_mul_f32 v139, v37, v139
    v_mfma_f32_16x16x32_bf16 v[216:219], a[0:3], a[200:203], v[216:219]
    v_mul_f32 v140, v37, v140
    v_mul_f32 v141, v37, v141
    v_mfma_f32_16x16x32_bf16 v[236:239], a[0:3], a[204:207], v[236:239]
    v_mul_f32 v142, v37, v142
    v_mul_f32 v143, v37, v143
    v_mfma_f32_16x16x32_bf16 v[180:183], a[8:11], a[192:195], v[180:183]
    v_mul_f32 v144, v37, v144
    v_mul_f32 v145, v37, v145
    v_mfma_f32_16x16x32_bf16 v[200:203], a[8:11], a[196:199], v[200:203]
    v_mul_f32 v146, v37, v146
    v_mul_f32 v147, v37, v147
    v_mfma_f32_16x16x32_bf16 v[220:223], a[8:11], a[200:203], v[220:223]
    v_mul_f32 v148, v37, v148
    v_mul_f32 v149, v37, v149
    v_mfma_f32_16x16x32_bf16 v[240:243], a[8:11], a[204:207], v[240:243]
    v_mul_f32 v150, v37, v150
    v_mul_f32 v151, v37, v151
    v_mfma_f32_16x16x32_bf16 v[184:187], a[16:19], a[192:195], v[184:187]
    v_mul_f32 v152, v37, v152
    v_mul_f32 v153, v37, v153
    v_mfma_f32_16x16x32_bf16 v[204:207], a[16:19], a[196:199], v[204:207]
    v_mul_f32 v154, v37, v154
    v_mul_f32 v155, v37, v155
    v_mfma_f32_16x16x32_bf16 v[224:227], a[16:19], a[200:203], v[224:227]
    v_mul_f32 v156, v39, v156
    v_mul_f32 v157, v39, v157
    v_mfma_f32_16x16x32_bf16 v[244:247], a[16:19], a[204:207], v[244:247]
    v_mul_f32 v158, v39, v158
    v_mul_f32 v159, v39, v159
    v_mfma_f32_16x16x32_bf16 v[188:191], a[24:27], a[192:195], v[188:191]
    v_mul_f32 v160, v39, v160
    v_mul_f32 v161, v39, v161
    v_mfma_f32_16x16x32_bf16 v[208:211], a[24:27], a[196:199], v[208:211]
    v_mul_f32 v162, v39, v162
    v_mul_f32 v163, v39, v163
    v_mfma_f32_16x16x32_bf16 v[228:231], a[24:27], a[200:203], v[228:231]
    v_mul_f32 v164, v39, v164
    v_mul_f32 v165, v39, v165
    v_mfma_f32_16x16x32_bf16 v[248:251], a[24:27], a[204:207], v[248:251]
    v_mul_f32 v166, v39, v166
    v_mul_f32 v167, v39, v167
    v_mfma_f32_16x16x32_bf16 v[192:195], a[32:35], a[192:195], v[192:195]
    v_mul_f32 v168, v39, v168
    v_mul_f32 v169, v39, v169
    v_mfma_f32_16x16x32_bf16 v[212:215], a[32:35], a[196:199], v[212:215]
    v_mul_f32 v170, v39, v170
    v_mul_f32 v171, v39, v171
    v_mfma_f32_16x16x32_bf16 v[232:235], a[32:35], a[200:203], v[232:235]
    v_mul_f32 v172, v39, v172
    v_mul_f32 v173, v39, v173
    v_mfma_f32_16x16x32_bf16 v[252:255], a[32:35], a[204:207], v[252:255]
    v_mul_f32 v174, v39, v174
    v_mul_f32 v175, v39, v175
    s_waitcnt vmcnt(0)
    v_mfma_f32_16x16x32_bf16 v[176:179], a[4:7], a[160:163], v[176:179]
    v_mfma_f32_16x16x32_bf16 v[180:183], a[12:15], a[160:163], v[180:183]
    v_mfma_f32_16x16x32_bf16 v[184:187], a[20:23], a[160:163], v[184:187]
    v_mfma_f32_16x16x32_bf16 v[188:191], a[28:31], a[160:163], v[188:191]
    s_nop 4
    v_fmac_f32 v96, v32, v176
    v_fmac_f32 v97, v32, v177
    v_fmac_f32 v98, v32, v178
    v_fmac_f32 v99, v32, v179
    ds_write_b128 v82, v[96:99] offset:0
    v_mfma_f32_16x16x32_bf16 v[192:195], a[36:39], a[160:163], v[192:195]
    v_fmac_f32 v100, v32, v180
    v_fmac_f32 v101, v32, v181
    v_fmac_f32 v102, v32, v182
    v_fmac_f32 v103, v32, v183
    ds_write_b128 v82, v[100:103] offset:64
    v_mfma_f32_16x16x32_bf16 v[196:199], a[4:7], a[164:167], v[196:199]
    v_fmac_f32 v104, v32, v184
    v_fmac_f32 v105, v32, v185
    v_fmac_f32 v106, v32, v186
    v_fmac_f32 v107, v32, v187
    ds_write_b128 v82, v[104:107] offset:128
    v_mfma_f32_16x16x32_bf16 v[200:203], a[12:15], a[164:167], v[200:203]
    v_fmac_f32 v108, v32, v188
    v_fmac_f32 v109, v32, v189
    v_fmac_f32 v110, v32, v190
    v_fmac_f32 v111, v32, v191
    ds_write_b128 v82, v[108:111] offset:192
    v_mfma_f32_16x16x32_bf16 v[204:207], a[20:23], a[164:167], v[204:207]
    v_fmac_f32 v112, v32, v192
    v_fmac_f32 v113, v32, v193
    v_fmac_f32 v114, v32, v194
    v_fmac_f32 v115, v32, v195
    ds_write_b128 v82, v[112:115] offset:256
    v_mfma_f32_16x16x32_bf16 v[208:211], a[28:31], a[164:167], v[208:211]
    v_fmac_f32 v116, v34, v196
    v_fmac_f32 v117, v34, v197
    v_fmac_f32 v118, v34, v198
    v_fmac_f32 v119, v34, v199
    ds_write_b128 v82, v[116:119] offset:5120
    v_mfma_f32_16x16x32_bf16 v[212:215], a[36:39], a[164:167], v[212:215]
    v_fmac_f32 v120, v34, v200
    v_fmac_f32 v121, v34, v201
    v_fmac_f32 v122, v34, v202
    v_fmac_f32 v123, v34, v203
    ds_write_b128 v82, v[120:123] offset:5184
    v_mfma_f32_16x16x32_bf16 v[216:219], a[4:7], a[168:171], v[216:219]
    v_fmac_f32 v124, v34, v204
    v_fmac_f32 v125, v34, v205
    v_fmac_f32 v126, v34, v206
    v_fmac_f32 v127, v34, v207
    ds_write_b128 v82, v[124:127] offset:5248
    v_mfma_f32_16x16x32_bf16 v[220:223], a[12:15], a[168:171], v[220:223]
    v_fmac_f32 v128, v34, v208
    v_fmac_f32 v129, v34, v209
    v_fmac_f32 v130, v34, v210
    v_fmac_f32 v131, v34, v211
    ds_write_b128 v82, v[128:131] offset:5312
    v_mfma_f32_16x16x32_bf16 v[224:227], a[20:23], a[168:171], v[224:227]
    v_fmac_f32 v132, v34, v212
    v_fmac_f32 v133, v34, v213
    v_fmac_f32 v134, v34, v214
    v_fmac_f32 v135, v34, v215
    ds_write_b128 v82, v[132:135] offset:5376
    v_mfma_f32_16x16x32_bf16 v[228:231], a[28:31], a[168:171], v[228:231]
    v_mfma_f32_16x16x32_bf16 v[232:235], a[36:39], a[168:171], v[232:235]
    v_mfma_f32_16x16x32_bf16 v[236:239], a[4:7], a[172:175], v[236:239]
    v_mfma_f32_16x16x32_bf16 v[240:243], a[12:15], a[172:175], v[240:243]
    v_mfma_f32_16x16x32_bf16 v[244:247], a[20:23], a[172:175], v[244:247]
    v_mfma_f32_16x16x32_bf16 v[248:251], a[28:31], a[172:175], v[248:251]
    v_mfma_f32_16x16x32_bf16 v[252:255], a[36:39], a[172:175], v[252:255]
    s_waitcnt lgkmcnt(0)
    s_barrier
    ds_read_b128 v[176:179], v62 offset:0
    ds_read_b128 v[180:183], v62 offset:20480
    ds_read_b128 v[184:187], v62 offset:40960
    ds_read_b128 v[188:191], v62 offset:61440
    ds_read_b128 v[192:195], v63 offset:0
    ds_read_b128 v[196:199], v63 offset:20480
    ds_read_b128 v[200:203], v63 offset:40960
    ds_read_b128 v[204:207], v63 offset:61440
    v_pk_fma_f32 v[136:137], v[36:37], v[216:217], v[136:137] op_sel:[0,0,0] op_sel_hi:[0,1,1]
    v_pk_fma_f32 v[138:139], v[36:37], v[218:219], v[138:139] op_sel:[0,0,0] op_sel_hi:[0,1,1]
    ds_write_b128 v82, v[136:139] offset:10240
    v_pk_fma_f32 v[140:141], v[36:37], v[220:221], v[140:141] op_sel:[0,0,0] op_sel_hi:[0,1,1]
    v_pk_fma_f32 v[142:143], v[36:37], v[222:223], v[142:143] op_sel:[0,0,0] op_sel_hi:[0,1,1]
    ds_write_b128 v82, v[140:143] offset:10304
    v_pk_fma_f32 v[144:145], v[36:37], v[224:225], v[144:145] op_sel:[0,0,0] op_sel_hi:[0,1,1]
    v_pk_fma_f32 v[146:147], v[36:37], v[226:227], v[146:147] op_sel:[0,0,0] op_sel_hi:[0,1,1]
    ds_write_b128 v82, v[144:147] offset:10368
    v_pk_fma_f32 v[148:149], v[36:37], v[228:229], v[148:149] op_sel:[0,0,0] op_sel_hi:[0,1,1]
    v_pk_fma_f32 v[150:151], v[36:37], v[230:231], v[150:151] op_sel:[0,0,0] op_sel_hi:[0,1,1]
    ds_write_b128 v82, v[148:151] offset:10432
    v_pk_fma_f32 v[152:153], v[36:37], v[232:233], v[152:153] op_sel:[0,0,0] op_sel_hi:[0,1,1]
    v_pk_fma_f32 v[154:155], v[36:37], v[234:235], v[154:155] op_sel:[0,0,0] op_sel_hi:[0,1,1]
    ds_write_b128 v82, v[152:155] offset:10496
    s_waitcnt lgkmcnt(9)
    v_pk_add_f32 v[176:177], v[176:177], v[180:181]
    v_pk_add_f32 v[184:185], v[184:185], v[188:189]
    v_pk_add_f32 v[178:179], v[178:179], v[182:183]
    v_pk_add_f32 v[186:187], v[186:187], v[190:191]
    v_pk_add_f32 v[52:53], v[52:53], v[176:177]
    v_pk_add_f32 v[72:73], v[72:73], v[178:179]
    v_pk_add_f32 v[176:177], v[52:53], v[184:185]
    v_pk_add_f32 v[178:179], v[72:73], v[186:187]
    buffer_store_dwordx4 v[176:179], v67, s[16:19], 0 offen sc1
    v_pk_fma_f32 v[156:157], v[38:39], v[236:237], v[156:157] op_sel:[0,0,0] op_sel_hi:[0,1,1]
    v_pk_fma_f32 v[158:159], v[38:39], v[238:239], v[158:159] op_sel:[0,0,0] op_sel_hi:[0,1,1]
    ds_write_b128 v82, v[156:159] offset:15360
    v_pk_fma_f32 v[160:161], v[38:39], v[240:241], v[160:161] op_sel:[0,0,0] op_sel_hi:[0,1,1]
    v_pk_fma_f32 v[162:163], v[38:39], v[242:243], v[162:163] op_sel:[0,0,0] op_sel_hi:[0,1,1]
    ds_write_b128 v82, v[160:163] offset:15424
    v_pk_fma_f32 v[164:165], v[38:39], v[244:245], v[164:165] op_sel:[0,0,0] op_sel_hi:[0,1,1]
    v_pk_fma_f32 v[166:167], v[38:39], v[246:247], v[166:167] op_sel:[0,0,0] op_sel_hi:[0,1,1]
    ds_write_b128 v82, v[164:167] offset:15488
    v_pk_fma_f32 v[168:169], v[38:39], v[248:249], v[168:169] op_sel:[0,0,0] op_sel_hi:[0,1,1]
    v_pk_fma_f32 v[170:171], v[38:39], v[250:251], v[170:171] op_sel:[0,0,0] op_sel_hi:[0,1,1]
    ds_write_b128 v82, v[168:171] offset:15552
    v_pk_fma_f32 v[172:173], v[38:39], v[252:253], v[172:173] op_sel:[0,0,0] op_sel_hi:[0,1,1]
    v_pk_fma_f32 v[174:175], v[38:39], v[254:255], v[174:175] op_sel:[0,0,0] op_sel_hi:[0,1,1]
    ds_write_b128 v82, v[172:175] offset:15616
    s_waitcnt lgkmcnt(10)
    v_pk_add_f32 v[192:193], v[192:193], v[196:197]
    v_pk_add_f32 v[200:201], v[200:201], v[204:205]
    v_pk_add_f32 v[194:195], v[194:195], v[198:199]
    v_pk_add_f32 v[202:203], v[202:203], v[206:207]
    v_pk_add_f32 v[54:55], v[54:55], v[192:193]
    v_pk_add_f32 v[74:75], v[74:75], v[194:195]
    v_pk_add_f32 v[192:193], v[54:55], v[200:201]
    v_pk_add_f32 v[194:195], v[74:75], v[202:203]
    buffer_store_dwordx4 v[192:195], v68, s[16:19], 0 offen sc1
    s_waitcnt lgkmcnt(0)
    s_barrier
    ds_read_b128 v[208:211], v64 offset:0
    ds_read_b128 v[212:215], v64 offset:20480
    ds_read_b128 v[216:219], v64 offset:40960
    ds_read_b128 v[220:223], v64 offset:61440
    ds_read_b128 v[224:227], v65 offset:0
    ds_read_b128 v[228:231], v65 offset:20480
    ds_read_b128 v[232:235], v65 offset:40960
    ds_read_b128 v[236:239], v65 offset:61440
    ds_read_b128 v[240:243], v66 offset:0
    ds_read_b128 v[244:247], v66 offset:20480
    ds_read_b128 v[248:251], v66 offset:40960
    ds_read_b128 v[252:255], v66 offset:61440
    s_waitcnt lgkmcnt(8)
    v_pk_add_f32 v[208:209], v[208:209], v[212:213]
    v_pk_add_f32 v[216:217], v[216:217], v[220:221]
    v_pk_add_f32 v[210:211], v[210:211], v[214:215]
    v_pk_add_f32 v[218:219], v[218:219], v[222:223]
    v_pk_add_f32 v[56:57], v[56:57], v[208:209]
    v_pk_add_f32 v[76:77], v[76:77], v[210:211]
    v_pk_add_f32 v[208:209], v[56:57], v[216:217]
    v_pk_add_f32 v[210:211], v[76:77], v[218:219]
    buffer_store_dwordx4 v[208:211], v69, s[16:19], 0 offen sc1
    s_waitcnt lgkmcnt(4)
    v_pk_add_f32 v[224:225], v[224:225], v[228:229]
    v_pk_add_f32 v[232:233], v[232:233], v[236:237]
    v_pk_add_f32 v[226:227], v[226:227], v[230:231]
    v_pk_add_f32 v[234:235], v[234:235], v[238:239]
    v_pk_add_f32 v[58:59], v[58:59], v[224:225]
    v_pk_add_f32 v[78:79], v[78:79], v[226:227]
    v_pk_add_f32 v[224:225], v[58:59], v[232:233]
    v_pk_add_f32 v[226:227], v[78:79], v[234:235]
    buffer_store_dwordx4 v[224:227], v70, s[16:19], 0 offen sc1
    s_waitcnt lgkmcnt(0)
    v_pk_add_f32 v[240:241], v[240:241], v[244:245]
    v_pk_add_f32 v[248:249], v[248:249], v[252:253]
    v_pk_add_f32 v[242:243], v[242:243], v[246:247]
    v_pk_add_f32 v[250:251], v[250:251], v[254:255]
    v_pk_add_f32 v[60:61], v[60:61], v[240:241]
    v_pk_add_f32 v[80:81], v[80:81], v[242:243]
    v_pk_add_f32 v[240:241], v[60:61], v[248:249]
    v_pk_add_f32 v[242:243], v[80:81], v[250:251]
    buffer_store_dwordx4 v[240:243], v71, s[16:19], 0 offen sc1
    s_branch L_end
L_typeA:
    s_bitcmp1_b32 s86, 0
    s_cselect_b64 s[66:67], -1, 0
    s_bitcmp1_b32 s86, 1
    s_cselect_b64 s[68:69], -1, 0
    s_bitcmp1_b32 s86, 0
    s_cselect_b32 s92, s16, s14
    s_cselect_b32 s93, s17, s15
    s_mul_i32 s40, s88, 102400
    s_add_u32 s92, s92, s40
    s_addc_u32 s93, s93, 0
    s_mov_b32 s94, 102400
    s_mov_b32 s95, 0x20000
    s_lshr_b32 s91, s86, 1
    s_lshl_b32 s91, s91, 7
    s_mov_b64 s[26:27], s[12:13]
    s_waitcnt vmcnt(8)
    s_barrier
    v_lshlrev_b32 v48, 1, v79
    v_add_u32 v48, 161792, v48
    ds_read_u16 v72, v48 offset:0
    ds_read_u16 v73, v48 offset:128
    ds_read_u16 v74, v48 offset:256
    ds_read_u16 v75, v48 offset:64
    ds_read_u16 v76, v48 offset:192
    ds_read_u16 v77, v48 offset:320
    v_add_u32 v83, s70, v82
    ds_read_b32 v52, v83
    v_add_u32 v83, s71, v82
    ds_read_b32 v53, v83
    v_add_u32 v83, s72, v82
    ds_read_b32 v54, v83
    v_add_u32 v83, s73, v82
    ds_read_b32 v55, v83
    v_add_u32 v83, s74, v82
    ds_read_b32 v56, v83
    v_add_u32 v83, s75, v82
    ds_read_b32 v57, v83
    v_add_u32 v83, s76, v82
    ds_read_b32 v58, v83
    v_add_u32 v83, s77, v82
    ds_read_b32 v59, v83
    v_add_u32 v83, s78, v82
    ds_read_b32 v60, v83
    v_add_u32 v83, s79, v82
    ds_read_b32 v61, v83
    s_waitcnt lgkmcnt(10)
    v_lshlrev_b32 v72, 16, v72
    v_lshlrev_b32 v73, 16, v73
    v_lshlrev_b32 v74, 16, v74
    v_mul_f32 v48, 0x3fb8aa3b, v74
    v_exp_f32 v48, v48
    v_mul_f32 v244, v72, v72
    v_cvt_pk_bf16_f32 v48, v48, v48
    v_lshlrev_b32 v48, 16, v48
    v_mul_f32 v49, v48, v73
    v_mul_f32 v48, v48, v72
    v_mul_f32 v49, 0.15915494, v49
    v_mul_f32 v48, 0x3fb8aa3b, v48
    v_fract_f32 v49, v49
    v_exp_f32 v48, v48
    v_cos_f32 v50, v49
    s_add_u32 m0, s43, 32768
    s_mul_i32 s61, s71, s63
    buffer_load_dwordx4 v4, s[44:47], s71 offen offset:0 lds
    v_sin_f32 v51, v49
    v_fmac_f32 v244, v73, v73
    v_mul_f32 v240, v48, v50
    v_mul_f32 v241, v48, v51
    v_rcp_f32 v48, v244
    v_add_f32 v50, -1.0, v240
    v_mul_f32 v242, v50, v72
    v_mul_f32 v243, v241, v72
    v_fmac_f32 v242, v241, v73
    v_fma_f32 v243, -v50, v73, v243
    v_mul_f32 v242, v242, v48
    v_mul_f32 v243, v243, v48
    v_mov_b32 v208, v240
    v_mov_b32 v224, v241
    v_mul_f32 v209, v208, v240
    v_mul_f32 v225, v208, v241
    buffer_load_dwordx4 v5, s[44:47], s71 offen offset:1024 lds
    v_fma_f32 v209, -v224, v241, v209
    v_fmac_f32 v225, v224, v240
    v_mul_f32 v210, v209, v240
    v_mul_f32 v226, v209, v241
    v_fma_f32 v210, -v225, v241, v210
    v_fmac_f32 v226, v225, v240
    v_mul_f32 v211, v210, v240
    v_mul_f32 v227, v210, v241
    v_fma_f32 v211, -v226, v241, v211
    v_fmac_f32 v227, v226, v240
    v_mul_f32 v212, v211, v240
    v_mul_f32 v228, v211, v241
    v_fma_f32 v212, -v227, v241, v212
    v_fmac_f32 v228, v227, v240
    v_mul_f32 v213, v212, v240
    v_mul_f32 v229, v212, v241
    buffer_load_dwordx4 v6, s[44:47], s71 offen offset:2048 lds
    v_fma_f32 v213, -v228, v241, v213
    v_fmac_f32 v229, v228, v240
    v_mul_f32 v214, v213, v240
    v_mul_f32 v230, v213, v241
    v_fma_f32 v214, -v229, v241, v214
    v_fmac_f32 v230, v229, v240
    v_mul_f32 v215, v214, v240
    v_mul_f32 v231, v214, v241
    v_fma_f32 v215, -v230, v241, v215
    v_fmac_f32 v231, v230, v240
    v_mul_f32 v216, v215, v240
    v_mul_f32 v232, v215, v241
    v_fma_f32 v216, -v231, v241, v216
    v_lshlrev_b32 v75, 16, v75
    v_lshlrev_b32 v76, 16, v76
    v_lshlrev_b32 v77, 16, v77
    buffer_load_dwordx4 v7, s[44:47], s71 offen offset:3072 lds
    v_mul_f32 v48, 0x3fb8aa3b, v77
    v_exp_f32 v48, v48
    v_mul_f32 v164, v75, v75
    v_cvt_pk_bf16_f32 v48, v48, v48
    v_lshlrev_b32 v48, 16, v48
    v_mul_f32 v49, v48, v76
    v_mul_f32 v48, v48, v75
    v_mul_f32 v49, 0.15915494, v49
    v_mul_f32 v48, 0x3fb8aa3b, v48
    v_fract_f32 v49, v49
    v_exp_f32 v48, v48
    v_cos_f32 v50, v49
    v_sin_f32 v51, v49
    v_fmac_f32 v164, v76, v76
    v_mul_f32 v160, v48, v50
    v_mul_f32 v161, v48, v51
    s_add_u32 m0, s43, 36864
    s_nop 0
    buffer_load_dwordx4 v10, s[48:51], s61 offen offset:0 lds
    v_rcp_f32 v48, v164
    v_add_f32 v50, -1.0, v160
    v_mul_f32 v162, v50, v75
    v_mul_f32 v163, v161, v75
    v_fmac_f32 v162, v161, v76
    v_fma_f32 v163, -v50, v76, v163
    v_mul_f32 v162, v162, v48
    v_mul_f32 v163, v163, v48
    v_mov_b32 v128, v160
    v_mov_b32 v144, v161
    v_mul_f32 v129, v128, v160
    v_mul_f32 v145, v128, v161
    v_fma_f32 v129, -v144, v161, v129
    v_fmac_f32 v145, v144, v160
    v_mul_f32 v130, v129, v160
    v_mul_f32 v146, v129, v161
    buffer_load_dwordx4 v11, s[48:51], s61 offen offset:1024 lds
    v_fma_f32 v130, -v145, v161, v130
    v_fmac_f32 v146, v145, v160
    v_mul_f32 v131, v130, v160
    v_mul_f32 v147, v130, v161
    v_fma_f32 v131, -v146, v161, v131
    v_fmac_f32 v147, v146, v160
    v_mul_f32 v132, v131, v160
    v_mul_f32 v148, v131, v161
    v_fma_f32 v132, -v147, v161, v132
    v_fmac_f32 v148, v147, v160
    v_mul_f32 v133, v132, v160
    v_mul_f32 v149, v132, v161
    v_fma_f32 v133, -v148, v161, v133
    v_fmac_f32 v149, v148, v160
    v_mul_f32 v134, v133, v160
    v_mul_f32 v150, v133, v161
    buffer_load_dwordx4 v10, s[52:55], s61 offen offset:2048 lds
    v_fma_f32 v134, -v149, v161, v134
    v_fmac_f32 v150, v149, v160
    v_mul_f32 v135, v134, v160
    v_mul_f32 v151, v134, v161
    v_fma_f32 v135, -v150, v161, v135
    v_fmac_f32 v151, v150, v160
    v_mul_f32 v136, v135, v160
    v_mul_f32 v152, v135, v161
    v_fma_f32 v136, -v151, v161, v136
    buffer_load_dwordx4 v11, s[52:55], s61 offen offset:3072 lds
    v_add_u32 v72, 131072, v12
    v_add_u32 v73, 131072, v13
    v_add_u32 v74, 131072, v14
    v_add_u32 v75, 131072, v15
    v_add_u32 v78, 131072, v80
    v_add_u32 v68, 131072, v20
    v_add_u32 v69, 131072, v21
    v_add_u32 v70, 131072, v22
    v_add_u32 v71, 131072, v23
    s_waitcnt vmcnt(8) lgkmcnt(0)
    s_barrier
    ds_read_b128 a[0:3], v12 offset:0
    ds_read_b128 a[160:163], v20 offset:4096
    ds_read_b128 a[164:167], v20 offset:20480
    ds_read_b128 a[168:171], v20 offset:6144
    ds_read_b128 a[172:175], v20 offset:22528
    ds_read_b128 a[4:7], v13 offset:0
    ds_read_b128 a[176:179], v21 offset:4096
    ds_read_b128 a[180:183], v21 offset:20480
    ds_read_b128 a[184:187], v21 offset:6144
    ds_read_b128 a[188:191], v21 offset:22528
    ds_read_b32 v84, v80 offset:0
    s_waitcnt lgkmcnt(6)
    v_mfma_f32_32x32x16_bf16 v[176:191], a[0:3], a[160:163], 0
    ds_read_b128 a[8:11], v14 offset:0
    ds_read_b128 a[192:195], v22 offset:4096
    s_add_u32 m0, s43, 65536
    s_mul_i32 s61, s72, s63
    buffer_load_dwordx4 v4, s[44:47], s72 offen offset:0 lds
    s_waitcnt lgkmcnt(2)
    v_mfma_f32_32x32x16_bf16 v[192:207], a[0:3], a[164:167], 0
    ds_read_b128 a[196:199], v22 offset:20480
    buffer_load_dwordx4 v5, s[44:47], s72 offen offset:1024 lds
    v_lshlrev_b32 v90, 16, v84
    v_lshlrev_b32 v91, 16, v52
    v_mfma_f32_32x32x16_bf16 v[96:111], a[0:3], a[168:171], 0
    ds_read_b128 a[200:203], v22 offset:6144
    buffer_load_dwordx4 v6, s[44:47], s72 offen offset:2048 lds
    v_and_b32 v84, 0xffff0000, v84
    v_and_b32 v52, 0xffff0000, v52
    v_fmac_f32 v232, v231, v240
    v_mul_f32 v217, v216, v240
    v_mfma_f32_32x32x16_bf16 v[112:127], a[0:3], a[172:175], 0
    ds_read_b128 a[204:207], v22 offset:22528
    buffer_load_dwordx4 v7, s[44:47], s72 offen offset:3072 lds
    s_add_u32 m0, s43, 69632
    v_mul_f32 v90, v90, v91
    v_mul_f32 v84, v84, v52
    v_mul_f32 v233, v216, v241
    v_mfma_f32_32x32x16_bf16 v[176:191], a[4:7], a[176:179], v[176:191]
    ds_read_b128 a[12:15], v15 offset:0
    ds_read_b128 a[160:163], v23 offset:4096
    buffer_load_dwordx4 v10, s[48:51], s61 offen offset:0 lds
    v_cvt_pk_bf16_f32 v90, v90, v84
    v_lshlrev_b32 v91, 16, v90
    v_fma_f32 v217, -v232, v241, v217
    v_mfma_f32_32x32x16_bf16 v[192:207], a[4:7], a[180:183], v[192:207]
    ds_read_b128 a[164:167], v23 offset:20480
    buffer_load_dwordx4 v11, s[48:51], s61 offen offset:1024 lds
    v_and_b32 v90, 0xffff0000, v90
    v_add_f32 v88, v88, v91
    v_fmac_f32 v233, v232, v240
    v_mul_f32 v218, v217, v240
    v_mfma_f32_32x32x16_bf16 v[96:111], a[4:7], a[184:187], v[96:111]
    ds_read_b128 a[168:171], v23 offset:6144
    buffer_load_dwordx4 v10, s[52:55], s61 offen offset:2048 lds
    v_add_f32 v88, v88, v90
    v_mul_f32 v234, v217, v241
    v_fma_f32 v218, -v233, v241, v218
    v_mfma_f32_32x32x16_bf16 v[112:127], a[4:7], a[188:191], v[112:127]
    ds_read_b128 a[172:175], v23 offset:22528
    buffer_load_dwordx4 v11, s[52:55], s61 offen offset:3072 lds
    s_add_u32 m0, s43, 98304
    s_mul_i32 s61, s73, s63
    v_fmac_f32 v234, v233, v240
    v_mul_f32 v219, v218, v240
    s_waitcnt vmcnt(8)
    s_barrier
    s_waitcnt lgkmcnt(5)
    v_mfma_f32_32x32x16_bf16 v[176:191], a[8:11], a[192:195], v[176:191]
    ds_read_b32 v86, v80 offset:32768
    ds_read_b128 a[16:19], v12 offset:32768
    buffer_load_dwordx4 v4, s[44:47], s73 offen offset:0 lds
    v_mul_f32 v235, v218, v241
    v_fma_f32 v219, -v234, v241, v219
    v_mfma_f32_32x32x16_bf16 v[192:207], a[8:11], a[196:199], v[192:207]
    ds_read_b128 a[176:179], v20 offset:36864
    ds_read_b128 a[180:183], v20 offset:53248
    buffer_load_dwordx4 v5, s[44:47], s73 offen offset:1024 lds
    v_fmac_f32 v235, v234, v240
    v_mul_f32 v220, v219, v240
    v_mfma_f32_32x32x16_bf16 v[96:111], a[8:11], a[200:203], v[96:111]
    ds_read_b128 a[184:187], v20 offset:38912
    buffer_load_dwordx4 v6, s[44:47], s73 offen offset:2048 lds
    v_mul_f32 v236, v219, v241
    v_fma_f32 v220, -v235, v241, v220
    v_mfma_f32_32x32x16_bf16 v[112:127], a[8:11], a[204:207], v[112:127]
    ds_read_b128 a[188:191], v20 offset:55296
    buffer_load_dwordx4 v7, s[44:47], s73 offen offset:3072 lds
    s_add_u32 m0, s43, 102400
    v_fmac_f32 v236, v235, v240
    v_mul_f32 v221, v220, v240
    s_waitcnt lgkmcnt(6)
    v_mfma_f32_32x32x16_bf16 v[176:191], a[12:15], a[160:163], v[176:191]
    ds_read_b128 a[20:23], v13 offset:32768
    ds_read_b128 a[192:195], v21 offset:36864
    buffer_load_dwordx4 v10, s[48:51], s61 offen offset:0 lds
    v_mul_f32 v237, v220, v241
    v_fma_f32 v221, -v236, v241, v221
    v_mfma_f32_32x32x16_bf16 v[192:207], a[12:15], a[164:167], v[192:207]
    ds_read_b128 a[196:199], v21 offset:53248
    buffer_load_dwordx4 v11, s[48:51], s61 offen offset:1024 lds
    s_waitcnt lgkmcnt(8)
    v_lshlrev_b32 v90, 16, v86
    v_fmac_f32 v237, v236, v240
    v_mul_f32 v222, v221, v240
    v_mfma_f32_32x32x16_bf16 v[96:111], a[12:15], a[168:171], v[96:111]
    ds_read_b128 a[200:203], v21 offset:38912
    buffer_load_dwordx4 v10, s[52:55], s61 offen offset:2048 lds
    v_lshlrev_b32 v91, 16, v53
    v_and_b32 v86, 0xffff0000, v86
    v_mul_f32 v238, v221, v241
    v_fma_f32 v222, -v237, v241, v222
    v_mfma_f32_32x32x16_bf16 v[112:127], a[12:15], a[172:175], v[112:127]
    ds_read_b128 a[204:207], v21 offset:55296
    buffer_load_dwordx4 v11, s[52:55], s61 offen offset:3072 lds
    s_add_u32 m0, s43, 131072
    s_mul_i32 s61, s74, s63
    v_and_b32 v53, 0xffff0000, v53
    v_mul_f32 v90, v90, v91
    s_waitcnt lgkmcnt(5)
    v_mfma_f32_32x32x16_bf16 v[176:191], a[16:19], a[176:179], v[176:191]
    ds_read_b128 a[24:27], v14 offset:32768
    ds_read_b128 a[160:163], v22 offset:36864
    buffer_load_dwordx4 v4, s[44:47], s74 offen offset:0 lds
    v_mul_f32 v86, v86, v53
    v_cvt_pk_bf16_f32 v90, v90, v86
    v_fmac_f32 v238, v237, v240
    v_mfma_f32_32x32x16_bf16 v[192:207], a[16:19], a[180:183], v[192:207]
    ds_read_b128 a[164:167], v22 offset:53248
    buffer_load_dwordx4 v5, s[44:47], s74 offen offset:1024 lds
    v_lshlrev_b32 v91, 16, v90
    v_and_b32 v90, 0xffff0000, v90
    v_mul_f32 v223, v222, v240
    v_mul_f32 v239, v222, v241
    v_mfma_f32_32x32x16_bf16 v[96:111], a[16:19], a[184:187], v[96:111]
    ds_read_b128 a[168:171], v22 offset:38912
    buffer_load_dwordx4 v6, s[44:47], s74 offen offset:2048 lds
    v_add_f32 v88, v88, v91
    v_add_f32 v88, v88, v90
    v_fma_f32 v223, -v238, v241, v223
    v_fmac_f32 v239, v238, v240
    v_mfma_f32_32x32x16_bf16 v[112:127], a[16:19], a[188:191], v[112:127]
    ds_read_b128 a[172:175], v22 offset:55296
    buffer_load_dwordx4 v7, s[44:47], s74 offen offset:3072 lds
    s_add_u32 m0, s43, 135168
    v_cmp_eq_u32 s[12:13], 1, v3
    v_mov_b32 v244, v223
    s_waitcnt lgkmcnt(5)
    v_mfma_f32_32x32x16_bf16 v[176:191], a[20:23], a[192:195], v[176:191]
    ds_read_b128 a[28:31], v15 offset:32768
    ds_read_b128 a[176:179], v23 offset:36864
    buffer_load_dwordx4 v10, s[48:51], s61 offen offset:0 lds
    v_mov_b32 v245, v239
    v_cndmask_b32 v50, 1.0, v244, s[12:13]
    v_mfma_f32_32x32x16_bf16 v[192:207], a[20:23], a[196:199], v[192:207]
    ds_read_b128 a[180:183], v23 offset:53248
    buffer_load_dwordx4 v11, s[48:51], s61 offen offset:1024 lds
    v_cndmask_b32 v51, 0, v245, s[12:13]
    v_mul_f32 v246, v242, v50
    v_mfma_f32_32x32x16_bf16 v[96:111], a[20:23], a[200:203], v[96:111]
    ds_read_b128 a[184:187], v23 offset:38912
    buffer_load_dwordx4 v10, s[52:55], s61 offen offset:2048 lds
    v_mul_f32 v247, v242, v51
    v_fma_f32 v246, -v243, v51, v246
    v_mfma_f32_32x32x16_bf16 v[112:127], a[20:23], a[204:207], v[112:127]
    ds_read_b128 a[188:191], v23 offset:55296
    buffer_load_dwordx4 v11, s[52:55], s61 offen offset:3072 lds
    v_fmac_f32 v247, v243, v50
    v_mul_f32 v48, v244, v244
    s_waitcnt vmcnt(16)
    s_barrier
    s_waitcnt lgkmcnt(5)
    v_mfma_f32_32x32x16_bf16 v[176:191], a[24:27], a[160:163], v[176:191]
    ds_read_b32 v84, v81 offset:0
    ds_read_b128 a[32:35], v16 offset:0
    v_add_f32 v49, v244, v244
    v_fma_f32 v48, -v245, v245, v48
    v_mfma_f32_32x32x16_bf16 v[192:207], a[24:27], a[164:167], v[192:207]
    ds_read_b128 a[192:195], v24 offset:4096
    ds_read_b128 a[196:199], v24 offset:20480
    s_add_u32 m0, s43, 0
    s_mul_i32 s61, s75, s63
    buffer_load_dwordx4 v4, s[44:47], s75 offen offset:0 lds
    v_mul_f32 v49, v49, v245
    v_mfma_f32_32x32x16_bf16 v[96:111], a[24:27], a[168:171], v[96:111]
    ds_read_b128 a[200:203], v24 offset:6144
    v_cndmask_b32 v50, 1.0, v48, s[66:67]
    v_cndmask_b32 v51, 0, v49, s[66:67]
    v_mfma_f32_32x32x16_bf16 v[112:127], a[24:27], a[172:175], v[112:127]
    ds_read_b128 a[204:207], v24 offset:22528
    buffer_load_dwordx4 v5, s[44:47], s75 offen offset:1024 lds
    v_mul_f32 v252, v246, v50
    v_mul_f32 v253, v246, v51
    s_waitcnt lgkmcnt(6)
    v_mfma_f32_32x32x16_bf16 v[176:191], a[28:31], a[176:179], v[176:191]
    ds_read_b128 a[36:39], v17 offset:0
    ds_read_b128 a[160:163], v25 offset:4096
    global_load_dword v46, v45, s[36:37] sc1
    v_fma_f32 v252, -v247, v51, v252
    v_fmac_f32 v253, v247, v50
    v_mfma_f32_32x32x16_bf16 v[192:207], a[28:31], a[180:183], v[192:207]
    ds_read_b128 a[164:167], v25 offset:20480
    buffer_load_dwordx4 v6, s[44:47], s75 offen offset:2048 lds
    s_waitcnt lgkmcnt(8)
    v_lshlrev_b32 v90, 16, v84
    v_mul_f32 v248, v48, v48
    v_add_f32 v249, v48, v48
    v_mfma_f32_32x32x16_bf16 v[96:111], a[28:31], a[184:187], v[96:111]
    ds_read_b128 a[168:171], v25 offset:6144
    v_lshlrev_b32 v91, 16, v54
    v_and_b32 v84, 0xffff0000, v84
    v_fma_f32 v248, -v49, v49, v248
    v_mul_f32 v249, v249, v49
    v_mfma_f32_32x32x16_bf16 v[112:127], a[28:31], a[188:191], v[112:127]
    ds_read_b128 a[172:175], v25 offset:22528
    buffer_load_dwordx4 v7, s[44:47], s75 offen offset:3072 lds
    s_add_u32 m0, s43, 4096
    v_and_b32 v54, 0xffff0000, v54
    v_mul_f32 v90, v90, v91
    v_cndmask_b32 v50, 1.0, v248, s[68:69]
    s_waitcnt lgkmcnt(5)
    v_mfma_f32_32x32x16_bf16 v[176:191], a[32:35], a[192:195], v[176:191]
    ds_read_b128 a[40:43], v18 offset:0
    ds_read_b128 a[176:179], v26 offset:4096
    v_mul_f32 v84, v84, v54
    v_cvt_pk_bf16_f32 v90, v90, v84
    v_cndmask_b32 v51, 0, v249, s[68:69]
    v_mul_f32 v246, v252, v50
    v_mfma_f32_32x32x16_bf16 v[192:207], a[32:35], a[196:199], v[192:207]
    ds_read_b128 a[180:183], v26 offset:20480
    buffer_load_dwordx4 v10, s[48:51], s61 offen offset:0 lds
    v_lshlrev_b32 v91, 16, v90
    v_and_b32 v90, 0xffff0000, v90
    v_mul_f32 v247, v252, v51
    v_fma_f32 v246, -v253, v51, v246
    v_mfma_f32_32x32x16_bf16 v[96:111], a[32:35], a[200:203], v[96:111]
    ds_read_b128 a[184:187], v26 offset:6144
    v_add_f32 v88, v88, v91
    v_add_f32 v88, v88, v90
    v_fmac_f32 v247, v253, v50
    v_mul_f32 v48, v248, v248
    v_mfma_f32_32x32x16_bf16 v[112:127], a[32:35], a[204:207], v[112:127]
    ds_read_b128 a[188:191], v26 offset:22528
    buffer_load_dwordx4 v11, s[48:51], s61 offen offset:1024 lds
    v_add_f32 v49, v248, v248
    s_waitcnt lgkmcnt(5)
    v_mfma_f32_32x32x16_bf16 v[176:191], a[36:39], a[160:163], v[176:191]
    ds_read_b128 a[44:47], v19 offset:0
    ds_read_b128 a[192:195], v27 offset:4096
    v_fma_f32 v48, -v249, v249, v48
    v_mfma_f32_32x32x16_bf16 v[192:207], a[36:39], a[164:167], v[192:207]
    ds_read_b128 a[196:199], v27 offset:20480
    buffer_load_dwordx4 v10, s[52:55], s61 offen offset:2048 lds
    v_mul_f32 v49, v49, v249
    v_mfma_f32_32x32x16_bf16 v[96:111], a[36:39], a[168:171], v[96:111]
    ds_read_b128 a[200:203], v27 offset:6144
    v_cndmask_b32 v250, 1.0, v48, s[12:13]
    v_mfma_f32_32x32x16_bf16 v[112:127], a[36:39], a[172:175], v[112:127]
    ds_read_b128 a[204:207], v27 offset:22528
    buffer_load_dwordx4 v11, s[52:55], s61 offen offset:3072 lds
    v_cndmask_b32 v251, 0, v49, s[12:13]
    s_waitcnt vmcnt(17)
    s_barrier
    s_waitcnt lgkmcnt(5)
    v_mfma_f32_32x32x16_bf16 v[176:191], a[40:43], a[176:179], v[176:191]
    ds_read_b32 v86, v81 offset:32768
    ds_read_b128 a[48:51], v16 offset:32768
    v_mul_f32 v248, v48, v48
    v_mfma_f32_32x32x16_bf16 v[192:207], a[40:43], a[180:183], v[192:207]
    ds_read_b128 a[160:163], v24 offset:36864
    ds_read_b128 a[164:167], v24 offset:53248
    s_add_u32 m0, s43, 32768
    s_mul_i32 s61, s76, s63
    buffer_load_dwordx4 v4, s[44:47], s76 offen offset:0 lds
    v_add_f32 v249, v48, v48
    v_mfma_f32_32x32x16_bf16 v[96:111], a[40:43], a[184:187], v[96:111]
    ds_read_b128 a[168:171], v24 offset:38912
    v_fma_f32 v248, -v49, v49, v248
    v_mfma_f32_32x32x16_bf16 v[112:127], a[40:43], a[188:191], v[112:127]
    ds_read_b128 a[172:175], v24 offset:55296
    buffer_load_dwordx4 v5, s[44:47], s76 offen offset:1024 lds
    v_mul_f32 v249, v249, v49
    s_waitcnt lgkmcnt(6)
    v_mfma_f32_32x32x16_bf16 v[176:191], a[44:47], a[192:195], v[176:191]
    ds_read_b128 a[52:55], v17 offset:32768
    ds_read_b128 a[176:179], v25 offset:36864
    v_mul_f32 v48, v248, v248
    v_mfma_f32_32x32x16_bf16 v[192:207], a[44:47], a[196:199], v[192:207]
    ds_read_b128 a[180:183], v25 offset:53248
    buffer_load_dwordx4 v6, s[44:47], s76 offen offset:2048 lds
    s_waitcnt lgkmcnt(8)
    v_lshlrev_b32 v90, 16, v86
    v_add_f32 v49, v248, v248
    v_mfma_f32_32x32x16_bf16 v[96:111], a[44:47], a[200:203], v[96:111]
    ds_read_b128 a[184:187], v25 offset:38912
    v_lshlrev_b32 v91, 16, v55
    v_and_b32 v86, 0xffff0000, v86
    v_fma_f32 v48, -v249, v249, v48
    v_mfma_f32_32x32x16_bf16 v[112:127], a[44:47], a[204:207], v[112:127]
    ds_read_b128 a[188:191], v25 offset:55296
    buffer_load_dwordx4 v7, s[44:47], s76 offen offset:3072 lds
    s_add_u32 m0, s43, 36864
    v_and_b32 v55, 0xffff0000, v55
    v_mul_f32 v90, v90, v91
    v_mul_f32 v49, v49, v249
    s_waitcnt lgkmcnt(5)
    v_mfma_f32_32x32x16_bf16 v[176:191], a[48:51], a[160:163], v[176:191]
    ds_read_b128 a[56:59], v18 offset:32768
    ds_read_b128 a[192:195], v26 offset:36864
    v_mul_f32 v86, v86, v55
    v_cvt_pk_bf16_f32 v90, v90, v86
    v_cndmask_b32 v50, 1.0, v48, s[66:67]
    v_mfma_f32_32x32x16_bf16 v[192:207], a[48:51], a[164:167], v[192:207]
    ds_read_b128 a[196:199], v26 offset:53248
    buffer_load_dwordx4 v10, s[48:51], s61 offen offset:0 lds
    v_lshlrev_b32 v91, 16, v90
    v_and_b32 v90, 0xffff0000, v90
    v_cndmask_b32 v51, 0, v49, s[66:67]
    v_mfma_f32_32x32x16_bf16 v[96:111], a[48:51], a[168:171], v[96:111]
    ds_read_b128 a[200:203], v26 offset:38912
    v_add_f32 v88, v88, v91
    v_add_f32 v88, v88, v90
    v_mul_f32 v252, v250, v50
    v_mfma_f32_32x32x16_bf16 v[112:127], a[48:51], a[172:175], v[112:127]
    ds_read_b128 a[204:207], v26 offset:55296
    buffer_load_dwordx4 v11, s[48:51], s61 offen offset:1024 lds
    v_mul_f32 v253, v250, v51
    s_waitcnt lgkmcnt(5)
    v_mfma_f32_32x32x16_bf16 v[176:191], a[52:55], a[176:179], v[176:191]
    ds_read_b128 a[60:63], v19 offset:32768
    ds_read_b128 a[160:163], v27 offset:36864
    v_fma_f32 v252, -v251, v51, v252
    v_mfma_f32_32x32x16_bf16 v[192:207], a[52:55], a[180:183], v[192:207]
    ds_read_b128 a[164:167], v27 offset:53248
    buffer_load_dwordx4 v10, s[52:55], s61 offen offset:2048 lds
    v_fmac_f32 v253, v251, v50
    v_mfma_f32_32x32x16_bf16 v[96:111], a[52:55], a[184:187], v[96:111]
    ds_read_b128 a[168:171], v27 offset:38912
    v_mul_f32 v50, v48, v48
    v_mfma_f32_32x32x16_bf16 v[112:127], a[52:55], a[188:191], v[112:127]
    ds_read_b128 a[172:175], v27 offset:55296
    buffer_load_dwordx4 v11, s[52:55], s61 offen offset:3072 lds
    v_add_f32 v51, v48, v48
    s_waitcnt vmcnt(17)
    s_barrier
    s_waitcnt lgkmcnt(5)
    v_mfma_f32_32x32x16_bf16 v[176:191], a[56:59], a[192:195], v[176:191]
    ds_read_b32 v84, v78 offset:0
    ds_read_b128 a[64:67], v72 offset:0
    v_fma_f32 v50, -v49, v49, v50
    v_mfma_f32_32x32x16_bf16 v[192:207], a[56:59], a[196:199], v[192:207]
    ds_read_b128 a[176:179], v68 offset:4096
    ds_read_b128 a[180:183], v68 offset:20480
    s_add_u32 m0, s43, 65536
    s_mul_i32 s61, s77, s63
    buffer_load_dwordx4 v4, s[44:47], s77 offen offset:0 lds
    v_mul_f32 v51, v51, v49
    v_mfma_f32_32x32x16_bf16 v[96:111], a[56:59], a[200:203], v[96:111]
    ds_read_b128 a[184:187], v68 offset:6144
    v_cndmask_b32 v50, 1.0, v50, s[68:69]
    v_mfma_f32_32x32x16_bf16 v[112:127], a[56:59], a[204:207], v[112:127]
    ds_read_b128 a[188:191], v68 offset:22528
    buffer_load_dwordx4 v5, s[44:47], s77 offen offset:1024 lds
    v_cndmask_b32 v51, 0, v51, s[68:69]
    s_waitcnt lgkmcnt(6)
    v_mfma_f32_32x32x16_bf16 v[176:191], a[60:63], a[160:163], v[176:191]
    ds_read_b128 a[68:71], v73 offset:0
    ds_read_b128 a[192:195], v69 offset:4096
    v_mul_f32 v250, v252, v50
    v_mfma_f32_32x32x16_bf16 v[192:207], a[60:63], a[164:167], v[192:207]
    ds_read_b128 a[196:199], v69 offset:20480
    buffer_load_dwordx4 v6, s[44:47], s77 offen offset:2048 lds
    s_waitcnt lgkmcnt(8)
    v_lshlrev_b32 v90, 16, v84
    v_mul_f32 v251, v252, v51
    v_mfma_f32_32x32x16_bf16 v[96:111], a[60:63], a[168:171], v[96:111]
    ds_read_b128 a[200:203], v69 offset:6144
    v_lshlrev_b32 v91, 16, v56
    v_and_b32 v84, 0xffff0000, v84
    v_fma_f32 v250, -v253, v51, v250
    v_mfma_f32_32x32x16_bf16 v[112:127], a[60:63], a[172:175], v[112:127]
    ds_read_b128 a[204:207], v69 offset:22528
    buffer_load_dwordx4 v7, s[44:47], s77 offen offset:3072 lds
    s_add_u32 m0, s43, 69632
    v_and_b32 v56, 0xffff0000, v56
    v_mul_f32 v90, v90, v91
    v_fmac_f32 v251, v253, v50
    s_waitcnt lgkmcnt(5)
    v_mfma_f32_32x32x16_bf16 v[176:191], a[64:67], a[176:179], v[176:191]
    ds_read_b128 a[72:75], v74 offset:0
    ds_read_b128 a[160:163], v70 offset:4096
    v_mul_f32 v84, v84, v56
    v_cvt_pk_bf16_f32 v90, v90, v84
    v_lshl_add_u32 v254, v2, 1, v3
    v_mfma_f32_32x32x16_bf16 v[192:207], a[64:67], a[180:183], v[192:207]
    ds_read_b128 a[164:167], v70 offset:20480
    buffer_load_dwordx4 v10, s[48:51], s61 offen offset:0 lds
    v_lshlrev_b32 v91, 16, v90
    v_and_b32 v90, 0xffff0000, v90
    v_mov_b32 v252, 0
    v_mfma_f32_32x32x16_bf16 v[96:111], a[64:67], a[184:187], v[96:111]
    ds_read_b128 a[168:171], v70 offset:6144
    v_add_f32 v88, v88, v91
    v_add_f32 v88, v88, v90
    v_mov_b32 v253, 0
    v_mfma_f32_32x32x16_bf16 v[112:127], a[64:67], a[188:191], v[112:127]
    ds_read_b128 a[172:175], v70 offset:22528
    buffer_load_dwordx4 v11, s[48:51], s61 offen offset:1024 lds
    v_fmac_f32 v152, v151, v160
    s_waitcnt lgkmcnt(5)
    v_mfma_f32_32x32x16_bf16 v[176:191], a[68:71], a[192:195], v[176:191]
    ds_read_b128 a[76:79], v75 offset:0
    ds_read_b128 a[176:179], v71 offset:4096
    v_mul_f32 v137, v136, v160
    v_mfma_f32_32x32x16_bf16 v[192:207], a[68:71], a[196:199], v[192:207]
    ds_read_b128 a[180:183], v71 offset:20480
    buffer_load_dwordx4 v10, s[52:55], s61 offen offset:2048 lds
    v_mul_f32 v153, v136, v161
    v_mfma_f32_32x32x16_bf16 v[96:111], a[68:71], a[200:203], v[96:111]
    ds_read_b128 a[184:187], v71 offset:6144
    v_fma_f32 v137, -v152, v161, v137
    v_mfma_f32_32x32x16_bf16 v[112:127], a[68:71], a[204:207], v[112:127]
    ds_read_b128 a[188:191], v71 offset:22528
    buffer_load_dwordx4 v11, s[52:55], s61 offen offset:3072 lds
    v_fmac_f32 v153, v152, v160
    s_waitcnt vmcnt(16)
    s_barrier
    s_waitcnt lgkmcnt(5)
    v_mfma_f32_32x32x16_bf16 v[176:191], a[72:75], a[160:163], v[176:191]
    ds_read_b32 v86, v80 offset:0
    ds_read_b128 a[80:83], v12 offset:0
    s_add_u32 m0, s43, 98304
    s_mul_i32 s61, s78, s63
    buffer_load_dwordx4 v4, s[44:47], s78 offen offset:0 lds
    v_mul_f32 v138, v137, v160
    v_mfma_f32_32x32x16_bf16 v[192:207], a[72:75], a[164:167], v[192:207]
    ds_read_b128 a[192:195], v20 offset:4096
    ds_read_b128 a[196:199], v20 offset:20480
    buffer_load_dwordx4 v5, s[44:47], s78 offen offset:1024 lds
    v_mul_f32 v154, v137, v161
    v_mfma_f32_32x32x16_bf16 v[96:111], a[72:75], a[168:171], v[96:111]
    ds_read_b128 a[200:203], v20 offset:6144
    v_fma_f32 v138, -v153, v161, v138
    v_mfma_f32_32x32x16_bf16 v[112:127], a[72:75], a[172:175], v[112:127]
    ds_read_b128 a[204:207], v20 offset:22528
    buffer_load_dwordx4 v6, s[44:47], s78 offen offset:2048 lds
    v_fmac_f32 v154, v153, v160
    s_waitcnt lgkmcnt(6)
    v_mfma_f32_32x32x16_bf16 v[176:191], a[76:79], a[176:179], v[176:191]
    ds_read_b128 a[84:87], v13 offset:0
    ds_read_b128 a[160:163], v21 offset:4096
    v_mul_f32 v139, v138, v160
    v_mfma_f32_32x32x16_bf16 v[192:207], a[76:79], a[180:183], v[192:207]
    ds_read_b128 a[164:167], v21 offset:20480
    buffer_load_dwordx4 v7, s[44:47], s78 offen offset:3072 lds
    s_add_u32 m0, s43, 102400
    s_waitcnt lgkmcnt(8)
    v_lshlrev_b32 v90, 16, v86
    v_mul_f32 v155, v138, v161
    v_mfma_f32_32x32x16_bf16 v[96:111], a[76:79], a[184:187], v[96:111]
    ds_read_b128 a[168:171], v21 offset:6144
    v_lshlrev_b32 v91, 16, v57
    v_and_b32 v86, 0xffff0000, v86
    v_fma_f32 v139, -v154, v161, v139
    v_mfma_f32_32x32x16_bf16 v[112:127], a[76:79], a[188:191], v[112:127]
    ds_read_b128 a[172:175], v21 offset:22528
    buffer_load_dwordx4 v10, s[48:51], s61 offen offset:0 lds
    v_and_b32 v57, 0xffff0000, v57
    v_mul_f32 v90, v90, v91
    v_fmac_f32 v155, v154, v160
    s_waitcnt lgkmcnt(5)
    v_mfma_f32_32x32x16_bf16 v[176:191], a[80:83], a[192:195], v[176:191]
    ds_read_b128 a[88:91], v14 offset:0
    ds_read_b128 a[176:179], v22 offset:4096
    v_mul_f32 v86, v86, v57
    v_cvt_pk_bf16_f32 v90, v90, v86
    v_mul_f32 v140, v139, v160
    v_mfma_f32_32x32x16_bf16 v[192:207], a[80:83], a[196:199], v[192:207]
    ds_read_b128 a[180:183], v22 offset:20480
    buffer_load_dwordx4 v11, s[48:51], s61 offen offset:1024 lds
    v_lshlrev_b32 v91, 16, v90
    v_and_b32 v90, 0xffff0000, v90
    v_mul_f32 v156, v139, v161
    v_mfma_f32_32x32x16_bf16 v[96:111], a[80:83], a[200:203], v[96:111]
    ds_read_b128 a[184:187], v22 offset:6144
    v_add_f32 v88, v88, v91
    v_add_f32 v88, v88, v90
    v_fma_f32 v140, -v155, v161, v140
    v_mfma_f32_32x32x16_bf16 v[112:127], a[80:83], a[204:207], v[112:127]
    ds_read_b128 a[188:191], v22 offset:22528
    buffer_load_dwordx4 v10, s[52:55], s61 offen offset:2048 lds
    v_fmac_f32 v156, v155, v160
    s_waitcnt lgkmcnt(5)
    v_mfma_f32_32x32x16_bf16 v[176:191], a[84:87], a[160:163], v[176:191]
    ds_read_b128 a[92:95], v15 offset:0
    ds_read_b128 a[192:195], v23 offset:4096
    v_mul_f32 v141, v140, v160
    v_mfma_f32_32x32x16_bf16 v[192:207], a[84:87], a[164:167], v[192:207]
    ds_read_b128 a[196:199], v23 offset:20480
    buffer_load_dwordx4 v11, s[52:55], s61 offen offset:3072 lds
    v_mul_f32 v157, v140, v161
    v_mfma_f32_32x32x16_bf16 v[96:111], a[84:87], a[168:171], v[96:111]
    ds_read_b128 a[200:203], v23 offset:6144
    v_fma_f32 v141, -v156, v161, v141
    v_mfma_f32_32x32x16_bf16 v[112:127], a[84:87], a[172:175], v[112:127]
    ds_read_b128 a[204:207], v23 offset:22528
    s_lshr_b32 s65, s2, 1
    s_and_b32 s65, s65, 3
    s_lshl_b32 s65, s65, 3
    s_add_u32 s65, s65, s3
    s_lshl_b32 s65, s65, 1
    s_lshr_b32 s23, s86, 1
    s_add_u32 s65, s65, s23
    s_mul_i32 s65, s65, 3840
    s_mul_i32 s23, s81, 409600
    s_add_u32 s65, s65, s23
    s_add_u32 s65, s65, 163840
    s_bitcmp1_b32 s86, 0
    s_cselect_b32 s40, s26, s10
    s_cselect_b32 s41, s27, s11
    v_min_u32 v94, 29, v1
    v_lshl_add_u32 v94, v94, 7, s65
    global_load_dword v93, v94, s[40:41]
    v_fmac_f32 v157, v156, v160
    s_waitcnt vmcnt(17)
    s_barrier
    s_waitcnt lgkmcnt(5)
    v_mfma_f32_32x32x16_bf16 v[176:191], a[88:91], a[176:179], v[176:191]
    ds_read_b32 v84, v80 offset:32768
    ds_read_b128 a[96:99], v12 offset:32768
    v_mul_f32 v142, v141, v160
    v_mfma_f32_32x32x16_bf16 v[192:207], a[88:91], a[180:183], v[192:207]
    ds_read_b128 a[160:163], v20 offset:36864
    ds_read_b128 a[164:167], v20 offset:53248
    s_add_u32 m0, s43, 131072
    s_mul_i32 s61, s79, s63
    buffer_load_dwordx4 v4, s[44:47], s79 offen offset:0 lds
    v_mul_f32 v158, v141, v161
    v_mfma_f32_32x32x16_bf16 v[96:111], a[88:91], a[184:187], v[96:111]
    ds_read_b128 a[168:171], v20 offset:38912
    v_fma_f32 v142, -v157, v161, v142
    v_mfma_f32_32x32x16_bf16 v[112:127], a[88:91], a[188:191], v[112:127]
    ds_read_b128 a[172:175], v20 offset:55296
    buffer_load_dwordx4 v5, s[44:47], s79 offen offset:1024 lds
    v_fmac_f32 v158, v157, v160
    s_waitcnt lgkmcnt(6)
    v_mfma_f32_32x32x16_bf16 v[176:191], a[92:95], a[192:195], v[176:191]
    ds_read_b128 a[100:103], v13 offset:32768
    ds_read_b128 a[176:179], v21 offset:36864
    v_mul_f32 v143, v142, v160
    v_mfma_f32_32x32x16_bf16 v[192:207], a[92:95], a[196:199], v[192:207]
    ds_read_b128 a[180:183], v21 offset:53248
    buffer_load_dwordx4 v6, s[44:47], s79 offen offset:2048 lds
    s_waitcnt lgkmcnt(8)
    v_lshlrev_b32 v90, 16, v84
    v_mul_f32 v159, v142, v161
    v_mfma_f32_32x32x16_bf16 v[96:111], a[92:95], a[200:203], v[96:111]
    ds_read_b128 a[184:187], v21 offset:38912
    v_lshlrev_b32 v91, 16, v58
    v_and_b32 v84, 0xffff0000, v84
    v_fma_f32 v143, -v158, v161, v143
    v_mfma_f32_32x32x16_bf16 v[112:127], a[92:95], a[204:207], v[112:127]
    ds_read_b128 a[188:191], v21 offset:55296
    buffer_load_dwordx4 v7, s[44:47], s79 offen offset:3072 lds
    s_add_u32 m0, s43, 135168
    v_and_b32 v58, 0xffff0000, v58
    v_mul_f32 v90, v90, v91
    v_fmac_f32 v159, v158, v160
    s_waitcnt lgkmcnt(5)
    v_mfma_f32_32x32x16_bf16 v[176:191], a[96:99], a[160:163], v[176:191]
    ds_read_b128 a[104:107], v14 offset:32768
    ds_read_b128 a[192:195], v22 offset:36864
    v_mul_f32 v84, v84, v58
    v_cvt_pk_bf16_f32 v90, v90, v84
    v_cmp_eq_u32 s[12:13], 1, v3
    v_mfma_f32_32x32x16_bf16 v[192:207], a[96:99], a[164:167], v[192:207]
    ds_read_b128 a[196:199], v22 offset:53248
    buffer_load_dwordx4 v10, s[48:51], s61 offen offset:0 lds
    v_lshlrev_b32 v91, 16, v90
    v_and_b32 v90, 0xffff0000, v90
    v_mov_b32 v164, v143
    v_mfma_f32_32x32x16_bf16 v[96:111], a[96:99], a[168:171], v[96:111]
    ds_read_b128 a[200:203], v22 offset:38912
    v_add_f32 v88, v88, v91
    v_add_f32 v88, v88, v90
    v_mov_b32 v165, v159
    v_mfma_f32_32x32x16_bf16 v[112:127], a[96:99], a[172:175], v[112:127]
    ds_read_b128 a[204:207], v22 offset:55296
    buffer_load_dwordx4 v11, s[48:51], s61 offen offset:1024 lds
    v_cndmask_b32 v50, 1.0, v164, s[12:13]
    s_waitcnt lgkmcnt(5)
    v_mfma_f32_32x32x16_bf16 v[176:191], a[100:103], a[176:179], v[176:191]
    ds_read_b128 a[108:111], v15 offset:32768
    ds_read_b128 a[160:163], v23 offset:36864
    v_cndmask_b32 v51, 0, v165, s[12:13]
    v_mfma_f32_32x32x16_bf16 v[192:207], a[100:103], a[180:183], v[192:207]
    ds_read_b128 a[164:167], v23 offset:53248
    buffer_load_dwordx4 v10, s[52:55], s61 offen offset:2048 lds
    v_mul_f32 v166, v162, v50
    v_mfma_f32_32x32x16_bf16 v[96:111], a[100:103], a[184:187], v[96:111]
    ds_read_b128 a[168:171], v23 offset:38912
    v_mul_f32 v167, v162, v51
    v_mfma_f32_32x32x16_bf16 v[112:127], a[100:103], a[188:191], v[112:127]
    ds_read_b128 a[172:175], v23 offset:55296
    buffer_load_dwordx4 v11, s[52:55], s61 offen offset:3072 lds
    v_fma_f32 v166, -v163, v51, v166
    s_waitcnt vmcnt(17)
    s_barrier
    s_waitcnt lgkmcnt(5)
    v_mfma_f32_32x32x16_bf16 v[176:191], a[104:107], a[192:195], v[176:191]
    ds_read_b32 v86, v81 offset:0
    ds_read_b128 a[112:115], v16 offset:0
    v_fmac_f32 v167, v163, v50
    v_mfma_f32_32x32x16_bf16 v[192:207], a[104:107], a[196:199], v[192:207]
    ds_read_b128 a[176:179], v24 offset:4096
    ds_read_b128 a[180:183], v24 offset:20480
    s_lshr_b32 s65, s2, 1
    s_and_b32 s65, s65, 3
    s_lshl_b32 s65, s65, 3
    s_add_u32 s65, s65, s3
    s_lshl_b32 s65, s65, 1
    s_lshr_b32 s23, s86, 1
    s_add_u32 s65, s65, s23
    s_mul_i32 s65, s65, 6400
    s_mul_i32 s23, s81, 409600
    s_add_u32 s65, s65, s23
    s_add_u32 s65, s65, 0
    s_bitcmp1_b32 s86, 0
    s_cselect_b32 s40, s16, s14
    s_cselect_b32 s41, s17, s15
    v_min_u32 v94, 49, v1
    v_lshl_add_u32 v94, v94, 7, s65
    global_load_dword v93, v94, s[40:41]
    v_mul_f32 v48, v164, v164
    v_mfma_f32_32x32x16_bf16 v[96:111], a[104:107], a[200:203], v[96:111]
    ds_read_b128 a[184:187], v24 offset:6144
    v_add_f32 v49, v164, v164
    v_mfma_f32_32x32x16_bf16 v[112:127], a[104:107], a[204:207], v[112:127]
    ds_read_b128 a[188:191], v24 offset:22528
    v_fma_f32 v48, -v165, v165, v48
    s_waitcnt lgkmcnt(6)
    v_mfma_f32_32x32x16_bf16 v[176:191], a[108:111], a[160:163], v[176:191]
    ds_read_b128 a[116:119], v17 offset:0
    ds_read_b128 a[192:195], v25 offset:4096
    v_mul_f32 v49, v49, v165
    v_mfma_f32_32x32x16_bf16 v[192:207], a[108:111], a[164:167], v[192:207]
    ds_read_b128 a[196:199], v25 offset:20480
    s_waitcnt lgkmcnt(8)
    v_lshlrev_b32 v90, 16, v86
    v_cndmask_b32 v50, 1.0, v48, s[66:67]
    v_mfma_f32_32x32x16_bf16 v[96:111], a[108:111], a[168:171], v[96:111]
    ds_read_b128 a[200:203], v25 offset:6144
    v_lshlrev_b32 v91, 16, v59
    v_and_b32 v86, 0xffff0000, v86
    v_cndmask_b32 v51, 0, v49, s[66:67]
    v_mfma_f32_32x32x16_bf16 v[112:127], a[108:111], a[172:175], v[112:127]
    ds_read_b128 a[204:207], v25 offset:22528
    v_and_b32 v59, 0xffff0000, v59
    v_mul_f32 v90, v90, v91
    v_mul_f32 v172, v166, v50
    s_waitcnt lgkmcnt(5)
    v_mfma_f32_32x32x16_bf16 v[176:191], a[112:115], a[176:179], v[176:191]
    ds_read_b128 a[120:123], v18 offset:0
    ds_read_b128 a[160:163], v26 offset:4096
    v_mul_f32 v86, v86, v59
    v_cvt_pk_bf16_f32 v90, v90, v86
    v_mul_f32 v173, v166, v51
    v_mfma_f32_32x32x16_bf16 v[192:207], a[112:115], a[180:183], v[192:207]
    ds_read_b128 a[164:167], v26 offset:20480
    v_lshlrev_b32 v91, 16, v90
    v_and_b32 v90, 0xffff0000, v90
    v_fma_f32 v172, -v167, v51, v172
    v_mfma_f32_32x32x16_bf16 v[96:111], a[112:115], a[184:187], v[96:111]
    ds_read_b128 a[168:171], v26 offset:6144
    v_add_f32 v88, v88, v91
    v_add_f32 v88, v88, v90
    v_fmac_f32 v173, v167, v50
    v_mfma_f32_32x32x16_bf16 v[112:127], a[112:115], a[188:191], v[112:127]
    ds_read_b128 a[172:175], v26 offset:22528
    v_mul_f32 v168, v48, v48
    s_waitcnt lgkmcnt(5)
    v_mfma_f32_32x32x16_bf16 v[176:191], a[116:119], a[192:195], v[176:191]
    ds_read_b128 a[124:127], v19 offset:0
    ds_read_b128 a[176:179], v27 offset:4096
    v_add_f32 v169, v48, v48
    v_mfma_f32_32x32x16_bf16 v[192:207], a[116:119], a[196:199], v[192:207]
    ds_read_b128 a[180:183], v27 offset:20480
    v_fma_f32 v168, -v49, v49, v168
    v_mfma_f32_32x32x16_bf16 v[96:111], a[116:119], a[200:203], v[96:111]
    ds_read_b128 a[184:187], v27 offset:6144
    v_mul_f32 v169, v169, v49
    v_mfma_f32_32x32x16_bf16 v[112:127], a[116:119], a[204:207], v[112:127]
    ds_read_b128 a[188:191], v27 offset:22528
    v_cndmask_b32 v50, 1.0, v168, s[68:69]
    s_waitcnt vmcnt(10)
    s_barrier
    s_waitcnt lgkmcnt(5)
    v_mfma_f32_32x32x16_bf16 v[176:191], a[120:123], a[160:163], v[176:191]
    ds_read_b32 v84, v81 offset:32768
    ds_read_b128 a[128:131], v16 offset:32768
    v_cndmask_b32 v51, 0, v169, s[68:69]
    v_mfma_f32_32x32x16_bf16 v[192:207], a[120:123], a[164:167], v[192:207]
    ds_read_b128 a[192:195], v24 offset:36864
    ds_read_b128 a[196:199], v24 offset:53248
    v_mul_f32 v166, v172, v50
    v_mfma_f32_32x32x16_bf16 v[96:111], a[120:123], a[168:171], v[96:111]
    ds_read_b128 a[200:203], v24 offset:38912
    v_mul_f32 v167, v172, v51
    v_mfma_f32_32x32x16_bf16 v[112:127], a[120:123], a[172:175], v[112:127]
    ds_read_b128 a[204:207], v24 offset:55296
    v_fma_f32 v166, -v173, v51, v166
    s_waitcnt lgkmcnt(6)
    v_mfma_f32_32x32x16_bf16 v[176:191], a[124:127], a[176:179], v[176:191]
    ds_read_b128 a[132:135], v17 offset:32768
    ds_read_b128 a[160:163], v25 offset:36864
    v_fmac_f32 v167, v173, v50
    v_mfma_f32_32x32x16_bf16 v[192:207], a[124:127], a[180:183], v[192:207]
    ds_read_b128 a[164:167], v25 offset:53248
    s_waitcnt lgkmcnt(8)
    v_lshlrev_b32 v90, 16, v84
    v_mul_f32 v48, v168, v168
    v_mfma_f32_32x32x16_bf16 v[96:111], a[124:127], a[184:187], v[96:111]
    ds_read_b128 a[168:171], v25 offset:38912
    v_lshlrev_b32 v91, 16, v60
    v_and_b32 v84, 0xffff0000, v84
    v_add_f32 v49, v168, v168
    v_mfma_f32_32x32x16_bf16 v[112:127], a[124:127], a[188:191], v[112:127]
    ds_read_b128 a[172:175], v25 offset:55296
    v_and_b32 v60, 0xffff0000, v60
    v_mul_f32 v90, v90, v91
    v_fma_f32 v48, -v169, v169, v48
    s_waitcnt lgkmcnt(5)
    v_mfma_f32_32x32x16_bf16 v[176:191], a[128:131], a[192:195], v[176:191]
    ds_read_b128 a[136:139], v18 offset:32768
    ds_read_b128 a[176:179], v26 offset:36864
    v_mul_f32 v84, v84, v60
    v_cvt_pk_bf16_f32 v90, v90, v84
    v_mul_f32 v49, v49, v169
    v_mfma_f32_32x32x16_bf16 v[192:207], a[128:131], a[196:199], v[192:207]
    ds_read_b128 a[180:183], v26 offset:53248
    v_lshlrev_b32 v91, 16, v90
    v_and_b32 v90, 0xffff0000, v90
    v_cndmask_b32 v170, 1.0, v48, s[12:13]
    v_mfma_f32_32x32x16_bf16 v[96:111], a[128:131], a[200:203], v[96:111]
    ds_read_b128 a[184:187], v26 offset:38912
    v_add_f32 v88, v88, v91
    v_add_f32 v88, v88, v90
    v_cndmask_b32 v171, 0, v49, s[12:13]
    v_mfma_f32_32x32x16_bf16 v[112:127], a[128:131], a[204:207], v[112:127]
    ds_read_b128 a[188:191], v26 offset:55296
    v_mul_f32 v168, v48, v48
    s_waitcnt lgkmcnt(5)
    v_mfma_f32_32x32x16_bf16 v[176:191], a[132:135], a[160:163], v[176:191]
    ds_read_b128 a[140:143], v19 offset:32768
    ds_read_b128 a[192:195], v27 offset:36864
    v_add_f32 v169, v48, v48
    v_mfma_f32_32x32x16_bf16 v[192:207], a[132:135], a[164:167], v[192:207]
    ds_read_b128 a[196:199], v27 offset:53248
    v_fma_f32 v168, -v49, v49, v168
    v_mfma_f32_32x32x16_bf16 v[96:111], a[132:135], a[168:171], v[96:111]
    ds_read_b128 a[200:203], v27 offset:38912
    v_mul_f32 v169, v169, v49
    v_mfma_f32_32x32x16_bf16 v[112:127], a[132:135], a[172:175], v[112:127]
    ds_read_b128 a[204:207], v27 offset:55296
    v_mul_f32 v48, v168, v168
    s_waitcnt vmcnt(1)
    s_barrier
    s_waitcnt lgkmcnt(5)
    v_mfma_f32_32x32x16_bf16 v[176:191], a[136:139], a[176:179], v[176:191]
    ds_read_b32 v86, v78 offset:0
    ds_read_b128 a[144:147], v72 offset:0
    v_add_f32 v49, v168, v168
    v_mfma_f32_32x32x16_bf16 v[192:207], a[136:139], a[180:183], v[192:207]
    ds_read_b128 a[160:163], v68 offset:4096
    ds_read_b128 a[164:167], v68 offset:20480
    v_fma_f32 v48, -v169, v169, v48
    v_mfma_f32_32x32x16_bf16 v[96:111], a[136:139], a[184:187], v[96:111]
    ds_read_b128 a[168:171], v68 offset:6144
    s_mov_b32 s65, 0
L_sp_20:
    v_readfirstlane_b32 s80, v46
    s_nop 0
    s_cmp_lg_u32 s80, 0
    s_cbranch_scc1 L_sp_21
    s_add_u32 s65, s65, 1
    s_cmp_gt_u32 s65, 100000
    s_cbranch_scc1 L_sp_21
    global_load_dword v46, v45, s[36:37] sc1
    s_waitcnt vmcnt(0)
    s_branch L_sp_20
L_sp_21:
    v_mov_b32 v47, s80
    v_mul_f32 v49, v49, v169
    v_mfma_f32_32x32x16_bf16 v[112:127], a[136:139], a[188:191], v[112:127]
    ds_read_b128 a[172:175], v68 offset:22528
    v_cndmask_b32 v50, 1.0, v48, s[66:67]
    s_waitcnt lgkmcnt(6)
    v_mfma_f32_32x32x16_bf16 v[176:191], a[140:143], a[192:195], v[176:191]
    ds_read_b128 a[148:151], v73 offset:0
    ds_read_b128 a[176:179], v69 offset:4096
    v_cndmask_b32 v51, 0, v49, s[66:67]
    v_mfma_f32_32x32x16_bf16 v[192:207], a[140:143], a[196:199], v[192:207]
    ds_read_b128 a[180:183], v69 offset:20480
    s_waitcnt lgkmcnt(8)
    v_lshlrev_b32 v90, 16, v86
    v_mul_f32 v172, v170, v50
    v_mfma_f32_32x32x16_bf16 v[96:111], a[140:143], a[200:203], v[96:111]
    ds_read_b128 a[184:187], v69 offset:6144
    v_lshlrev_b32 v91, 16, v61
    v_and_b32 v86, 0xffff0000, v86
    v_mul_f32 v173, v170, v51
    v_mfma_f32_32x32x16_bf16 v[112:127], a[140:143], a[204:207], v[112:127]
    ds_read_b128 a[188:191], v69 offset:22528
    v_and_b32 v61, 0xffff0000, v61
    v_mul_f32 v90, v90, v91
    v_fma_f32 v172, -v171, v51, v172
    s_waitcnt lgkmcnt(5)
    v_mfma_f32_32x32x16_bf16 v[176:191], a[144:147], a[160:163], v[176:191]
    ds_read_b128 a[152:155], v74 offset:0
    ds_read_b128 a[192:195], v70 offset:4096
    v_mul_f32 v86, v86, v61
    v_cvt_pk_bf16_f32 v90, v90, v86
    v_fmac_f32 v173, v171, v50
    v_mfma_f32_32x32x16_bf16 v[192:207], a[144:147], a[164:167], v[192:207]
    ds_read_b128 a[196:199], v70 offset:20480
    v_lshlrev_b32 v91, 16, v90
    v_and_b32 v90, 0xffff0000, v90
    v_mul_f32 v50, v48, v48
    v_mfma_f32_32x32x16_bf16 v[96:111], a[144:147], a[168:171], v[96:111]
    ds_read_b128 a[200:203], v70 offset:6144
    v_add_f32 v88, v88, v91
    v_add_f32 v88, v88, v90
    v_add_f32 v51, v48, v48
    v_fma_f32 v50, -v49, v49, v50
    v_mul_f32 v51, v51, v49
    v_mfma_f32_32x32x16_bf16 v[112:127], a[144:147], a[172:175], v[112:127]
    ds_read_b128 a[204:207], v70 offset:22528
    v_add_f32_dpp v88, v88, v88 quad_perm:[1,0,3,2] row_mask:0xf bank_mask:0xf
    s_nop 1
    v_add_f32_dpp v88, v88, v88 quad_perm:[2,3,0,1] row_mask:0xf bank_mask:0xf
    v_cndmask_b32 v50, 1.0, v50, s[68:69]
    v_cndmask_b32 v51, 0, v51, s[68:69]
    v_mul_f32 v170, v172, v50
    s_waitcnt lgkmcnt(5)
    v_mfma_f32_32x32x16_bf16 v[176:191], a[148:151], a[176:179], v[176:191]
    ds_read_b128 a[156:159], v75 offset:0
    ds_read_b128 a[160:163], v71 offset:4096
    v_add_f32_dpp v88, v88, v88 row_half_mirror row_mask:0xf bank_mask:0xf
    s_nop 1
    v_add_f32_dpp v88, v88, v88 row_mirror row_mask:0xf bank_mask:0xf
    v_mul_f32 v171, v172, v51
    v_fma_f32 v170, -v173, v51, v170
    v_mfma_f32_32x32x16_bf16 v[192:207], a[148:151], a[180:183], v[192:207]
    ds_read_b128 a[164:167], v71 offset:20480
    v_mov_b32 v90, v88
    s_nop 1
    v_permlane16_swap_b32 v90, v88
    v_fmac_f32 v171, v173, v50
    v_lshl_add_u32 v174, v2, 1, v3
    v_mov_b32 v172, 0
    v_mfma_f32_32x32x16_bf16 v[96:111], a[148:151], a[184:187], v[96:111]
    ds_read_b128 a[168:171], v71 offset:6144
    v_add_f32 v88, v88, v90
    v_cvt_pk_bf16_f32 v88, v88, v88
    v_mov_b32 v173, 0
    v_lshrrev_b32 v48, 3, v1
    v_mul_u32_u24 v48, 1280, v48
    v_mfma_f32_32x32x16_bf16 v[112:127], a[148:151], a[188:191], v[112:127]
    ds_read_b128 a[172:175], v71 offset:22528
    v_lshlrev_b32 v88, 16, v88
    v_mul_f32 v88, 0xbfb8aa3b, v88
    v_and_b32 v49, 7, v1
    v_lshrrev_b32 v50, 4, v1
    v_xor_b32 v49, v49, v50
    s_waitcnt lgkmcnt(5)
    v_mfma_f32_32x32x16_bf16 v[176:191], a[152:155], a[192:195], v[176:191]
    v_lshl_add_u32 v4, v49, 4, v48
    v_xor_b32 v5, 64, v4
    v_mfma_f32_32x32x16_bf16 v[192:207], a[152:155], a[196:199], v[192:207]
    v_add_u32 v5, 9216, v5
    v_and_b32 v48, 15, v1
    v_mfma_f32_32x32x16_bf16 v[96:111], a[152:155], a[200:203], v[96:111]
    v_lshrrev_b32 v49, 1, v48
    v_xor_b32 v49, v49, v50
    v_mfma_f32_32x32x16_bf16 v[112:127], a[152:155], a[204:207], v[112:127]
    v_lshlrev_b32 v49, 4, v49
    v_lshl_add_u32 v48, v48, 7, v49
    s_waitcnt lgkmcnt(0)
    v_mfma_f32_32x32x16_bf16 v[176:191], a[156:159], a[160:163], v[176:191]
    v_add_u32 v6, s43, v48
    v_xor_b32 v7, 64, v6
    v_mfma_f32_32x32x16_bf16 v[192:207], a[156:159], a[164:167], v[192:207]
    v_exp_f32 v88, v88
    s_nop 0
    v_add_f32 v88, 1.0, v88
    v_add_u32 v8, 98304, v6
    v_add_u32 v9, 98304, v7
    v_mfma_f32_32x32x16_bf16 v[96:111], a[156:159], a[168:171], v[96:111]
    v_rcp_f32 v88, v88
    s_nop 0
    v_cvt_pk_bf16_f32 v88, v88, v88
    v_mfma_f32_32x32x16_bf16 v[112:127], a[156:159], a[172:175], v[112:127]
    v_lshlrev_b32 v90, 16, v88
    v_sub_f32 v91, 1.0, v90
    v_cvt_pk_bf16_f32 v91, v91, v91
    v_lshlrev_b32 v91, 16, v91
    s_mov_b32 s40, 15990784
    s_mov_b32 exec_lo, 1
    s_mov_b32 exec_hi, 1
    buffer_store_dwordx2 v[90:91], v89, s[56:59], s40 offen sc1
    s_mov_b64 exec, -1
    s_barrier
    v_fmac_f32 v177, v240, v176
    v_fmac_f32 v97, v160, v96
    v_fmac_f32 v193, v240, v192
    v_fmac_f32 v113, v160, v112
    v_fma_f32 v177, -v241, v192, v177
    v_fma_f32 v97, -v161, v112, v97
    v_fmac_f32 v193, v241, v176
    v_fmac_f32 v113, v161, v96
    v_fmac_f32 v178, v240, v177
    v_fmac_f32 v98, v160, v97
    v_fmac_f32 v194, v240, v193
    v_fmac_f32 v114, v160, v113
    s_add_u32 m0, s43, 98304
    s_bfe_u32 s23, 0x3030403, s89
    s_lshl_b32 s23, s23, 8
    s_add_u32 s23, s23, s91
    buffer_load_dwordx4 v4, s[92:95], s23 offen offset:0 lds
    v_fma_f32 v178, -v241, v193, v178
    v_fma_f32 v98, -v161, v113, v98
    v_fmac_f32 v194, v241, v177
    v_fmac_f32 v114, v161, v97
    v_fmac_f32 v179, v240, v178
    v_fmac_f32 v99, v160, v98
    v_fmac_f32 v195, v240, v194
    v_fmac_f32 v115, v160, v114
    v_fma_f32 v179, -v241, v194, v179
    v_fma_f32 v99, -v161, v114, v99
    v_fmac_f32 v195, v241, v178
    v_fmac_f32 v115, v161, v98
    buffer_load_dwordx4 v5, s[92:95], s23 offen offset:1024 lds
    v_fmac_f32 v180, v240, v179
    v_fmac_f32 v100, v160, v99
    v_fmac_f32 v196, v240, v195
    v_fmac_f32 v116, v160, v115
    v_fma_f32 v180, -v241, v195, v180
    v_fma_f32 v100, -v161, v115, v100
    v_fmac_f32 v196, v241, v179
    v_fmac_f32 v116, v161, v99
    v_fmac_f32 v181, v240, v180
    v_fmac_f32 v101, v160, v100
    v_fmac_f32 v197, v240, v196
    v_fmac_f32 v117, v160, v116
    s_add_u32 m0, s43, 100352
    s_add_u32 s23, s23, 20480
    buffer_load_dwordx4 v4, s[92:95], s23 offen offset:0 lds
    v_fma_f32 v181, -v241, v196, v181
    v_fma_f32 v101, -v161, v116, v101
    v_fmac_f32 v197, v241, v180
    v_fmac_f32 v117, v161, v100
    v_fmac_f32 v182, v240, v181
    v_fmac_f32 v102, v160, v101
    v_fmac_f32 v198, v240, v197
    v_fmac_f32 v118, v160, v117
    v_fma_f32 v182, -v241, v197, v182
    v_fma_f32 v102, -v161, v117, v102
    v_fmac_f32 v198, v241, v181
    v_fmac_f32 v118, v161, v101
    buffer_load_dwordx4 v5, s[92:95], s23 offen offset:1024 lds
    v_fmac_f32 v183, v240, v182
    v_fmac_f32 v103, v160, v102
    v_fmac_f32 v199, v240, v198
    v_fmac_f32 v119, v160, v118
    v_fma_f32 v183, -v241, v198, v183
    v_fma_f32 v103, -v161, v118, v103
    v_fmac_f32 v199, v241, v182
    v_fmac_f32 v119, v161, v102
    v_fmac_f32 v184, v240, v183
    v_fmac_f32 v104, v160, v103
    v_fmac_f32 v200, v240, v199
    v_fmac_f32 v120, v160, v119
    s_add_u32 m0, s43, 102400
    s_add_u32 s23, s23, 20480
    buffer_load_dwordx4 v4, s[92:95], s23 offen offset:0 lds
    v_fma_f32 v184, -v241, v199, v184
    v_fma_f32 v104, -v161, v119, v104
    v_fmac_f32 v200, v241, v183
    v_fmac_f32 v120, v161, v103
    v_fmac_f32 v185, v240, v184
    v_fmac_f32 v105, v160, v104
    v_fmac_f32 v201, v240, v200
    v_fmac_f32 v121, v160, v120
    v_fma_f32 v185, -v241, v200, v185
    v_fma_f32 v105, -v161, v120, v105
    v_fmac_f32 v201, v241, v184
    v_fmac_f32 v121, v161, v104
    buffer_load_dwordx4 v5, s[92:95], s23 offen offset:1024 lds
    v_fmac_f32 v186, v240, v185
    v_fmac_f32 v106, v160, v105
    v_fmac_f32 v202, v240, v201
    v_fmac_f32 v122, v160, v121
    v_fma_f32 v186, -v241, v201, v186
    v_fma_f32 v106, -v161, v121, v106
    v_fmac_f32 v202, v241, v185
    v_fmac_f32 v122, v161, v105
    v_fmac_f32 v187, v240, v186
    v_fmac_f32 v107, v160, v106
    v_fmac_f32 v203, v240, v202
    v_fmac_f32 v123, v160, v122
    s_add_u32 m0, s43, 104448
    s_add_u32 s23, s23, 20480
    buffer_load_dwordx4 v4, s[92:95], s23 offen offset:0 lds
    v_fma_f32 v187, -v241, v202, v187
    v_fma_f32 v107, -v161, v122, v107
    v_fmac_f32 v203, v241, v186
    v_fmac_f32 v123, v161, v106
    v_fmac_f32 v188, v240, v187
    v_fmac_f32 v108, v160, v107
    v_fmac_f32 v204, v240, v203
    v_fmac_f32 v124, v160, v123
    v_fma_f32 v188, -v241, v203, v188
    v_fma_f32 v108, -v161, v123, v108
    v_fmac_f32 v204, v241, v187
    v_fmac_f32 v124, v161, v107
    buffer_load_dwordx4 v5, s[92:95], s23 offen offset:1024 lds
    v_fmac_f32 v189, v240, v188
    v_fmac_f32 v109, v160, v108
    v_fmac_f32 v205, v240, v204
    v_fmac_f32 v125, v160, v124
    v_fma_f32 v189, -v241, v204, v189
    v_fma_f32 v109, -v161, v124, v109
    v_fmac_f32 v205, v241, v188
    v_fmac_f32 v125, v161, v108
    v_fmac_f32 v190, v240, v189
    v_fmac_f32 v110, v160, v109
    v_fmac_f32 v206, v240, v205
    v_fmac_f32 v126, v160, v125
    v_fma_f32 v190, -v241, v205, v190
    v_fma_f32 v110, -v161, v125, v110
    v_fmac_f32 v206, v241, v189
    v_fmac_f32 v126, v161, v109
    v_fmac_f32 v191, v240, v190
    v_fmac_f32 v111, v160, v110
    v_fmac_f32 v207, v240, v206
    v_fmac_f32 v127, v160, v126
    v_fma_f32 v191, -v241, v206, v191
    v_fma_f32 v111, -v161, v126, v111
    v_fmac_f32 v207, v241, v190
    v_fmac_f32 v127, v161, v110
    v_mov_b32 v48, v191
    v_mov_b32 v50, v111
    v_mov_b32 v49, v207
    v_mov_b32 v51, v127
    ds_write_b64 v34, v[48:49] offset:0
    ds_write_b64 v34, v[50:51] offset:8192
    s_waitcnt lgkmcnt(0)
    s_barrier
    ds_read_b64 v[52:53], v35 offset:0
    ds_read_b64 v[54:55], v35 offset:256
    ds_read_b64 v[56:57], v35 offset:512
    ds_read_b64 v[58:59], v35 offset:768
    ds_read_b64 v[60:61], v35 offset:1024
    ds_read_b64 v[62:63], v35 offset:1280
    ds_read_b64 v[64:65], v35 offset:1536
    ds_read_b64 v[66:67], v35 offset:1792
    ds_read_b64 v[72:73], v35 offset:8192
    ds_read_b64 v[74:75], v35 offset:8448
    ds_read_b64 v[76:77], v35 offset:8704
    ds_read_b64 v[78:79], v35 offset:8960
    ds_read_b64 v[80:81], v35 offset:9216
    ds_read_b64 v[82:83], v35 offset:9472
    ds_read_b64 v[84:85], v35 offset:9728
    ds_read_b64 v[86:87], v35 offset:9984
    s_mul_i32 s40, s87, 360448
    s_add_u32 s48, s38, s40
    s_addc_u32 s49, s39, 0
    s_mov_b32 s50, 360448
    s_mov_b32 s51, 0x20000
    s_mul_i32 s40, s88, 450560
    s_add_u32 s40, s40, 11534336
    s_add_u32 s8, s38, s40
    s_addc_u32 s9, s39, 0
    s_mov_b32 s10, 450560
    s_mov_b32 s11, 0x20000
    s_waitcnt lgkmcnt(0)
    v_pk_fma_f32 v[54:55], v[244:245], v[52:53], v[54:55] op_sel:[0,0,0] op_sel_hi:[0,1,1]
    v_pk_fma_f32 v[74:75], v[164:165], v[72:73], v[74:75] op_sel:[0,0,0] op_sel_hi:[0,1,1]
    v_pk_fma_f32 v[54:55], v[244:245], v[52:53], v[54:55] op_sel:[1,1,0] op_sel_hi:[1,0,1] neg_lo:[1,0,0]
    v_pk_fma_f32 v[74:75], v[164:165], v[72:73], v[74:75] op_sel:[1,1,0] op_sel_hi:[1,0,1] neg_lo:[1,0,0]
    v_pk_fma_f32 v[56:57], v[244:245], v[54:55], v[56:57] op_sel:[0,0,0] op_sel_hi:[0,1,1]
    v_pk_fma_f32 v[76:77], v[164:165], v[74:75], v[76:77] op_sel:[0,0,0] op_sel_hi:[0,1,1]
    v_pk_fma_f32 v[56:57], v[244:245], v[54:55], v[56:57] op_sel:[1,1,0] op_sel_hi:[1,0,1] neg_lo:[1,0,0]
    v_pk_fma_f32 v[76:77], v[164:165], v[74:75], v[76:77] op_sel:[1,1,0] op_sel_hi:[1,0,1] neg_lo:[1,0,0]
    v_pk_fma_f32 v[58:59], v[244:245], v[56:57], v[58:59] op_sel:[0,0,0] op_sel_hi:[0,1,1]
    v_pk_fma_f32 v[78:79], v[164:165], v[76:77], v[78:79] op_sel:[0,0,0] op_sel_hi:[0,1,1]
    v_pk_fma_f32 v[58:59], v[244:245], v[56:57], v[58:59] op_sel:[1,1,0] op_sel_hi:[1,0,1] neg_lo:[1,0,0]
    v_pk_fma_f32 v[78:79], v[164:165], v[76:77], v[78:79] op_sel:[1,1,0] op_sel_hi:[1,0,1] neg_lo:[1,0,0]
    v_pk_fma_f32 v[60:61], v[244:245], v[58:59], v[60:61] op_sel:[0,0,0] op_sel_hi:[0,1,1]
    v_pk_fma_f32 v[80:81], v[164:165], v[78:79], v[80:81] op_sel:[0,0,0] op_sel_hi:[0,1,1]
    v_pk_fma_f32 v[60:61], v[244:245], v[58:59], v[60:61] op_sel:[1,1,0] op_sel_hi:[1,0,1] neg_lo:[1,0,0]
    v_pk_fma_f32 v[80:81], v[164:165], v[78:79], v[80:81] op_sel:[1,1,0] op_sel_hi:[1,0,1] neg_lo:[1,0,0]
    v_pk_fma_f32 v[62:63], v[244:245], v[60:61], v[62:63] op_sel:[0,0,0] op_sel_hi:[0,1,1]
    v_pk_fma_f32 v[82:83], v[164:165], v[80:81], v[82:83] op_sel:[0,0,0] op_sel_hi:[0,1,1]
    v_pk_fma_f32 v[62:63], v[244:245], v[60:61], v[62:63] op_sel:[1,1,0] op_sel_hi:[1,0,1] neg_lo:[1,0,0]
    v_pk_fma_f32 v[82:83], v[164:165], v[80:81], v[82:83] op_sel:[1,1,0] op_sel_hi:[1,0,1] neg_lo:[1,0,0]
    v_pk_fma_f32 v[64:65], v[244:245], v[62:63], v[64:65] op_sel:[0,0,0] op_sel_hi:[0,1,1]
    v_pk_fma_f32 v[84:85], v[164:165], v[82:83], v[84:85] op_sel:[0,0,0] op_sel_hi:[0,1,1]
    v_pk_fma_f32 v[64:65], v[244:245], v[62:63], v[64:65] op_sel:[1,1,0] op_sel_hi:[1,0,1] neg_lo:[1,0,0]
    v_pk_fma_f32 v[84:85], v[164:165], v[82:83], v[84:85] op_sel:[1,1,0] op_sel_hi:[1,0,1] neg_lo:[1,0,0]
    v_pk_fma_f32 v[66:67], v[244:245], v[64:65], v[66:67] op_sel:[0,0,0] op_sel_hi:[0,1,1]
    v_pk_fma_f32 v[86:87], v[164:165], v[84:85], v[86:87] op_sel:[0,0,0] op_sel_hi:[0,1,1]
    v_pk_fma_f32 v[66:67], v[244:245], v[64:65], v[66:67] op_sel:[1,1,0] op_sel_hi:[1,0,1] neg_lo:[1,0,0]
    v_pk_fma_f32 v[86:87], v[164:165], v[84:85], v[86:87] op_sel:[1,1,0] op_sel_hi:[1,0,1] neg_lo:[1,0,0]
    v_mov_b32 v68, v67
    v_mov_b32 v69, v47
    v_mov_b32 v67, v47
    s_add_u32 s40, s84, 0
    s_lshl_b32 s40, s40, 4
    s_add_u32 s40, s40, s82
    s_lshl_b32 s40, s40, 9
    s_add_u32 s40, s40, 15728640
    s_lshl_b32 s41, s86, 3
    s_lshl_b32 exec_lo, 0xff, s41
    s_mov_b32 exec_hi, 0
    buffer_store_dwordx4 v[66:69], v33, s[56:59], s40 offen sc1
    s_mov_b64 exec, -1
    v_mov_b32 v88, v87
    v_mov_b32 v89, v47
    v_mov_b32 v87, v47
    s_add_u32 s40, s84, 1
    s_lshl_b32 s40, s40, 4
    s_add_u32 s40, s40, s82
    s_lshl_b32 s40, s40, 9
    s_add_u32 s40, s40, 15728640
    s_lshl_b32 s41, s86, 3
    s_lshl_b32 exec_lo, 0xff, s41
    s_mov_b32 exec_hi, 0
    buffer_store_dwordx4 v[86:89], v33, s[56:59], s40 offen sc1
    s_mov_b64 exec, -1
    s_waitcnt vmcnt(10)
    s_add_u32 s65, s90, 0
    s_mov_b64 exec, 1
    buffer_store_dword v47, v45, s[56:59], s65 offen sc1
    s_mov_b64 exec, -1
    s_cmp_lg_u32 s86, 0
    s_cbranch_scc1 L_w0_22
    s_mov_b32 s40, 0
    s_mov_b32 exec_hi, 0
    buffer_load_dword v46, v92, s[56:59], s40 offen sc1
    s_mov_b32 exec_hi, -1
L_w0_22:
    v_cmp_eq_u32 s[14:15], 1, v254
    v_cmp_eq_u32 s[12:13], 2, v254
    s_nop 0
    v_cndmask_b32 v252, v252, v52, s[14:15]
    v_cndmask_b32 v253, v253, v53, s[14:15]
    v_cmp_eq_u32 s[14:15], 3, v254
    v_cndmask_b32 v252, v252, v54, s[12:13]
    v_cndmask_b32 v253, v253, v55, s[12:13]
    v_cmp_eq_u32 s[12:13], 4, v254
    s_add_u32 m0, s43, 131072
    s_add_u32 s23, s23, 20480
    buffer_load_dwordx4 v4, s[92:95], s23 offen offset:0 lds
    v_cndmask_b32 v252, v252, v56, s[14:15]
    v_cndmask_b32 v253, v253, v57, s[14:15]
    v_cmp_eq_u32 s[14:15], 5, v254
    v_cndmask_b32 v252, v252, v58, s[12:13]
    v_cndmask_b32 v253, v253, v59, s[12:13]
    v_cmp_eq_u32 s[12:13], 6, v254
    v_cndmask_b32 v252, v252, v60, s[14:15]
    v_cndmask_b32 v253, v253, v61, s[14:15]
    buffer_load_dwordx4 v5, s[92:95], s23 offen offset:1024 lds
    v_cmp_eq_u32 s[14:15], 7, v254
    v_cndmask_b32 v252, v252, v62, s[12:13]
    v_cndmask_b32 v253, v253, v63, s[12:13]
    v_cndmask_b32 v48, v252, v64, s[14:15]
    v_cndmask_b32 v49, v253, v65, s[14:15]
    v_mul_f32 v252, v242, v48
    v_mul_f32 v253, v242, v49
    v_fma_f32 v252, -v243, v49, v252
    s_add_u32 m0, s43, 133120
    s_bfe_u32 s23, 0x4000304, s89
    s_lshl_b32 s23, s23, 8
    s_add_u32 s23, s23, s91
    buffer_load_dwordx4 v4, s[92:95], s23 offen offset:0 lds
    v_fmac_f32 v253, v243, v48
    v_cmp_eq_u32 s[14:15], 1, v174
    v_cmp_eq_u32 s[12:13], 2, v174
    s_nop 0
    v_cndmask_b32 v172, v172, v72, s[14:15]
    v_cndmask_b32 v173, v173, v73, s[14:15]
    v_cmp_eq_u32 s[14:15], 3, v174
    v_cndmask_b32 v172, v172, v74, s[12:13]
    v_cndmask_b32 v173, v173, v75, s[12:13]
    buffer_load_dwordx4 v5, s[92:95], s23 offen offset:1024 lds
    v_cmp_eq_u32 s[12:13], 4, v174
    v_cndmask_b32 v172, v172, v76, s[14:15]
    v_cndmask_b32 v173, v173, v77, s[14:15]
    v_cmp_eq_u32 s[14:15], 5, v174
    v_cndmask_b32 v172, v172, v78, s[12:13]
    v_cndmask_b32 v173, v173, v79, s[12:13]
    v_cmp_eq_u32 s[12:13], 6, v174
    v_cndmask_b32 v172, v172, v80, s[14:15]
    s_add_u32 m0, s43, 135168
    s_add_u32 s23, s23, 20480
    buffer_load_dwordx4 v4, s[92:95], s23 offen offset:0 lds
    v_cndmask_b32 v173, v173, v81, s[14:15]
    v_cmp_eq_u32 s[14:15], 7, v174
    v_cndmask_b32 v172, v172, v82, s[12:13]
    v_cndmask_b32 v173, v173, v83, s[12:13]
    v_cndmask_b32 v48, v172, v84, s[14:15]
    v_cndmask_b32 v49, v173, v85, s[14:15]
    v_mul_f32 v172, v162, v48
    v_mul_f32 v173, v162, v49
    buffer_load_dwordx4 v5, s[92:95], s23 offen offset:1024 lds
    v_fma_f32 v172, -v163, v49, v172
    v_fmac_f32 v173, v163, v48
    v_subrev_u32 v52, 0, v40
    v_ashrrev_i32 v52, 31, v52
    v_bfi_b32 v52, v52, 0, v47
    v_subrev_u32 v53, 1024, v40
    v_ashrrev_i32 v53, 31, v53
    v_bfi_b32 v53, v53, 0, v47
    s_add_u32 m0, s43, 137216
    s_add_u32 s23, s23, 20480
    buffer_load_dwordx4 v4, s[92:95], s23 offen offset:0 lds
    v_pk_mul_f32 v[48:49], v[242:243], v[176:177] op_sel:[1,0] op_sel_hi:[1,1]
    v_pk_mul_f32 v[176:177], v[242:243], v[176:177] op_sel:[0,0] op_sel_hi:[0,1]
    v_pk_fma_f32 v[176:177], v[242:243], v[192:193], v[176:177] op_sel:[1,0,0] op_sel_hi:[1,1,1] neg_lo:[1,0,0] neg_hi:[1,0,0]
    v_pk_fma_f32 v[192:193], v[242:243], v[192:193], v[48:49] op_sel:[0,0,0] op_sel_hi:[0,1,1]
    v_pk_mul_f32 v[50:51], v[242:243], v[178:179] op_sel:[1,0] op_sel_hi:[1,1]
    v_pk_mul_f32 v[178:179], v[242:243], v[178:179] op_sel:[0,0] op_sel_hi:[0,1]
    v_pk_fma_f32 v[178:179], v[242:243], v[194:195], v[178:179] op_sel:[1,0,0] op_sel_hi:[1,1,1] neg_lo:[1,0,0] neg_hi:[1,0,0]
    v_pk_fma_f32 v[194:195], v[242:243], v[194:195], v[50:51] op_sel:[0,0,0] op_sel_hi:[0,1,1]
    buffer_load_dwordx4 v5, s[92:95], s23 offen offset:1024 lds
    v_pk_mul_f32 v[48:49], v[242:243], v[180:181] op_sel:[1,0] op_sel_hi:[1,1]
    v_pk_mul_f32 v[180:181], v[242:243], v[180:181] op_sel:[0,0] op_sel_hi:[0,1]
    v_pk_fma_f32 v[180:181], v[242:243], v[196:197], v[180:181] op_sel:[1,0,0] op_sel_hi:[1,1,1] neg_lo:[1,0,0] neg_hi:[1,0,0]
    v_pk_fma_f32 v[196:197], v[242:243], v[196:197], v[48:49] op_sel:[0,0,0] op_sel_hi:[0,1,1]
    v_pk_mul_f32 v[50:51], v[242:243], v[182:183] op_sel:[1,0] op_sel_hi:[1,1]
    v_pk_mul_f32 v[182:183], v[242:243], v[182:183] op_sel:[0,0] op_sel_hi:[0,1]
    v_pk_fma_f32 v[182:183], v[242:243], v[198:199], v[182:183] op_sel:[1,0,0] op_sel_hi:[1,1,1] neg_lo:[1,0,0] neg_hi:[1,0,0]
    v_pk_fma_f32 v[198:199], v[242:243], v[198:199], v[50:51] op_sel:[0,0,0] op_sel_hi:[0,1,1]
    s_add_u32 m0, s43, 0
    s_add_u32 s23, s23, 20480
    buffer_load_dwordx4 v4, s[92:95], s23 offen offset:0 lds
    v_pk_mul_f32 v[48:49], v[242:243], v[184:185] op_sel:[1,0] op_sel_hi:[1,1]
    v_pk_mul_f32 v[184:185], v[242:243], v[184:185] op_sel:[0,0] op_sel_hi:[0,1]
    v_pk_fma_f32 v[184:185], v[242:243], v[200:201], v[184:185] op_sel:[1,0,0] op_sel_hi:[1,1,1] neg_lo:[1,0,0] neg_hi:[1,0,0]
    v_pk_fma_f32 v[200:201], v[242:243], v[200:201], v[48:49] op_sel:[0,0,0] op_sel_hi:[0,1,1]
    v_pk_mul_f32 v[50:51], v[242:243], v[186:187] op_sel:[1,0] op_sel_hi:[1,1]
    v_pk_mul_f32 v[186:187], v[242:243], v[186:187] op_sel:[0,0] op_sel_hi:[0,1]
    v_pk_fma_f32 v[186:187], v[242:243], v[202:203], v[186:187] op_sel:[1,0,0] op_sel_hi:[1,1,1] neg_lo:[1,0,0] neg_hi:[1,0,0]
    v_pk_fma_f32 v[202:203], v[242:243], v[202:203], v[50:51] op_sel:[0,0,0] op_sel_hi:[0,1,1]
    buffer_load_dwordx4 v5, s[92:95], s23 offen offset:1024 lds
    v_pk_mul_f32 v[48:49], v[242:243], v[188:189] op_sel:[1,0] op_sel_hi:[1,1]
    v_pk_mul_f32 v[188:189], v[242:243], v[188:189] op_sel:[0,0] op_sel_hi:[0,1]
    v_pk_fma_f32 v[188:189], v[242:243], v[204:205], v[188:189] op_sel:[1,0,0] op_sel_hi:[1,1,1] neg_lo:[1,0,0] neg_hi:[1,0,0]
    v_pk_fma_f32 v[204:205], v[242:243], v[204:205], v[48:49] op_sel:[0,0,0] op_sel_hi:[0,1,1]
    v_pk_mul_f32 v[50:51], v[242:243], v[190:191] op_sel:[1,0] op_sel_hi:[1,1]
    v_pk_mul_f32 v[190:191], v[242:243], v[190:191] op_sel:[0,0] op_sel_hi:[0,1]
    v_pk_fma_f32 v[190:191], v[242:243], v[206:207], v[190:191] op_sel:[1,0,0] op_sel_hi:[1,1,1] neg_lo:[1,0,0] neg_hi:[1,0,0]
    v_pk_fma_f32 v[206:207], v[242:243], v[206:207], v[50:51] op_sel:[0,0,0] op_sel_hi:[0,1,1]
    s_add_u32 m0, s43, 2048
    s_add_u32 s23, s23, 20480
    buffer_load_dwordx4 v4, s[92:95], s23 offen offset:0 lds
    v_pk_mul_f32 v[48:49], v[162:163], v[96:97] op_sel:[1,0] op_sel_hi:[1,1]
    v_pk_mul_f32 v[96:97], v[162:163], v[96:97] op_sel:[0,0] op_sel_hi:[0,1]
    v_pk_fma_f32 v[96:97], v[162:163], v[112:113], v[96:97] op_sel:[1,0,0] op_sel_hi:[1,1,1] neg_lo:[1,0,0] neg_hi:[1,0,0]
    v_pk_fma_f32 v[112:113], v[162:163], v[112:113], v[48:49] op_sel:[0,0,0] op_sel_hi:[0,1,1]
    v_pk_mul_f32 v[50:51], v[162:163], v[98:99] op_sel:[1,0] op_sel_hi:[1,1]
    v_pk_mul_f32 v[98:99], v[162:163], v[98:99] op_sel:[0,0] op_sel_hi:[0,1]
    v_pk_fma_f32 v[98:99], v[162:163], v[114:115], v[98:99] op_sel:[1,0,0] op_sel_hi:[1,1,1] neg_lo:[1,0,0] neg_hi:[1,0,0]
    v_pk_fma_f32 v[114:115], v[162:163], v[114:115], v[50:51] op_sel:[0,0,0] op_sel_hi:[0,1,1]
    buffer_load_dwordx4 v5, s[92:95], s23 offen offset:1024 lds
    v_pk_mul_f32 v[48:49], v[162:163], v[100:101] op_sel:[1,0] op_sel_hi:[1,1]
    v_pk_mul_f32 v[100:101], v[162:163], v[100:101] op_sel:[0,0] op_sel_hi:[0,1]
    v_pk_fma_f32 v[100:101], v[162:163], v[116:117], v[100:101] op_sel:[1,0,0] op_sel_hi:[1,1,1] neg_lo:[1,0,0] neg_hi:[1,0,0]
    v_pk_fma_f32 v[116:117], v[162:163], v[116:117], v[48:49] op_sel:[0,0,0] op_sel_hi:[0,1,1]
    v_pk_mul_f32 v[50:51], v[162:163], v[102:103] op_sel:[1,0] op_sel_hi:[1,1]
    v_pk_mul_f32 v[102:103], v[162:163], v[102:103] op_sel:[0,0] op_sel_hi:[0,1]
    v_pk_fma_f32 v[102:103], v[162:163], v[118:119], v[102:103] op_sel:[1,0,0] op_sel_hi:[1,1,1] neg_lo:[1,0,0] neg_hi:[1,0,0]
    v_pk_fma_f32 v[118:119], v[162:163], v[118:119], v[50:51] op_sel:[0,0,0] op_sel_hi:[0,1,1]
    s_add_u32 m0, s43, 4096
    s_bfe_u32 s23, 0x1040000, s89
    s_lshl_b32 s23, s23, 8
    s_add_u32 s23, s23, s91
    buffer_load_dwordx4 v4, s[92:95], s23 offen offset:0 lds
    v_pk_mul_f32 v[48:49], v[162:163], v[104:105] op_sel:[1,0] op_sel_hi:[1,1]
    v_pk_mul_f32 v[104:105], v[162:163], v[104:105] op_sel:[0,0] op_sel_hi:[0,1]
    v_pk_fma_f32 v[104:105], v[162:163], v[120:121], v[104:105] op_sel:[1,0,0] op_sel_hi:[1,1,1] neg_lo:[1,0,0] neg_hi:[1,0,0]
    v_pk_fma_f32 v[120:121], v[162:163], v[120:121], v[48:49] op_sel:[0,0,0] op_sel_hi:[0,1,1]
    v_pk_mul_f32 v[50:51], v[162:163], v[106:107] op_sel:[1,0] op_sel_hi:[1,1]
    v_pk_mul_f32 v[106:107], v[162:163], v[106:107] op_sel:[0,0] op_sel_hi:[0,1]
    v_pk_fma_f32 v[106:107], v[162:163], v[122:123], v[106:107] op_sel:[1,0,0] op_sel_hi:[1,1,1] neg_lo:[1,0,0] neg_hi:[1,0,0]
    v_pk_fma_f32 v[122:123], v[162:163], v[122:123], v[50:51] op_sel:[0,0,0] op_sel_hi:[0,1,1]
    buffer_load_dwordx4 v5, s[92:95], s23 offen offset:1024 lds
    v_pk_mul_f32 v[48:49], v[162:163], v[108:109] op_sel:[1,0] op_sel_hi:[1,1]
    v_pk_mul_f32 v[108:109], v[162:163], v[108:109] op_sel:[0,0] op_sel_hi:[0,1]
    v_pk_fma_f32 v[108:109], v[162:163], v[124:125], v[108:109] op_sel:[1,0,0] op_sel_hi:[1,1,1] neg_lo:[1,0,0] neg_hi:[1,0,0]
    v_pk_fma_f32 v[124:125], v[162:163], v[124:125], v[48:49] op_sel:[0,0,0] op_sel_hi:[0,1,1]
    v_pk_mul_f32 v[50:51], v[162:163], v[110:111] op_sel:[1,0] op_sel_hi:[1,1]
    v_pk_mul_f32 v[110:111], v[162:163], v[110:111] op_sel:[0,0] op_sel_hi:[0,1]
    v_pk_fma_f32 v[110:111], v[162:163], v[126:127], v[110:111] op_sel:[1,0,0] op_sel_hi:[1,1,1] neg_lo:[1,0,0] neg_hi:[1,0,0]
    v_pk_fma_f32 v[126:127], v[162:163], v[126:127], v[50:51] op_sel:[0,0,0] op_sel_hi:[0,1,1]
    s_add_u32 m0, s43, 6144
    s_add_u32 s23, s23, 20480
    buffer_load_dwordx4 v4, s[92:95], s23 offen offset:0 lds
    buffer_load_dwordx4 v5, s[92:95], s23 offen offset:1024 lds
    s_add_u32 m0, s43, 32768
    s_add_u32 s23, s23, 20480
    buffer_load_dwordx4 v4, s[92:95], s23 offen offset:0 lds
    buffer_load_dwordx4 v5, s[92:95], s23 offen offset:1024 lds
    s_add_u32 m0, s43, 34816
    s_add_u32 s23, s23, 20480
    buffer_load_dwordx4 v4, s[92:95], s23 offen offset:0 lds
    buffer_load_dwordx4 v5, s[92:95], s23 offen offset:1024 lds
    s_add_u32 m0, s43, 36864
    s_add_u32 s23, s23, 20480
    buffer_load_dwordx4 v4, s[92:95], s23 offen offset:0 lds
    buffer_load_dwordx4 v5, s[92:95], s23 offen offset:1024 lds
    s_add_u32 m0, s43, 38912
    s_bfe_u32 s23, 0x10102, s89
    s_lshl_b32 s23, s23, 8
    s_add_u32 s23, s23, s91
    buffer_load_dwordx4 v4, s[92:95], s23 offen offset:0 lds
    buffer_load_dwordx4 v5, s[92:95], s23 offen offset:1024 lds
    s_waitcnt vmcnt(33)
    ds_read_b128 a[0:3], v8 offset:0
    ds_read_b128 a[4:7], v9 offset:0
    s_waitcnt vmcnt(31)
    ds_read_b128 a[8:11], v8 offset:2048
    ds_read_b128 a[12:15], v9 offset:2048
    s_waitcnt vmcnt(29)
    ds_read_b128 a[16:19], v8 offset:4096
    ds_read_b128 a[20:23], v9 offset:4096
    s_waitcnt vmcnt(27)
    ds_read_b128 a[24:27], v8 offset:6144
    ds_read_b128 a[28:31], v9 offset:6144
    s_waitcnt vmcnt(22)
    ds_read_b128 a[32:35], v8 offset:32768
    ds_read_b128 a[36:39], v9 offset:32768
    s_waitcnt vmcnt(20)
    ds_read_b128 a[40:43], v8 offset:34816
    ds_read_b128 a[44:47], v9 offset:34816
    s_waitcnt vmcnt(18)
    ds_read_b128 a[48:51], v8 offset:36864
    ds_read_b128 a[52:55], v9 offset:36864
    s_waitcnt vmcnt(16)
    ds_read_b128 a[56:59], v8 offset:38912
    ds_read_b128 a[60:63], v9 offset:38912
    s_waitcnt vmcnt(14)
    ds_read_b128 a[64:67], v6 offset:0
    ds_read_b128 a[68:71], v7 offset:0
    s_waitcnt lgkmcnt(15)
    s_add_u32 m0, s43, 98304
    s_add_u32 s23, s23, 20480
    buffer_load_dwordx4 v4, s[92:95], s23 offen offset:0 lds
    buffer_load_dwordx4 v5, s[92:95], s23 offen offset:1024 lds
    s_waitcnt lgkmcnt(14)
    s_add_u32 m0, s43, 100352
    s_add_u32 s23, s23, 20480
    buffer_load_dwordx4 v4, s[92:95], s23 offen offset:0 lds
    buffer_load_dwordx4 v5, s[92:95], s23 offen offset:1024 lds
    s_waitcnt lgkmcnt(12)
    s_add_u32 m0, s43, 102400
    s_add_u32 s23, s23, 20480
    buffer_load_dwordx4 v4, s[92:95], s23 offen offset:0 lds
    buffer_load_dwordx4 v5, s[92:95], s23 offen offset:1024 lds
    s_waitcnt lgkmcnt(10)
    s_add_u32 m0, s43, 104448
    s_add_u32 s23, s23, 20480
    buffer_load_dwordx4 v4, s[92:95], s23 offen offset:0 lds
    buffer_load_dwordx4 v5, s[92:95], s23 offen offset:1024 lds
    s_waitcnt lgkmcnt(8)
    s_add_u32 m0, s43, 131072
    s_bfe_u32 s23, 0x2020201, s89
    s_lshl_b32 s23, s23, 8
    s_add_u32 s23, s23, s91
    buffer_load_dwordx4 v4, s[92:95], s23 offen offset:0 lds
    buffer_load_dwordx4 v5, s[92:95], s23 offen offset:1024 lds
    s_waitcnt lgkmcnt(6)
    s_add_u32 m0, s43, 133120
    s_add_u32 s23, s23, 20480
    buffer_load_dwordx4 v4, s[92:95], s23 offen offset:0 lds
    buffer_load_dwordx4 v5, s[92:95], s23 offen offset:1024 lds
    s_waitcnt lgkmcnt(4)
    s_add_u32 m0, s43, 135168
    s_add_u32 s23, s23, 20480
    buffer_load_dwordx4 v4, s[92:95], s23 offen offset:0 lds
    buffer_load_dwordx4 v5, s[92:95], s23 offen offset:1024 lds
    s_waitcnt lgkmcnt(2)
    s_add_u32 m0, s43, 137216
    s_add_u32 s23, s23, 20480
    buffer_load_dwordx4 v4, s[92:95], s23 offen offset:0 lds
    buffer_load_dwordx4 v5, s[92:95], s23 offen offset:1024 lds
    s_waitcnt lgkmcnt(0)
    s_add_u32 m0, s43, 0
    s_add_u32 s23, s23, 20480
    buffer_load_dwordx4 v4, s[92:95], s23 offen offset:0 lds
    buffer_load_dwordx4 v5, s[92:95], s23 offen offset:1024 lds
    s_add_u32 s40, s84, 0
    s_lshl_b32 s40, s40, 13
    s_add_u32 s40, s40, 15728640
    s_add_u32 s44, s38, s40
    s_addc_u32 s45, s39, 0
    s_mov_b32 s46, 8192
    s_mov_b32 s47, 0x20000
    buffer_load_dwordx4 v[60:63], v40, s[44:47], 0 offen sc1
    v_subrev_u32 v48, 1024, v40
    buffer_load_dwordx4 v[64:67], v48, s[44:47], 0 offen sc1
    s_add_u32 s40, s84, 1
    s_lshl_b32 s40, s40, 13
    s_add_u32 s40, s40, 15728640
    s_add_u32 s44, s38, s40
    s_addc_u32 s45, s39, 0
    s_mov_b32 s46, 8192
    s_mov_b32 s47, 0x20000
    buffer_load_dwordx4 v[84:87], v40, s[44:47], 0 offen sc1
    v_subrev_u32 v48, 1024, v40
    buffer_load_dwordx4 v[88:91], v48, s[44:47], 0 offen sc1
    s_cmp_lg_u32 s86, 0
    s_cbranch_scc1 L_w0_23
    s_waitcnt vmcnt(46)
    s_mov_b32 s65, 0
L_sp_24:
    v_cmp_ne_u32 vcc, s80, v46
    s_nop 0
    s_cmp_eq_u32 vcc_lo, 0
    s_cbranch_scc1 L_sp_25
    s_add_u32 s65, s65, 1
    s_cmp_gt_u32 s65, 100000
    s_cbranch_scc1 L_sp_25
    s_mov_b32 s40, 0
    s_mov_b32 exec_hi, 0
    buffer_load_dword v46, v92, s[56:59], s40 offen sc1
    s_mov_b32 exec_hi, -1
    s_waitcnt vmcnt(0)
    s_branch L_sp_24
L_sp_25:
L_w0_23:
    s_barrier
    s_waitcnt vmcnt(34)
    ds_read_b128 a[72:75], v6 offset:2048
    ds_read_b128 a[76:79], v7 offset:2048
    s_waitcnt vmcnt(32)
    ds_read_b128 a[80:83], v6 offset:4096
    ds_read_b128 a[84:87], v7 offset:4096
    s_waitcnt vmcnt(30)
    ds_read_b128 a[88:91], v6 offset:6144
    ds_read_b128 a[92:95], v7 offset:6144
    s_waitcnt vmcnt(28)
    ds_read_b128 a[96:99], v6 offset:32768
    ds_read_b128 a[100:103], v7 offset:32768
    s_waitcnt vmcnt(26)
    ds_read_b128 a[104:107], v6 offset:34816
    ds_read_b128 a[108:111], v7 offset:34816
    s_waitcnt vmcnt(24)
    ds_read_b128 a[112:115], v6 offset:36864
    ds_read_b128 a[116:119], v7 offset:36864
    s_waitcnt vmcnt(22)
    ds_read_b128 a[120:123], v6 offset:38912
    ds_read_b128 a[124:127], v7 offset:38912
    s_waitcnt vmcnt(2)
    s_mov_b32 s65, 0
L_sp_26:
    v_xor_b32 v61, v61, v52
    v_xor_b32 v63, v63, v52
    v_xor_b32 v65, v65, v53
    v_xor_b32 v67, v67, v53
    v_or3_b32 v48, v61, v63, v65
    v_or_b32 v48, v48, v67
    v_cmp_ne_u32 vcc, 0, v48
    s_cbranch_vccz L_sp_27
    s_add_u32 s65, s65, 1
    s_cmp_gt_u32 s65, 100000
    s_cbranch_scc1 L_sp_27
    s_add_u32 s40, s84, 0
    s_lshl_b32 s40, s40, 13
    s_add_u32 s40, s40, 15728640
    s_add_u32 s44, s38, s40
    s_addc_u32 s45, s39, 0
    s_mov_b32 s46, 8192
    s_mov_b32 s47, 0x20000
    buffer_load_dwordx4 v[60:63], v40, s[44:47], 0 offen sc1
    v_subrev_u32 v48, 1024, v40
    buffer_load_dwordx4 v[64:67], v48, s[44:47], 0 offen sc1
    s_waitcnt vmcnt(0)
    s_branch L_sp_26
L_sp_27:
    v_mov_b32 v61, v62
    v_mov_b32 v65, v66
    v_pk_fma_f32 v[60:61], v[248:249], v[64:65], v[60:61] op_sel:[0,0,0] op_sel_hi:[0,1,1]
    v_pk_fma_f32 v[60:61], v[248:249], v[64:65], v[60:61] op_sel:[1,1,0] op_sel_hi:[1,0,1] neg_lo:[1,0,0]
    v_pk_mul_f32 v[48:49], v[250:251], v[60:61] op_sel:[0,0] op_sel_hi:[0,1]
    v_pk_fma_f32 v[48:49], v[250:251], v[60:61], v[48:49] op_sel:[1,1,0] op_sel_hi:[1,0,1] neg_lo:[1,0,0]
    v_cmp_ne_u32 vcc, 0, v52
    s_nop 1
    v_cndmask_b32 v48, 0, v48, vcc
    v_cndmask_b32 v49, 0, v49, vcc
    ds_write_b64 v34, v[48:49] offset:0
    s_waitcnt lgkmcnt(0)
    s_barrier
    ds_read_b64 v[68:69], v35 offset:0
    ds_read_b64 v[70:71], v35 offset:256
    ds_read_b64 v[72:73], v35 offset:512
    ds_read_b64 v[74:75], v35 offset:768
    ds_read_b64 v[76:77], v35 offset:1024
    ds_read_b64 v[78:79], v35 offset:1280
    ds_read_b64 v[80:81], v35 offset:1536
    ds_read_b64 v[82:83], v35 offset:1792
    s_waitcnt lgkmcnt(6)
    v_pk_add_f32 v[68:69], v[68:69], v[70:71]
    s_waitcnt lgkmcnt(4)
    v_pk_add_f32 v[72:73], v[72:73], v[74:75]
    s_waitcnt lgkmcnt(2)
    v_pk_add_f32 v[76:77], v[76:77], v[78:79]
    s_waitcnt lgkmcnt(0)
    v_pk_add_f32 v[80:81], v[80:81], v[82:83]
    v_pk_add_f32 v[68:69], v[68:69], v[72:73]
    v_pk_add_f32 v[76:77], v[76:77], v[80:81]
    v_pk_add_f32 v[48:49], v[68:69], v[76:77]
    v_pk_fma_f32 v[252:253], v[246:247], v[48:49], v[252:253] op_sel:[0,0,0] op_sel_hi:[0,1,1]
    v_pk_fma_f32 v[252:253], v[246:247], v[48:49], v[252:253] op_sel:[1,1,0] op_sel_hi:[1,0,1] neg_lo:[1,0,0]
    s_cmp_lg_u32 s86, 0
    s_cbranch_scc1 L_w0_28
    s_mov_b32 s40, 0
    s_mov_b32 exec_hi, 0
    buffer_load_dword v46, v43, s[56:59], s40 offen sc1
    s_mov_b32 exec_hi, -1
L_w0_28:
    v_pk_fma_f32 v[176:177], v[208:209], v[252:253], v[176:177] op_sel:[0,0,0] op_sel_hi:[1,0,1]
    v_pk_fma_f32 v[192:193], v[208:209], v[252:253], v[192:193] op_sel:[0,1,0] op_sel_hi:[1,1,1]
    v_pk_fma_f32 v[176:177], v[224:225], v[252:253], v[176:177] op_sel:[0,1,0] op_sel_hi:[1,1,1] neg_lo:[1,0,0] neg_hi:[1,0,0]
    v_pk_fma_f32 v[192:193], v[224:225], v[252:253], v[192:193] op_sel:[0,0,0] op_sel_hi:[1,0,1]
    s_bfe_u32 s61, 0x20100, s89
    s_mul_i32 s61, s61, 20480
    buffer_load_dwordx4 a[208:211], v41, s[8:11], s61 offen offset:0 sc1
    v_pk_fma_f32 v[178:179], v[210:211], v[252:253], v[178:179] op_sel:[0,0,0] op_sel_hi:[1,0,1]
    v_pk_fma_f32 v[194:195], v[210:211], v[252:253], v[194:195] op_sel:[0,1,0] op_sel_hi:[1,1,1]
    v_pk_fma_f32 v[178:179], v[226:227], v[252:253], v[178:179] op_sel:[0,1,0] op_sel_hi:[1,1,1] neg_lo:[1,0,0] neg_hi:[1,0,0]
    v_pk_fma_f32 v[194:195], v[226:227], v[252:253], v[194:195] op_sel:[0,0,0] op_sel_hi:[1,0,1]
    buffer_load_dwordx4 a[212:215], v41, s[8:11], s61 offen offset:1024 sc1
    v_pk_fma_f32 v[180:181], v[212:213], v[252:253], v[180:181] op_sel:[0,0,0] op_sel_hi:[1,0,1]
    v_pk_fma_f32 v[196:197], v[212:213], v[252:253], v[196:197] op_sel:[0,1,0] op_sel_hi:[1,1,1]
    v_pk_fma_f32 v[180:181], v[228:229], v[252:253], v[180:181] op_sel:[0,1,0] op_sel_hi:[1,1,1] neg_lo:[1,0,0] neg_hi:[1,0,0]
    v_pk_fma_f32 v[196:197], v[228:229], v[252:253], v[196:197] op_sel:[0,0,0] op_sel_hi:[1,0,1]
    buffer_load_dwordx4 a[216:219], v41, s[8:11], s61 offen offset:2048 sc1
    v_pk_fma_f32 v[182:183], v[214:215], v[252:253], v[182:183] op_sel:[0,0,0] op_sel_hi:[1,0,1]
    v_pk_fma_f32 v[198:199], v[214:215], v[252:253], v[198:199] op_sel:[0,1,0] op_sel_hi:[1,1,1]
    v_pk_fma_f32 v[182:183], v[230:231], v[252:253], v[182:183] op_sel:[0,1,0] op_sel_hi:[1,1,1] neg_lo:[1,0,0] neg_hi:[1,0,0]
    v_pk_fma_f32 v[198:199], v[230:231], v[252:253], v[198:199] op_sel:[0,0,0] op_sel_hi:[1,0,1]
    buffer_load_dwordx4 a[220:223], v41, s[8:11], s61 offen offset:3072 sc1
    v_pk_fma_f32 v[184:185], v[216:217], v[252:253], v[184:185] op_sel:[0,0,0] op_sel_hi:[1,0,1]
    v_pk_fma_f32 v[200:201], v[216:217], v[252:253], v[200:201] op_sel:[0,1,0] op_sel_hi:[1,1,1]
    v_pk_fma_f32 v[184:185], v[232:233], v[252:253], v[184:185] op_sel:[0,1,0] op_sel_hi:[1,1,1] neg_lo:[1,0,0] neg_hi:[1,0,0]
    v_pk_fma_f32 v[200:201], v[232:233], v[252:253], v[200:201] op_sel:[0,0,0] op_sel_hi:[1,0,1]
    buffer_load_dwordx4 a[224:227], v42, s[8:11], s61 offen sc1
    v_pk_fma_f32 v[186:187], v[218:219], v[252:253], v[186:187] op_sel:[0,0,0] op_sel_hi:[1,0,1]
    v_pk_fma_f32 v[202:203], v[218:219], v[252:253], v[202:203] op_sel:[0,1,0] op_sel_hi:[1,1,1]
    v_pk_fma_f32 v[186:187], v[234:235], v[252:253], v[186:187] op_sel:[0,1,0] op_sel_hi:[1,1,1] neg_lo:[1,0,0] neg_hi:[1,0,0]
    v_pk_fma_f32 v[202:203], v[234:235], v[252:253], v[202:203] op_sel:[0,0,0] op_sel_hi:[1,0,1]
    s_bfe_u32 s61, 0x3000001, s89
    s_mul_i32 s61, s61, 20480
    buffer_load_dwordx4 a[228:231], v41, s[8:11], s61 offen offset:0 sc1
    v_pk_fma_f32 v[188:189], v[220:221], v[252:253], v[188:189] op_sel:[0,0,0] op_sel_hi:[1,0,1]
    v_pk_fma_f32 v[204:205], v[220:221], v[252:253], v[204:205] op_sel:[0,1,0] op_sel_hi:[1,1,1]
    v_pk_fma_f32 v[188:189], v[236:237], v[252:253], v[188:189] op_sel:[0,1,0] op_sel_hi:[1,1,1] neg_lo:[1,0,0] neg_hi:[1,0,0]
    v_pk_fma_f32 v[204:205], v[236:237], v[252:253], v[204:205] op_sel:[0,0,0] op_sel_hi:[1,0,1]
    buffer_load_dwordx4 a[232:235], v41, s[8:11], s61 offen offset:1024 sc1
    v_pk_fma_f32 v[190:191], v[222:223], v[252:253], v[190:191] op_sel:[0,0,0] op_sel_hi:[1,0,1]
    v_pk_fma_f32 v[206:207], v[222:223], v[252:253], v[206:207] op_sel:[0,1,0] op_sel_hi:[1,1,1]
    v_pk_fma_f32 v[190:191], v[238:239], v[252:253], v[190:191] op_sel:[0,1,0] op_sel_hi:[1,1,1] neg_lo:[1,0,0] neg_hi:[1,0,0]
    v_pk_fma_f32 v[206:207], v[238:239], v[252:253], v[206:207] op_sel:[0,0,0] op_sel_hi:[1,0,1]
    buffer_load_dwordx4 a[236:239], v41, s[8:11], s61 offen offset:2048 sc1
    v_cvt_pk_bf16_f32 v176, v176, v177
    v_cvt_pk_bf16_f32 v177, v178, v179
    v_cvt_pk_bf16_f32 v178, v180, v181
    v_cvt_pk_bf16_f32 v179, v182, v183
    buffer_load_dwordx4 a[240:243], v41, s[8:11], s61 offen offset:3072 sc1
    ds_write_b128 v36, v[176:179]
    v_cvt_pk_bf16_f32 v184, v184, v185
    v_cvt_pk_bf16_f32 v185, v186, v187
    v_cvt_pk_bf16_f32 v186, v188, v189
    buffer_load_dwordx4 a[244:247], v42, s[8:11], s61 offen sc1
    v_cvt_pk_bf16_f32 v187, v190, v191
    ds_write_b128 v37, v[184:187]
    ds_read_b64_tr_b16 v[180:181], v38 offset:0
    ds_read_b64_tr_b16 v[182:183], v39 offset:0
    s_bfe_u32 s61, 0x1010204, s89
    s_mul_i32 s61, s61, 20480
    buffer_load_dwordx4 v[12:15], v41, s[8:11], s61 offen offset:0 sc1
    ds_read_b64_tr_b16 v[188:189], v38 offset:1024
    ds_read_b64_tr_b16 v[190:191], v39 offset:1024
    v_cvt_pk_bf16_f32 v192, -v192, -v193
    v_cvt_pk_bf16_f32 v193, -v194, -v195
    buffer_load_dwordx4 v[16:19], v41, s[8:11], s61 offen offset:1024 sc1
    v_cvt_pk_bf16_f32 v194, -v196, -v197
    v_cvt_pk_bf16_f32 v195, -v198, -v199
    ds_write_b128 v36, v[192:195]
    v_cvt_pk_bf16_f32 v200, -v200, -v201
    buffer_load_dwordx4 v[20:23], v41, s[8:11], s61 offen offset:2048 sc1
    v_cvt_pk_bf16_f32 v201, -v202, -v203
    v_cvt_pk_bf16_f32 v202, -v204, -v205
    v_cvt_pk_bf16_f32 v203, -v206, -v207
    ds_write_b128 v37, v[200:203]
    buffer_load_dwordx4 v[24:27], v41, s[8:11], s61 offen offset:3072 sc1
    ds_read_b64_tr_b16 v[196:197], v38 offset:0
    ds_read_b64_tr_b16 v[198:199], v39 offset:0
    ds_read_b64_tr_b16 v[204:205], v38 offset:1024
    ds_read_b64_tr_b16 v[206:207], v39 offset:1024
    buffer_load_dwordx4 v[28:31], v42, s[8:11], s61 offen sc1
    s_add_u32 s41, s84, 0
    s_lshr_b32 s40, s41, 2
    s_lshl_b32 s40, s40, 1
    s_and_b32 s65, s41, 1
    s_add_u32 s40, s40, s65
    s_lshl_b32 s40, s40, 1
    s_bfe_u32 s65, s41, 0x10001
    s_add_u32 s40, s40, s65
    s_lshl_b32 s40, s40, 13
    s_add_u32 s40, s40, s64
    s_add_u32 s40, s40, 196608
    s_waitcnt lgkmcnt(6)
    buffer_store_dwordx4 v[180:183], v33, s[56:59], s40 offen offset:0 sc1
    buffer_store_dwordx4 v[188:191], v33, s[56:59], s40 offen offset:1024 sc1
    s_add_u32 s41, s84, 0
    s_lshr_b32 s40, s41, 2
    s_lshl_b32 s40, s40, 1
    s_and_b32 s65, s41, 1
    s_add_u32 s40, s40, s65
    s_lshl_b32 s40, s40, 1
    s_bfe_u32 s65, s41, 0x10001
    s_add_u32 s40, s40, s65
    s_lshl_b32 s40, s40, 13
    s_add_u32 s40, s40, s64
    s_add_u32 s40, s40, 200704
    s_waitcnt lgkmcnt(0)
    buffer_store_dwordx4 v[196:199], v33, s[56:59], s40 offen offset:0 sc1
    buffer_store_dwordx4 v[204:207], v33, s[56:59], s40 offen offset:1024 sc1
    s_waitcnt vmcnt(19)
    s_mov_b32 s65, 0
L_sp_29:
    v_xor_b32 v85, v85, v52
    v_xor_b32 v87, v87, v52
    v_xor_b32 v89, v89, v53
    v_xor_b32 v91, v91, v53
    v_or3_b32 v48, v85, v87, v89
    v_or_b32 v48, v48, v91
    v_cmp_ne_u32 vcc, 0, v48
    s_cbranch_vccz L_sp_30
    s_add_u32 s65, s65, 1
    s_cmp_gt_u32 s65, 100000
    s_cbranch_scc1 L_sp_30
    s_add_u32 s40, s84, 1
    s_lshl_b32 s40, s40, 13
    s_add_u32 s40, s40, 15728640
    s_add_u32 s44, s38, s40
    s_addc_u32 s45, s39, 0
    s_mov_b32 s46, 8192
    s_mov_b32 s47, 0x20000
    buffer_load_dwordx4 v[84:87], v40, s[44:47], 0 offen sc1
    v_subrev_u32 v48, 1024, v40
    buffer_load_dwordx4 v[88:91], v48, s[44:47], 0 offen sc1
    s_waitcnt vmcnt(0)
    s_branch L_sp_29
L_sp_30:
    v_mov_b32 v85, v86
    v_mov_b32 v89, v90
    v_pk_fma_f32 v[84:85], v[168:169], v[88:89], v[84:85] op_sel:[0,0,0] op_sel_hi:[0,1,1]
    v_pk_fma_f32 v[84:85], v[168:169], v[88:89], v[84:85] op_sel:[1,1,0] op_sel_hi:[1,0,1] neg_lo:[1,0,0]
    v_pk_mul_f32 v[48:49], v[170:171], v[84:85] op_sel:[0,0] op_sel_hi:[0,1]
    v_pk_fma_f32 v[48:49], v[170:171], v[84:85], v[48:49] op_sel:[1,1,0] op_sel_hi:[1,0,1] neg_lo:[1,0,0]
    v_cmp_ne_u32 vcc, 0, v52
    s_nop 1
    v_cndmask_b32 v48, 0, v48, vcc
    v_cndmask_b32 v49, 0, v49, vcc
    ds_write_b64 v34, v[48:49] offset:8192
    s_waitcnt lgkmcnt(0)
    s_barrier
    ds_read_b64 v[68:69], v35 offset:8192
    ds_read_b64 v[70:71], v35 offset:8448
    ds_read_b64 v[72:73], v35 offset:8704
    ds_read_b64 v[74:75], v35 offset:8960
    ds_read_b64 v[76:77], v35 offset:9216
    ds_read_b64 v[78:79], v35 offset:9472
    ds_read_b64 v[80:81], v35 offset:9728
    ds_read_b64 v[82:83], v35 offset:9984
    s_waitcnt lgkmcnt(6)
    v_pk_add_f32 v[68:69], v[68:69], v[70:71]
    s_waitcnt lgkmcnt(4)
    v_pk_add_f32 v[72:73], v[72:73], v[74:75]
    s_waitcnt lgkmcnt(2)
    v_pk_add_f32 v[76:77], v[76:77], v[78:79]
    s_waitcnt lgkmcnt(0)
    v_pk_add_f32 v[80:81], v[80:81], v[82:83]
    v_pk_add_f32 v[68:69], v[68:69], v[72:73]
    v_pk_add_f32 v[76:77], v[76:77], v[80:81]
    v_pk_add_f32 v[48:49], v[68:69], v[76:77]
    v_pk_fma_f32 v[172:173], v[166:167], v[48:49], v[172:173] op_sel:[0,0,0] op_sel_hi:[0,1,1]
    v_pk_fma_f32 v[172:173], v[166:167], v[48:49], v[172:173] op_sel:[1,1,0] op_sel_hi:[1,0,1] neg_lo:[1,0,0]
    s_cmp_lg_u32 s86, 0
    s_cbranch_scc1 L_w0_31
    s_waitcnt vmcnt(19)
    s_mov_b32 s65, 0
L_sp_32:
    v_cmp_ne_u32 vcc, s80, v46
    s_nop 0
    s_cmp_eq_u32 vcc_lo, 0
    s_cbranch_scc1 L_sp_33
    s_add_u32 s65, s65, 1
    s_cmp_gt_u32 s65, 100000
    s_cbranch_scc1 L_sp_33
    s_mov_b32 s40, 0
    s_mov_b32 exec_hi, 0
    buffer_load_dword v46, v43, s[56:59], s40 offen sc1
    s_mov_b32 exec_hi, -1
    s_waitcnt vmcnt(0)
    s_branch L_sp_32
L_sp_33:
L_w0_31:
    s_barrier
    v_add_u32 v10, s43, v33
    v_add_u32 v11, 0x10000, v10
    v_pk_fma_f32 v[96:97], v[128:129], v[172:173], v[96:97] op_sel:[0,0,0] op_sel_hi:[1,0,1]
    v_pk_fma_f32 v[112:113], v[128:129], v[172:173], v[112:113] op_sel:[0,1,0] op_sel_hi:[1,1,1]
    v_pk_fma_f32 v[96:97], v[144:145], v[172:173], v[96:97] op_sel:[0,1,0] op_sel_hi:[1,1,1] neg_lo:[1,0,0] neg_hi:[1,0,0]
    s_bfe_u32 s60, 0x20100, s89
    s_lshl_b32 s60, s60, 14
    buffer_load_dwordx4 a[160:163], v44, s[48:51], s60 offen offset:0 sc1
    v_pk_fma_f32 v[112:113], v[144:145], v[172:173], v[112:113] op_sel:[0,0,0] op_sel_hi:[1,0,1]
    v_pk_fma_f32 v[98:99], v[130:131], v[172:173], v[98:99] op_sel:[0,0,0] op_sel_hi:[1,0,1]
    v_pk_fma_f32 v[114:115], v[130:131], v[172:173], v[114:115] op_sel:[0,1,0] op_sel_hi:[1,1,1]
    buffer_load_dwordx4 a[164:167], v44, s[48:51], s60 offen offset:1024 sc1
    v_pk_fma_f32 v[98:99], v[146:147], v[172:173], v[98:99] op_sel:[0,1,0] op_sel_hi:[1,1,1] neg_lo:[1,0,0] neg_hi:[1,0,0]
    v_pk_fma_f32 v[114:115], v[146:147], v[172:173], v[114:115] op_sel:[0,0,0] op_sel_hi:[1,0,1]
    v_pk_fma_f32 v[100:101], v[132:133], v[172:173], v[100:101] op_sel:[0,0,0] op_sel_hi:[1,0,1]
    buffer_load_dwordx4 a[168:171], v44, s[48:51], s60 offen offset:2048 sc1
    v_pk_fma_f32 v[116:117], v[132:133], v[172:173], v[116:117] op_sel:[0,1,0] op_sel_hi:[1,1,1]
    v_pk_fma_f32 v[100:101], v[148:149], v[172:173], v[100:101] op_sel:[0,1,0] op_sel_hi:[1,1,1] neg_lo:[1,0,0] neg_hi:[1,0,0]
    v_pk_fma_f32 v[116:117], v[148:149], v[172:173], v[116:117] op_sel:[0,0,0] op_sel_hi:[1,0,1]
    buffer_load_dwordx4 a[172:175], v44, s[48:51], s60 offen offset:3072 sc1
    v_pk_fma_f32 v[102:103], v[134:135], v[172:173], v[102:103] op_sel:[0,0,0] op_sel_hi:[1,0,1]
    v_pk_fma_f32 v[118:119], v[134:135], v[172:173], v[118:119] op_sel:[0,1,0] op_sel_hi:[1,1,1]
    v_pk_fma_f32 v[102:103], v[150:151], v[172:173], v[102:103] op_sel:[0,1,0] op_sel_hi:[1,1,1] neg_lo:[1,0,0] neg_hi:[1,0,0]
    s_bfe_u32 s60, 0x3000001, s89
    s_lshl_b32 s60, s60, 14
    buffer_load_dwordx4 a[176:179], v44, s[48:51], s60 offen offset:0 sc1
    v_pk_fma_f32 v[118:119], v[150:151], v[172:173], v[118:119] op_sel:[0,0,0] op_sel_hi:[1,0,1]
    v_pk_fma_f32 v[104:105], v[136:137], v[172:173], v[104:105] op_sel:[0,0,0] op_sel_hi:[1,0,1]
    v_pk_fma_f32 v[120:121], v[136:137], v[172:173], v[120:121] op_sel:[0,1,0] op_sel_hi:[1,1,1]
    buffer_load_dwordx4 a[180:183], v44, s[48:51], s60 offen offset:1024 sc1
    v_pk_fma_f32 v[104:105], v[152:153], v[172:173], v[104:105] op_sel:[0,1,0] op_sel_hi:[1,1,1] neg_lo:[1,0,0] neg_hi:[1,0,0]
    v_pk_fma_f32 v[120:121], v[152:153], v[172:173], v[120:121] op_sel:[0,0,0] op_sel_hi:[1,0,1]
    v_pk_fma_f32 v[106:107], v[138:139], v[172:173], v[106:107] op_sel:[0,0,0] op_sel_hi:[1,0,1]
    buffer_load_dwordx4 a[184:187], v44, s[48:51], s60 offen offset:2048 sc1
    v_pk_fma_f32 v[122:123], v[138:139], v[172:173], v[122:123] op_sel:[0,1,0] op_sel_hi:[1,1,1]
    v_pk_fma_f32 v[106:107], v[154:155], v[172:173], v[106:107] op_sel:[0,1,0] op_sel_hi:[1,1,1] neg_lo:[1,0,0] neg_hi:[1,0,0]
    v_pk_fma_f32 v[122:123], v[154:155], v[172:173], v[122:123] op_sel:[0,0,0] op_sel_hi:[1,0,1]
    buffer_load_dwordx4 a[188:191], v44, s[48:51], s60 offen offset:3072 sc1
    v_pk_fma_f32 v[108:109], v[140:141], v[172:173], v[108:109] op_sel:[0,0,0] op_sel_hi:[1,0,1]
    v_pk_fma_f32 v[124:125], v[140:141], v[172:173], v[124:125] op_sel:[0,1,0] op_sel_hi:[1,1,1]
    v_pk_fma_f32 v[108:109], v[156:157], v[172:173], v[108:109] op_sel:[0,1,0] op_sel_hi:[1,1,1] neg_lo:[1,0,0] neg_hi:[1,0,0]
    v_pk_fma_f32 v[124:125], v[156:157], v[172:173], v[124:125] op_sel:[0,0,0] op_sel_hi:[1,0,1]
    v_pk_fma_f32 v[110:111], v[142:143], v[172:173], v[110:111] op_sel:[0,0,0] op_sel_hi:[1,0,1]
    v_pk_fma_f32 v[126:127], v[142:143], v[172:173], v[126:127] op_sel:[0,1,0] op_sel_hi:[1,1,1]
    v_pk_fma_f32 v[110:111], v[158:159], v[172:173], v[110:111] op_sel:[0,1,0] op_sel_hi:[1,1,1] neg_lo:[1,0,0] neg_hi:[1,0,0]
    v_pk_fma_f32 v[126:127], v[158:159], v[172:173], v[126:127] op_sel:[0,0,0] op_sel_hi:[1,0,1]
    v_cvt_pk_bf16_f32 v96, v96, v97
    v_cvt_pk_bf16_f32 v97, v98, v99
    v_cvt_pk_bf16_f32 v98, v100, v101
    v_cvt_pk_bf16_f32 v99, v102, v103
    ds_write_b128 v36, v[96:99]
    v_cvt_pk_bf16_f32 v104, v104, v105
    v_cvt_pk_bf16_f32 v105, v106, v107
    v_cvt_pk_bf16_f32 v106, v108, v109
    v_cvt_pk_bf16_f32 v107, v110, v111
    ds_write_b128 v37, v[104:107]
    ds_read_b64_tr_b16 v[100:101], v38 offset:0
    ds_read_b64_tr_b16 v[102:103], v39 offset:0
    ds_read_b64_tr_b16 v[108:109], v38 offset:1024
    ds_read_b64_tr_b16 v[110:111], v39 offset:1024
    v_cvt_pk_bf16_f32 v112, -v112, -v113
    v_cvt_pk_bf16_f32 v113, -v114, -v115
    v_cvt_pk_bf16_f32 v114, -v116, -v117
    v_cvt_pk_bf16_f32 v115, -v118, -v119
    ds_write_b128 v36, v[112:115]
    v_cvt_pk_bf16_f32 v120, -v120, -v121
    v_cvt_pk_bf16_f32 v121, -v122, -v123
    v_cvt_pk_bf16_f32 v122, -v124, -v125
    v_cvt_pk_bf16_f32 v123, -v126, -v127
    ds_write_b128 v37, v[120:123]
    ds_read_b64_tr_b16 v[116:117], v38 offset:0
    ds_read_b64_tr_b16 v[118:119], v39 offset:0
    ds_read_b64_tr_b16 v[124:125], v38 offset:1024
    ds_read_b64_tr_b16 v[126:127], v39 offset:1024
    s_add_u32 s41, s84, 1
    s_lshr_b32 s40, s41, 2
    s_lshl_b32 s40, s40, 1
    s_and_b32 s65, s41, 1
    s_add_u32 s40, s40, s65
    s_lshl_b32 s40, s40, 1
    s_bfe_u32 s65, s41, 0x10001
    s_add_u32 s40, s40, s65
    s_lshl_b32 s40, s40, 13
    s_add_u32 s40, s40, s64
    s_add_u32 s40, s40, 196608
    s_waitcnt lgkmcnt(6)
    buffer_store_dwordx4 v[100:103], v33, s[56:59], s40 offen offset:0 sc1
    buffer_store_dwordx4 v[108:111], v33, s[56:59], s40 offen offset:1024 sc1
    s_add_u32 s41, s84, 1
    s_lshr_b32 s40, s41, 2
    s_lshl_b32 s40, s40, 1
    s_and_b32 s65, s41, 1
    s_add_u32 s40, s40, s65
    s_lshl_b32 s40, s40, 1
    s_bfe_u32 s65, s41, 0x10001
    s_add_u32 s40, s40, s65
    s_lshl_b32 s40, s40, 13
    s_add_u32 s40, s40, s64
    s_add_u32 s40, s40, 200704
    s_waitcnt lgkmcnt(0)
    buffer_store_dwordx4 v[116:119], v33, s[56:59], s40 offen offset:0 sc1
    buffer_store_dwordx4 v[124:127], v33, s[56:59], s40 offen offset:1024 sc1
    s_mov_b32 s66, 88064
    s_waitcnt vmcnt(8)
    v_mfma_f32_16x16x32_bf16 v[96:99], a[208:211], a[160:163], 0
    s_bfe_u32 s60, 0x1010204, s89
    s_lshl_b32 s60, s60, 14
    buffer_load_dwordx4 a[192:195], v44, s[48:51], s60 offen offset:0 sc1
    v_mfma_f32_16x16x32_bf16 v[116:119], a[208:211], a[164:167], 0
    v_mfma_f32_16x16x32_bf16 v[136:139], a[208:211], a[168:171], 0
    buffer_load_dwordx4 a[196:199], v44, s[48:51], s60 offen offset:1024 sc1
    v_mfma_f32_16x16x32_bf16 v[156:159], a[208:211], a[172:175], 0
    v_mfma_f32_16x16x32_bf16 v[100:103], a[212:215], a[160:163], 0
    buffer_load_dwordx4 a[200:203], v44, s[48:51], s60 offen offset:2048 sc1
    v_mfma_f32_16x16x32_bf16 v[120:123], a[212:215], a[164:167], 0
    v_mfma_f32_16x16x32_bf16 v[140:143], a[212:215], a[168:171], 0
    buffer_load_dwordx4 a[204:207], v44, s[48:51], s60 offen offset:3072 sc1
    v_mfma_f32_16x16x32_bf16 v[160:163], a[212:215], a[172:175], 0
    v_mfma_f32_16x16x32_bf16 v[104:107], a[216:219], a[160:163], 0
    v_mfma_f32_16x16x32_bf16 v[124:127], a[216:219], a[164:167], 0
    v_mfma_f32_16x16x32_bf16 v[144:147], a[216:219], a[168:171], 0
    v_mfma_f32_16x16x32_bf16 v[164:167], a[216:219], a[172:175], 0
    v_mfma_f32_16x16x32_bf16 v[108:111], a[220:223], a[160:163], 0
    v_mfma_f32_16x16x32_bf16 v[128:131], a[220:223], a[164:167], 0
    v_mfma_f32_16x16x32_bf16 v[148:151], a[220:223], a[168:171], 0
    v_mfma_f32_16x16x32_bf16 v[168:171], a[220:223], a[172:175], 0
    v_mfma_f32_16x16x32_bf16 v[112:115], a[224:227], a[160:163], 0
    v_mfma_f32_16x16x32_bf16 v[132:135], a[224:227], a[164:167], 0
    v_mfma_f32_16x16x32_bf16 v[152:155], a[224:227], a[168:171], 0
    v_mfma_f32_16x16x32_bf16 v[172:175], a[224:227], a[172:175], 0
    s_waitcnt vmcnt(8)
    v_mfma_f32_16x16x32_bf16 v[96:99], a[228:231], a[176:179], v[96:99]
    s_bfe_u32 s60, 0x2030502, s89
    s_lshl_b32 s60, s60, 14
    buffer_load_dwordx4 a[160:163], v44, s[48:51], s60 offen offset:0 sc1
    s_mul_i32 s40, s88, 160
    s_mul_i32 s41, s87, 81920
    s_add_u32 s41, s41, s40
    s_add_u32 s44, s4, s41
    s_addc_u32 s45, s5, 0
    s_mov_b32 s46, 80800
    s_mov_b32 s47, 0x20000
    s_lshl_b32 s41, s41, 1
    s_add_u32 s16, s34, s41
    s_addc_u32 s17, s35, 0
    s_mov_b32 s18, 161600
    s_mov_b32 s19, 0x20000
    s_lshl_b32 s41, s87, 9
    s_add_u32 s41, s41, 15990784
    s_cmp_eq_u32 s86, 1
    s_cselect_b32 s65, 256, 0
    s_add_u32 s41, s41, s65
    s_cmp_eq_u32 s86, 2
    s_cselect_b32 s52, s20, s30
    s_cselect_b32 s53, s21, s31
    s_cmp_lt_u32 s86, 2
    s_cselect_b32 s52, s38, s52
    s_cselect_b32 s53, s39, s53
    s_cselect_b32 s40, s41, s40
    s_mov_b32 s65, 160
    s_cselect_b32 s54, 256, s65
    s_add_u32 s52, s52, s40
    s_addc_u32 s53, s53, 0
    s_mov_b32 s55, 0x20000
    v_add_u32 v84, 0, v0
    v_mul_u32_u24 v85, 0xcccd, v84
    v_mfma_f32_16x16x32_bf16 v[116:119], a[228:231], a[180:183], v[116:119]
    v_lshrrev_b32 v85, 20, v85
    v_mul_u32_u24 v86, 20, v85
    v_sub_u32 v86, v84, v86
    v_mfma_f32_16x16x32_bf16 v[136:139], a[228:231], a[184:187], v[136:139]
    buffer_load_dwordx4 a[164:167], v44, s[48:51], s60 offen offset:1024 sc1
    v_mul_u32_u24 v87, 1280, v85
    v_lshl_add_u32 v87, v86, 3, v87
    buffer_load_dwordx2 v[52:53], v87, s[44:47], 0 offen
    v_mfma_f32_16x16x32_bf16 v[156:159], a[228:231], a[188:191], v[156:159]
    v_lshlrev_b32 v67, 1, v87
    v_bfe_u32 v87, v85, 1, 2
    v_xor_b32 v87, v87, v86
    v_mfma_f32_16x16x32_bf16 v[100:103], a[232:235], a[176:179], v[100:103]
    buffer_load_dwordx4 a[168:171], v44, s[48:51], s60 offen offset:2048 sc1
    v_mul_u32_u24 v62, 320, v85
    v_add_u32 v62, 0, v62
    v_lshl_add_u32 v62, v87, 4, v62
    v_mfma_f32_16x16x32_bf16 v[120:123], a[232:235], a[180:183], v[120:123]
    v_lshl_add_u32 v72, v86, 3, s66
    v_lshl_add_u32 v73, v85, 3, s66
    v_add_u32 v84, 256, v0
    v_mfma_f32_16x16x32_bf16 v[140:143], a[232:235], a[184:187], v[140:143]
    buffer_load_dwordx4 a[172:175], v44, s[48:51], s60 offen offset:3072 sc1
    v_mul_u32_u24 v85, 0xcccd, v84
    v_lshrrev_b32 v85, 20, v85
    v_mul_u32_u24 v86, 20, v85
    v_mfma_f32_16x16x32_bf16 v[160:163], a[232:235], a[188:191], v[160:163]
    v_sub_u32 v86, v84, v86
    v_mul_u32_u24 v87, 1280, v85
    v_lshl_add_u32 v87, v86, 3, v87
    v_mfma_f32_16x16x32_bf16 v[104:107], a[236:239], a[176:179], v[104:107]
    s_bfe_u32 s61, 0x2030502, s89
    s_mul_i32 s61, s61, 20480
    buffer_load_dwordx4 a[208:211], v41, s[8:11], s61 offen offset:0 sc1
    buffer_load_dwordx2 v[54:55], v87, s[44:47], 0 offen
    v_lshlrev_b32 v68, 1, v87
    v_bfe_u32 v87, v85, 1, 2
    v_mfma_f32_16x16x32_bf16 v[124:127], a[236:239], a[180:183], v[124:127]
    v_xor_b32 v87, v87, v86
    v_mul_u32_u24 v63, 320, v85
    v_add_u32 v63, 0, v63
    v_mfma_f32_16x16x32_bf16 v[144:147], a[236:239], a[184:187], v[144:147]
    buffer_load_dwordx4 a[212:215], v41, s[8:11], s61 offen offset:1024 sc1
    v_lshl_add_u32 v63, v87, 4, v63
    v_lshl_add_u32 v74, v86, 3, s66
    v_lshl_add_u32 v75, v85, 3, s66
    v_mfma_f32_16x16x32_bf16 v[164:167], a[236:239], a[188:191], v[164:167]
    v_add_u32 v84, 512, v0
    v_mul_u32_u24 v85, 0xcccd, v84
    v_lshrrev_b32 v85, 20, v85
    v_mfma_f32_16x16x32_bf16 v[108:111], a[240:243], a[176:179], v[108:111]
    buffer_load_dwordx4 a[216:219], v41, s[8:11], s61 offen offset:2048 sc1
    v_mul_u32_u24 v86, 20, v85
    v_sub_u32 v86, v84, v86
    v_mul_u32_u24 v87, 1280, v85
    v_mfma_f32_16x16x32_bf16 v[128:131], a[240:243], a[180:183], v[128:131]
    v_lshl_add_u32 v87, v86, 3, v87
    buffer_load_dwordx2 v[56:57], v87, s[44:47], 0 offen
    v_lshlrev_b32 v69, 1, v87
    v_mfma_f32_16x16x32_bf16 v[148:151], a[240:243], a[184:187], v[148:151]
    buffer_load_dwordx4 a[220:223], v41, s[8:11], s61 offen offset:3072 sc1
    v_bfe_u32 v87, v85, 1, 2
    v_xor_b32 v87, v87, v86
    v_mul_u32_u24 v64, 320, v85
    v_mfma_f32_16x16x32_bf16 v[168:171], a[240:243], a[188:191], v[168:171]
    v_add_u32 v64, 0, v64
    v_lshl_add_u32 v64, v87, 4, v64
    v_lshl_add_u32 v76, v86, 3, s66
    v_mfma_f32_16x16x32_bf16 v[112:115], a[244:247], a[176:179], v[112:115]
    buffer_load_dwordx4 a[224:227], v42, s[8:11], s61 offen sc1
    v_lshl_add_u32 v77, v85, 3, s66
    v_add_u32 v84, 768, v0
    v_mul_u32_u24 v85, 0xcccd, v84
    v_mfma_f32_16x16x32_bf16 v[132:135], a[244:247], a[180:183], v[132:135]
    v_lshrrev_b32 v85, 20, v85
    v_mul_u32_u24 v86, 20, v85
    v_sub_u32 v86, v84, v86
    v_mfma_f32_16x16x32_bf16 v[152:155], a[244:247], a[184:187], v[152:155]
    v_mul_u32_u24 v87, 1280, v85
    v_lshl_add_u32 v87, v86, 3, v87
    buffer_load_dwordx2 v[58:59], v87, s[44:47], 0 offen
    v_mfma_f32_16x16x32_bf16 v[172:175], a[244:247], a[188:191], v[172:175]
    v_lshlrev_b32 v70, 1, v87
    v_bfe_u32 v87, v85, 1, 2
    v_xor_b32 v87, v87, v86
    s_waitcnt vmcnt(13)
    v_mfma_f32_16x16x32_bf16 v[96:99], v[12:15], a[192:195], v[96:99]
    s_add_u32 s65, s90, 131072
    s_mov_b64 exec, 1
    buffer_store_dword v47, v45, s[56:59], s65 offen sc1
    s_mov_b64 exec, -1
    s_bfe_u32 s60, 0x4060303, s89
    s_lshl_b32 s60, s60, 14
    buffer_load_dwordx4 a[176:179], v44, s[48:51], s60 offen offset:0 sc1
    v_mul_u32_u24 v65, 320, v85
    v_add_u32 v65, 0, v65
    v_lshl_add_u32 v65, v87, 4, v65
    v_mfma_f32_16x16x32_bf16 v[116:119], v[12:15], a[196:199], v[116:119]
    v_lshl_add_u32 v78, v86, 3, s66
    v_lshl_add_u32 v79, v85, 3, s66
    v_add_u32 v84, 1024, v0
    v_mfma_f32_16x16x32_bf16 v[136:139], v[12:15], a[200:203], v[136:139]
    buffer_load_dwordx4 a[180:183], v44, s[48:51], s60 offen offset:1024 sc1
    v_mul_u32_u24 v85, 0xcccd, v84
    v_lshrrev_b32 v85, 20, v85
    v_mul_u32_u24 v86, 20, v85
    v_mfma_f32_16x16x32_bf16 v[156:159], v[12:15], a[204:207], v[156:159]
    v_sub_u32 v86, v84, v86
    v_mul_u32_u24 v87, 1280, v85
    v_lshl_add_u32 v87, v86, 3, v87
    v_mfma_f32_16x16x32_bf16 v[100:103], v[16:19], a[192:195], v[100:103]
    buffer_load_dwordx4 a[184:187], v44, s[48:51], s60 offen offset:2048 sc1
    buffer_load_dwordx2 v[60:61], v87, s[44:47], 0 offen
    v_lshlrev_b32 v71, 1, v87
    v_bfe_u32 v87, v85, 1, 2
    v_mfma_f32_16x16x32_bf16 v[120:123], v[16:19], a[196:199], v[120:123]
    v_xor_b32 v87, v87, v86
    v_mul_u32_u24 v66, 320, v85
    v_add_u32 v66, 0, v66
    v_mfma_f32_16x16x32_bf16 v[140:143], v[16:19], a[200:203], v[140:143]
    buffer_load_dwordx4 a[188:191], v44, s[48:51], s60 offen offset:3072 sc1
    v_lshl_add_u32 v66, v87, 4, v66
    v_lshl_add_u32 v80, v86, 3, s66
    v_lshl_add_u32 v81, v85, 3, s66
    v_mfma_f32_16x16x32_bf16 v[160:163], v[16:19], a[204:207], v[160:163]
    v_and_b32 v84, 15, v1
    v_mul_u32_u24 v82, 320, v84
    v_lshrrev_b32 v85, 4, v1
    v_mfma_f32_16x16x32_bf16 v[104:107], v[20:23], a[192:195], v[104:107]
    s_bfe_u32 s61, 0x4060303, s89
    s_mul_i32 s61, s61, 20480
    buffer_load_dwordx4 a[228:231], v41, s[8:11], s61 offen offset:0 sc1
    v_bfe_u32 v86, v84, 1, 2
    v_xor_b32 v85, v85, v86
    v_lshl_add_u32 v82, v85, 4, v82
    v_mfma_f32_16x16x32_bf16 v[124:127], v[20:23], a[196:199], v[124:127]
    v_mul_u32_u24 v85, 20480, v2
    v_add_u32 v82, v82, v85
    v_add_u32 v82, 0, v82
    v_mfma_f32_16x16x32_bf16 v[144:147], v[20:23], a[200:203], v[144:147]
    buffer_load_dwordx4 a[232:235], v41, s[8:11], s61 offen offset:1024 sc1
    v_lshl_add_u32 v83, v84, 3, s66
    v_lshlrev_b32 v48, 2, v1
    s_lshl_b32 s40, s86, 8
    s_add_u32 m0, s40, 88064
    s_nop 0
    buffer_load_dword v48, s[52:55], 0 offen sc1 lds
    v_mfma_f32_16x16x32_bf16 v[164:167], v[20:23], a[204:207], v[164:167]
    v_mfma_f32_16x16x32_bf16 v[108:111], v[24:27], a[192:195], v[108:111]
    buffer_load_dwordx4 a[236:239], v41, s[8:11], s61 offen offset:2048 sc1
    v_mfma_f32_16x16x32_bf16 v[128:131], v[24:27], a[196:199], v[128:131]
    v_mfma_f32_16x16x32_bf16 v[148:151], v[24:27], a[200:203], v[148:151]
    buffer_load_dwordx4 a[240:243], v41, s[8:11], s61 offen offset:3072 sc1
    v_mfma_f32_16x16x32_bf16 v[168:171], v[24:27], a[204:207], v[168:171]
    v_mfma_f32_16x16x32_bf16 v[112:115], v[28:31], a[192:195], v[112:115]
    buffer_load_dwordx4 a[244:247], v42, s[8:11], s61 offen sc1
    v_mfma_f32_16x16x32_bf16 v[132:135], v[28:31], a[196:199], v[132:135]
    v_mfma_f32_16x16x32_bf16 v[152:155], v[28:31], a[200:203], v[152:155]
    v_mfma_f32_16x16x32_bf16 v[172:175], v[28:31], a[204:207], v[172:175]
    s_waitcnt vmcnt(13)
    v_mfma_f32_16x16x32_bf16 v[96:99], a[208:211], a[160:163], v[96:99]
    s_bfe_u32 s60, 0x7040405, s89
    s_lshl_b32 s60, s60, 14
    buffer_load_dwordx4 a[192:195], v44, s[48:51], s60 offen offset:0 sc1
    v_mfma_f32_16x16x32_bf16 v[116:119], a[208:211], a[164:167], v[116:119]
    v_mfma_f32_16x16x32_bf16 v[136:139], a[208:211], a[168:171], v[136:139]
    buffer_load_dwordx4 a[196:199], v44, s[48:51], s60 offen offset:1024 sc1
    v_mfma_f32_16x16x32_bf16 v[156:159], a[208:211], a[172:175], v[156:159]
    v_mfma_f32_16x16x32_bf16 v[100:103], a[212:215], a[160:163], v[100:103]
    buffer_load_dwordx4 a[200:203], v44, s[48:51], s60 offen offset:2048 sc1
    v_mfma_f32_16x16x32_bf16 v[120:123], a[212:215], a[164:167], v[120:123]
    v_mfma_f32_16x16x32_bf16 v[140:143], a[212:215], a[168:171], v[140:143]
    buffer_load_dwordx4 a[204:207], v44, s[48:51], s60 offen offset:3072 sc1
    v_mfma_f32_16x16x32_bf16 v[160:163], a[212:215], a[172:175], v[160:163]
    v_mfma_f32_16x16x32_bf16 v[104:107], a[216:219], a[160:163], v[104:107]
    s_bfe_u32 s61, 0x7040405, s89
    s_mul_i32 s61, s61, 20480
    buffer_load_dwordx4 v[12:15], v41, s[8:11], s61 offen offset:0 sc1
    v_mfma_f32_16x16x32_bf16 v[124:127], a[216:219], a[164:167], v[124:127]
    v_mfma_f32_16x16x32_bf16 v[144:147], a[216:219], a[168:171], v[144:147]
    buffer_load_dwordx4 v[16:19], v41, s[8:11], s61 offen offset:1024 sc1
    v_mfma_f32_16x16x32_bf16 v[164:167], a[216:219], a[172:175], v[164:167]
    v_mfma_f32_16x16x32_bf16 v[108:111], a[220:223], a[160:163], v[108:111]
    buffer_load_dwordx4 v[20:23], v41, s[8:11], s61 offen offset:2048 sc1
    v_mfma_f32_16x16x32_bf16 v[128:131], a[220:223], a[164:167], v[128:131]
    v_mfma_f32_16x16x32_bf16 v[148:151], a[220:223], a[168:171], v[148:151]
    buffer_load_dwordx4 v[24:27], v41, s[8:11], s61 offen offset:3072 sc1
    v_mfma_f32_16x16x32_bf16 v[168:171], a[220:223], a[172:175], v[168:171]
    v_mfma_f32_16x16x32_bf16 v[112:115], a[224:227], a[160:163], v[112:115]
    buffer_load_dwordx4 v[28:31], v42, s[8:11], s61 offen sc1
    v_mfma_f32_16x16x32_bf16 v[132:135], a[224:227], a[164:167], v[132:135]
    v_mfma_f32_16x16x32_bf16 v[152:155], a[224:227], a[168:171], v[152:155]
    v_mfma_f32_16x16x32_bf16 v[172:175], a[224:227], a[172:175], v[172:175]
    s_waitcnt vmcnt(9)
    v_mfma_f32_16x16x32_bf16 v[96:99], a[228:231], a[176:179], v[96:99]
    s_bfe_u32 s60, 0x5050608, s89
    s_lshl_b32 s60, s60, 14
    buffer_load_dwordx4 a[160:163], v44, s[48:51], s60 offen offset:0 sc1
    s_barrier
    ds_read_b64 v[32:33], v83 offset:0
    ds_read_b64 v[34:35], v83 offset:128
    v_mfma_f32_16x16x32_bf16 v[116:119], a[228:231], a[180:183], v[116:119]
    ds_read_b64 v[36:37], v83 offset:256
    ds_read_b64 v[38:39], v83 offset:384
    ds_read_b64 v[84:85], v73
    v_mfma_f32_16x16x32_bf16 v[136:139], a[228:231], a[184:187], v[136:139]
    buffer_load_dwordx4 a[164:167], v44, s[48:51], s60 offen offset:1024 sc1
    ds_read_b64 v[86:87], v72 offset:512
    ds_read_b64 v[88:89], v72 offset:768
    v_lshlrev_b32 v90, 16, v52
    v_mfma_f32_16x16x32_bf16 v[156:159], a[228:231], a[188:191], v[156:159]
    v_and_b32 v91, 0xffff0000, v52
    v_lshlrev_b32 v92, 16, v53
    v_and_b32 v93, 0xffff0000, v53
    v_mfma_f32_16x16x32_bf16 v[100:103], a[232:235], a[176:179], v[100:103]
    buffer_load_dwordx4 a[168:171], v44, s[48:51], s60 offen offset:2048 sc1
    s_waitcnt lgkmcnt(0)
    v_lshlrev_b32 v48, 16, v86
    v_and_b32 v49, 0xffff0000, v86
    v_mfma_f32_16x16x32_bf16 v[120:123], a[232:235], a[180:183], v[120:123]
    v_lshlrev_b32 v50, 16, v88
    v_and_b32 v51, 0xffff0000, v88
    v_mul_f32 v48, v48, v90
    v_mfma_f32_16x16x32_bf16 v[140:143], a[232:235], a[184:187], v[140:143]
    buffer_load_dwordx4 a[172:175], v44, s[48:51], s60 offen offset:3072 sc1
    v_mul_f32 v52, v85, v50
    v_fmac_f32 v52, v84, v48
    v_mul_f32 v49, v49, v91
    v_mfma_f32_16x16x32_bf16 v[160:163], a[232:235], a[188:191], v[160:163]
    v_mul_f32 v53, v85, v51
    v_fmac_f32 v53, v84, v49
    v_lshlrev_b32 v48, 16, v87
    v_mfma_f32_16x16x32_bf16 v[104:107], a[236:239], a[176:179], v[104:107]
    s_bfe_u32 s61, 0x5050608, s89
    s_mul_i32 s61, s61, 20480
    buffer_load_dwordx4 a[208:211], v41, s[8:11], s61 offen offset:0 sc1
    v_and_b32 v49, 0xffff0000, v87
    v_lshlrev_b32 v50, 16, v89
    v_and_b32 v51, 0xffff0000, v89
    v_mfma_f32_16x16x32_bf16 v[124:127], a[236:239], a[180:183], v[124:127]
    v_mul_f32 v48, v48, v92
    v_mul_f32 v72, v85, v50
    v_fmac_f32 v72, v84, v48
    v_mfma_f32_16x16x32_bf16 v[144:147], a[236:239], a[184:187], v[144:147]
    buffer_load_dwordx4 a[212:215], v41, s[8:11], s61 offen offset:1024 sc1
    v_mul_f32 v49, v49, v93
    v_mul_f32 v73, v85, v51
    v_fmac_f32 v73, v84, v49
    v_mfma_f32_16x16x32_bf16 v[164:167], a[236:239], a[188:191], v[164:167]
    ds_read_b64 v[84:85], v75
    ds_read_b64 v[86:87], v74 offset:512
    ds_read_b64 v[88:89], v74 offset:768
    v_mfma_f32_16x16x32_bf16 v[108:111], a[240:243], a[176:179], v[108:111]
    buffer_load_dwordx4 a[216:219], v41, s[8:11], s61 offen offset:2048 sc1
    v_lshlrev_b32 v90, 16, v54
    v_and_b32 v91, 0xffff0000, v54
    v_lshlrev_b32 v92, 16, v55
    v_mfma_f32_16x16x32_bf16 v[128:131], a[240:243], a[180:183], v[128:131]
    v_and_b32 v93, 0xffff0000, v55
    s_waitcnt lgkmcnt(0)
    v_lshlrev_b32 v48, 16, v86
    v_mfma_f32_16x16x32_bf16 v[148:151], a[240:243], a[184:187], v[148:151]
    buffer_load_dwordx4 a[220:223], v41, s[8:11], s61 offen offset:3072 sc1
    v_and_b32 v49, 0xffff0000, v86
    v_lshlrev_b32 v50, 16, v88
    v_and_b32 v51, 0xffff0000, v88
    v_mfma_f32_16x16x32_bf16 v[168:171], a[240:243], a[188:191], v[168:171]
    v_mul_f32 v48, v48, v90
    v_mul_f32 v54, v85, v50
    v_fmac_f32 v54, v84, v48
    v_mfma_f32_16x16x32_bf16 v[112:115], a[244:247], a[176:179], v[112:115]
    buffer_load_dwordx4 a[224:227], v42, s[8:11], s61 offen sc1
    v_mul_f32 v49, v49, v91
    v_mul_f32 v55, v85, v51
    v_fmac_f32 v55, v84, v49
    v_mfma_f32_16x16x32_bf16 v[132:135], a[244:247], a[180:183], v[132:135]
    v_lshlrev_b32 v48, 16, v87
    v_and_b32 v49, 0xffff0000, v87
    v_lshlrev_b32 v50, 16, v89
    v_mfma_f32_16x16x32_bf16 v[152:155], a[244:247], a[184:187], v[152:155]
    v_and_b32 v51, 0xffff0000, v89
    v_mul_f32 v48, v48, v92
    v_mul_f32 v74, v85, v50
    v_mfma_f32_16x16x32_bf16 v[172:175], a[244:247], a[188:191], v[172:175]
    v_fmac_f32 v74, v84, v48
    v_mul_f32 v49, v49, v93
    v_mul_f32 v75, v85, v51
    s_waitcnt vmcnt(9)
    v_mfma_f32_16x16x32_bf16 v[96:99], v[12:15], a[192:195], v[96:99]
    s_bfe_u32 s60, 0x6070906, s89
    s_lshl_b32 s60, s60, 14
    buffer_load_dwordx4 a[176:179], v44, s[48:51], s60 offen offset:0 sc1
    v_fmac_f32 v75, v84, v49
    ds_read_b64 v[84:85], v77
    ds_read_b64 v[86:87], v76 offset:512
    v_mfma_f32_16x16x32_bf16 v[116:119], v[12:15], a[196:199], v[116:119]
    ds_read_b64 v[88:89], v76 offset:768
    v_lshlrev_b32 v90, 16, v56
    v_and_b32 v91, 0xffff0000, v56
    v_mfma_f32_16x16x32_bf16 v[136:139], v[12:15], a[200:203], v[136:139]
    buffer_load_dwordx4 a[180:183], v44, s[48:51], s60 offen offset:1024 sc1
    v_lshlrev_b32 v92, 16, v57
    v_and_b32 v93, 0xffff0000, v57
    s_waitcnt lgkmcnt(0)
    v_mfma_f32_16x16x32_bf16 v[156:159], v[12:15], a[204:207], v[156:159]
    v_lshlrev_b32 v48, 16, v86
    v_and_b32 v49, 0xffff0000, v86
    v_lshlrev_b32 v50, 16, v88
    v_mfma_f32_16x16x32_bf16 v[100:103], v[16:19], a[192:195], v[100:103]
    buffer_load_dwordx4 a[184:187], v44, s[48:51], s60 offen offset:2048 sc1
    v_and_b32 v51, 0xffff0000, v88
    v_mul_f32 v48, v48, v90
    v_mul_f32 v56, v85, v50
    v_mfma_f32_16x16x32_bf16 v[120:123], v[16:19], a[196:199], v[120:123]
    v_fmac_f32 v56, v84, v48
    v_mul_f32 v49, v49, v91
    v_mul_f32 v57, v85, v51
    v_mfma_f32_16x16x32_bf16 v[140:143], v[16:19], a[200:203], v[140:143]
    buffer_load_dwordx4 a[188:191], v44, s[48:51], s60 offen offset:3072 sc1
    v_fmac_f32 v57, v84, v49
    v_lshlrev_b32 v48, 16, v87
    v_and_b32 v49, 0xffff0000, v87
    v_mfma_f32_16x16x32_bf16 v[160:163], v[16:19], a[204:207], v[160:163]
    v_lshlrev_b32 v50, 16, v89
    v_and_b32 v51, 0xffff0000, v89
    v_mul_f32 v48, v48, v92
    v_mfma_f32_16x16x32_bf16 v[104:107], v[20:23], a[192:195], v[104:107]
    s_bfe_u32 s61, 0x6070906, s89
    s_mul_i32 s61, s61, 20480
    buffer_load_dwordx4 a[228:231], v41, s[8:11], s61 offen offset:0 sc1
    v_mul_f32 v76, v85, v50
    v_fmac_f32 v76, v84, v48
    v_mul_f32 v49, v49, v93
    v_mfma_f32_16x16x32_bf16 v[124:127], v[20:23], a[196:199], v[124:127]
    v_mul_f32 v77, v85, v51
    v_fmac_f32 v77, v84, v49
    ds_read_b64 v[84:85], v79
    v_mfma_f32_16x16x32_bf16 v[144:147], v[20:23], a[200:203], v[144:147]
    buffer_load_dwordx4 a[232:235], v41, s[8:11], s61 offen offset:1024 sc1
    ds_read_b64 v[86:87], v78 offset:512
    ds_read_b64 v[88:89], v78 offset:768
    v_lshlrev_b32 v90, 16, v58
    v_mfma_f32_16x16x32_bf16 v[164:167], v[20:23], a[204:207], v[164:167]
    v_and_b32 v91, 0xffff0000, v58
    v_lshlrev_b32 v92, 16, v59
    v_and_b32 v93, 0xffff0000, v59
    v_mfma_f32_16x16x32_bf16 v[108:111], v[24:27], a[192:195], v[108:111]
    buffer_load_dwordx4 a[236:239], v41, s[8:11], s61 offen offset:2048 sc1
    s_waitcnt lgkmcnt(0)
    v_lshlrev_b32 v48, 16, v86
    v_and_b32 v49, 0xffff0000, v86
    v_mfma_f32_16x16x32_bf16 v[128:131], v[24:27], a[196:199], v[128:131]
    v_lshlrev_b32 v50, 16, v88
    v_and_b32 v51, 0xffff0000, v88
    v_mul_f32 v48, v48, v90
    v_mfma_f32_16x16x32_bf16 v[148:151], v[24:27], a[200:203], v[148:151]
    buffer_load_dwordx4 a[240:243], v41, s[8:11], s61 offen offset:3072 sc1
    v_mul_f32 v58, v85, v50
    v_fmac_f32 v58, v84, v48
    v_mul_f32 v49, v49, v91
    v_mfma_f32_16x16x32_bf16 v[168:171], v[24:27], a[204:207], v[168:171]
    v_mul_f32 v59, v85, v51
    v_fmac_f32 v59, v84, v49
    v_lshlrev_b32 v48, 16, v87
    v_mfma_f32_16x16x32_bf16 v[112:115], v[28:31], a[192:195], v[112:115]
    buffer_load_dwordx4 a[244:247], v42, s[8:11], s61 offen sc1
    v_and_b32 v49, 0xffff0000, v87
    v_lshlrev_b32 v50, 16, v89
    v_and_b32 v51, 0xffff0000, v89
    v_mfma_f32_16x16x32_bf16 v[132:135], v[28:31], a[196:199], v[132:135]
    v_mul_f32 v48, v48, v92
    v_mul_f32 v78, v85, v50
    v_fmac_f32 v78, v84, v48
    v_mfma_f32_16x16x32_bf16 v[152:155], v[28:31], a[200:203], v[152:155]
    v_mul_f32 v49, v49, v93
    v_mul_f32 v79, v85, v51
    v_fmac_f32 v79, v84, v49
    v_mfma_f32_16x16x32_bf16 v[172:175], v[28:31], a[204:207], v[172:175]
    ds_read_b64 v[84:85], v81
    ds_read_b64 v[86:87], v80 offset:512
    ds_read_b64 v[88:89], v80 offset:768
    s_waitcnt vmcnt(9)
    v_mfma_f32_16x16x32_bf16 v[96:99], a[208:211], a[160:163], v[96:99]
    s_bfe_u32 s60, 0x80a0707, s89
    s_lshl_b32 s60, s60, 14
    buffer_load_dwordx4 a[192:195], v44, s[48:51], s60 offen offset:0 sc1
    v_lshlrev_b32 v90, 16, v60
    v_and_b32 v91, 0xffff0000, v60
    v_lshlrev_b32 v92, 16, v61
    v_mfma_f32_16x16x32_bf16 v[116:119], a[208:211], a[164:167], v[116:119]
    v_and_b32 v93, 0xffff0000, v61
    s_waitcnt lgkmcnt(0)
    v_lshlrev_b32 v48, 16, v86
    v_mfma_f32_16x16x32_bf16 v[136:139], a[208:211], a[168:171], v[136:139]
    buffer_load_dwordx4 a[196:199], v44, s[48:51], s60 offen offset:1024 sc1
    v_and_b32 v49, 0xffff0000, v86
    v_lshlrev_b32 v50, 16, v88
    v_and_b32 v51, 0xffff0000, v88
    v_mfma_f32_16x16x32_bf16 v[156:159], a[208:211], a[172:175], v[156:159]
    v_mul_f32 v48, v48, v90
    v_mul_f32 v60, v85, v50
    v_fmac_f32 v60, v84, v48
    v_mfma_f32_16x16x32_bf16 v[100:103], a[212:215], a[160:163], v[100:103]
    buffer_load_dwordx4 a[200:203], v44, s[48:51], s60 offen offset:2048 sc1
    v_mul_f32 v49, v49, v91
    v_mul_f32 v61, v85, v51
    v_fmac_f32 v61, v84, v49
    v_mfma_f32_16x16x32_bf16 v[120:123], a[212:215], a[164:167], v[120:123]
    v_lshlrev_b32 v48, 16, v87
    v_and_b32 v49, 0xffff0000, v87
    v_lshlrev_b32 v50, 16, v89
    v_mfma_f32_16x16x32_bf16 v[140:143], a[212:215], a[168:171], v[140:143]
    buffer_load_dwordx4 a[204:207], v44, s[48:51], s60 offen offset:3072 sc1
    v_and_b32 v51, 0xffff0000, v89
    v_mul_f32 v48, v48, v92
    v_mul_f32 v80, v85, v50
    v_mfma_f32_16x16x32_bf16 v[160:163], a[212:215], a[172:175], v[160:163]
    v_fmac_f32 v80, v84, v48
    v_mul_f32 v49, v49, v93
    v_mul_f32 v81, v85, v51
    v_mfma_f32_16x16x32_bf16 v[104:107], a[216:219], a[160:163], v[104:107]
    s_bfe_u32 s61, 0x80a0707, s89
    s_mul_i32 s61, s61, 20480
    buffer_load_dwordx4 v[12:15], v41, s[8:11], s61 offen offset:0 sc1
    v_fmac_f32 v81, v84, v49
    v_add_f32 v32, v32, v32
    v_add_f32 v34, v34, v34
    v_mfma_f32_16x16x32_bf16 v[124:127], a[216:219], a[164:167], v[124:127]
    v_add_f32 v36, v36, v36
    v_add_f32 v38, v38, v38
    v_mfma_f32_16x16x32_bf16 v[144:147], a[216:219], a[168:171], v[144:147]
    buffer_load_dwordx4 v[16:19], v41, s[8:11], s61 offen offset:1024 sc1
    v_mfma_f32_16x16x32_bf16 v[164:167], a[216:219], a[172:175], v[164:167]
    v_mfma_f32_16x16x32_bf16 v[108:111], a[220:223], a[160:163], v[108:111]
    buffer_load_dwordx4 v[20:23], v41, s[8:11], s61 offen offset:2048 sc1
    v_mfma_f32_16x16x32_bf16 v[128:131], a[220:223], a[164:167], v[128:131]
    v_mfma_f32_16x16x32_bf16 v[148:151], a[220:223], a[168:171], v[148:151]
    buffer_load_dwordx4 v[24:27], v41, s[8:11], s61 offen offset:3072 sc1
    v_mfma_f32_16x16x32_bf16 v[168:171], a[220:223], a[172:175], v[168:171]
    v_mfma_f32_16x16x32_bf16 v[112:115], a[224:227], a[160:163], v[112:115]
    buffer_load_dwordx4 v[28:31], v42, s[8:11], s61 offen sc1
    v_mfma_f32_16x16x32_bf16 v[132:135], a[224:227], a[164:167], v[132:135]
    v_mfma_f32_16x16x32_bf16 v[152:155], a[224:227], a[168:171], v[152:155]
    v_mfma_f32_16x16x32_bf16 v[172:175], a[224:227], a[172:175], v[172:175]
    s_waitcnt vmcnt(9)
    v_mfma_f32_16x16x32_bf16 v[96:99], a[228:231], a[176:179], v[96:99]
    s_cmp_lg_u32 s86, 0
    s_cbranch_scc1 L_w0_34
    s_mov_b32 s40, 131072
    s_mov_b32 exec_hi, 0
    buffer_load_dword v46, v43, s[56:59], s40 offen sc1
    s_mov_b32 exec_hi, -1
L_w0_34:
    s_bfe_u32 s60, 0xb080809, s89
    s_lshl_b32 s60, s60, 14
    buffer_load_dwordx4 a[160:163], v44, s[48:51], s60 offen offset:0 sc1
    v_mfma_f32_16x16x32_bf16 v[116:119], a[228:231], a[180:183], v[116:119]
    v_mfma_f32_16x16x32_bf16 v[136:139], a[228:231], a[184:187], v[136:139]
    buffer_load_dwordx4 a[164:167], v44, s[48:51], s60 offen offset:1024 sc1
    v_mfma_f32_16x16x32_bf16 v[156:159], a[228:231], a[188:191], v[156:159]
    v_mfma_f32_16x16x32_bf16 v[100:103], a[232:235], a[176:179], v[100:103]
    buffer_load_dwordx4 a[168:171], v44, s[48:51], s60 offen offset:2048 sc1
    v_mfma_f32_16x16x32_bf16 v[120:123], a[232:235], a[180:183], v[120:123]
    v_mfma_f32_16x16x32_bf16 v[140:143], a[232:235], a[184:187], v[140:143]
    buffer_load_dwordx4 a[172:175], v44, s[48:51], s60 offen offset:3072 sc1
    v_mfma_f32_16x16x32_bf16 v[160:163], a[232:235], a[188:191], v[160:163]
    v_mfma_f32_16x16x32_bf16 v[104:107], a[236:239], a[176:179], v[104:107]
    s_bfe_u32 s61, 0xb080809, s89
    s_mul_i32 s61, s61, 20480
    buffer_load_dwordx4 a[208:211], v41, s[8:11], s61 offen offset:0 sc1
    v_mfma_f32_16x16x32_bf16 v[124:127], a[236:239], a[180:183], v[124:127]
    v_mfma_f32_16x16x32_bf16 v[144:147], a[236:239], a[184:187], v[144:147]
    buffer_load_dwordx4 a[212:215], v41, s[8:11], s61 offen offset:1024 sc1
    v_mfma_f32_16x16x32_bf16 v[164:167], a[236:239], a[188:191], v[164:167]
    v_mfma_f32_16x16x32_bf16 v[108:111], a[240:243], a[176:179], v[108:111]
    buffer_load_dwordx4 a[216:219], v41, s[8:11], s61 offen offset:2048 sc1
    v_mfma_f32_16x16x32_bf16 v[128:131], a[240:243], a[180:183], v[128:131]
    v_mfma_f32_16x16x32_bf16 v[148:151], a[240:243], a[184:187], v[148:151]
    buffer_load_dwordx4 a[220:223], v41, s[8:11], s61 offen offset:3072 sc1
    v_mfma_f32_16x16x32_bf16 v[168:171], a[240:243], a[188:191], v[168:171]
    v_mfma_f32_16x16x32_bf16 v[112:115], a[244:247], a[176:179], v[112:115]
    buffer_load_dwordx4 a[224:227], v42, s[8:11], s61 offen sc1
    v_mfma_f32_16x16x32_bf16 v[132:135], a[244:247], a[180:183], v[132:135]
    v_mfma_f32_16x16x32_bf16 v[152:155], a[244:247], a[184:187], v[152:155]
    v_mfma_f32_16x16x32_bf16 v[172:175], a[244:247], a[188:191], v[172:175]
    s_waitcnt vmcnt(9)
    v_mfma_f32_16x16x32_bf16 v[96:99], v[12:15], a[192:195], v[96:99]
    s_cmp_lg_u32 s86, 0
    s_cbranch_scc1 L_w0_35
    s_waitcnt vmcnt(9)
    s_mov_b32 s65, 0
L_sp_36:
    v_cmp_ne_u32 vcc, s80, v46
    s_nop 0
    s_cmp_eq_u32 vcc_lo, 0
    s_cbranch_scc1 L_sp_37
    s_add_u32 s65, s65, 1
    s_cmp_gt_u32 s65, 100000
    s_cbranch_scc1 L_sp_37
    s_mov_b32 s40, 131072
    s_mov_b32 exec_hi, 0
    buffer_load_dword v46, v43, s[56:59], s40 offen sc1
    s_mov_b32 exec_hi, -1
    s_waitcnt vmcnt(0)
    s_branch L_sp_36
L_sp_37:
L_w0_35:
    s_barrier
    s_bfe_u32 s60, 0x3030403, s89
    s_lshl_b32 s60, s60, 15
    s_add_u32 s60, s60, 196608
    buffer_load_dwordx4 a[176:179], v44, s[48:51], s60 offen offset:0 sc1
    ds_read_b128 a[128:131], v8 offset:0
    ds_read_b128 a[132:135], v9 offset:0
    ds_read_b128 a[136:139], v8 offset:2048
    v_mfma_f32_16x16x32_bf16 v[116:119], v[12:15], a[196:199], v[116:119]
    ds_read_b128 a[140:143], v9 offset:2048
    ds_read_b128 a[144:147], v8 offset:4096
    ds_read_b128 a[148:151], v9 offset:4096
    v_mfma_f32_16x16x32_bf16 v[136:139], v[12:15], a[200:203], v[136:139]
    buffer_load_dwordx4 a[180:183], v44, s[48:51], s60 offen offset:1024 sc1
    ds_read_b128 a[152:155], v8 offset:6144
    ds_read_b128 a[156:159], v9 offset:6144
    v_mfma_f32_16x16x32_bf16 v[156:159], v[12:15], a[204:207], v[156:159]
    v_mfma_f32_16x16x32_bf16 v[100:103], v[16:19], a[192:195], v[100:103]
    buffer_load_dwordx4 a[184:187], v44, s[48:51], s60 offen offset:2048 sc1
    v_mfma_f32_16x16x32_bf16 v[120:123], v[16:19], a[196:199], v[120:123]
    v_mfma_f32_16x16x32_bf16 v[140:143], v[16:19], a[200:203], v[140:143]
    buffer_load_dwordx4 a[188:191], v44, s[48:51], s60 offen offset:3072 sc1
    v_mfma_f32_16x16x32_bf16 v[160:163], v[16:19], a[204:207], v[160:163]
    v_mfma_f32_16x16x32_bf16 v[104:107], v[20:23], a[192:195], v[104:107]
    s_bfe_u32 s61, 0x9090a0a, s89
    s_mul_i32 s61, s61, 20480
    buffer_load_dwordx4 a[228:231], v41, s[8:11], s61 offen offset:0 sc1
    v_mfma_f32_16x16x32_bf16 v[124:127], v[20:23], a[196:199], v[124:127]
    v_mfma_f32_16x16x32_bf16 v[144:147], v[20:23], a[200:203], v[144:147]
    v_mfma_f32_16x16x32_bf16 v[164:167], v[20:23], a[204:207], v[164:167]
    v_mfma_f32_16x16x32_bf16 v[108:111], v[24:27], a[192:195], v[108:111]
    v_mfma_f32_16x16x32_bf16 v[128:131], v[24:27], a[196:199], v[128:131]
    v_mfma_f32_16x16x32_bf16 v[148:151], v[24:27], a[200:203], v[148:151]
    v_mfma_f32_16x16x32_bf16 v[168:171], v[24:27], a[204:207], v[168:171]
    v_mfma_f32_16x16x32_bf16 v[112:115], v[28:31], a[192:195], v[112:115]
    v_mfma_f32_16x16x32_bf16 v[132:135], v[28:31], a[196:199], v[132:135]
    v_mfma_f32_16x16x32_bf16 v[152:155], v[28:31], a[200:203], v[152:155]
    v_mfma_f32_16x16x32_bf16 v[172:175], v[28:31], a[204:207], v[172:175]
    s_waitcnt vmcnt(5)
    v_mfma_f32_16x16x32_bf16 v[96:99], a[208:211], a[160:163], v[96:99]
    s_bfe_u32 s60, 0x3030403, s89
    s_lshl_b32 s60, s60, 15
    s_add_u32 s60, s60, 212992
    buffer_load_dwordx4 a[192:195], v44, s[48:51], s60 offen offset:0 sc1
    v_mfma_f32_16x16x32_bf16 v[116:119], a[208:211], a[164:167], v[116:119]
    v_mfma_f32_16x16x32_bf16 v[136:139], a[208:211], a[168:171], v[136:139]
    buffer_load_dwordx4 a[196:199], v44, s[48:51], s60 offen offset:1024 sc1
    v_mfma_f32_16x16x32_bf16 v[156:159], a[208:211], a[172:175], v[156:159]
    v_mfma_f32_16x16x32_bf16 v[100:103], a[212:215], a[160:163], v[100:103]
    buffer_load_dwordx4 a[200:203], v44, s[48:51], s60 offen offset:2048 sc1
    v_mfma_f32_16x16x32_bf16 v[120:123], a[212:215], a[164:167], v[120:123]
    v_mfma_f32_16x16x32_bf16 v[140:143], a[212:215], a[168:171], v[140:143]
    buffer_load_dwordx4 a[204:207], v44, s[48:51], s60 offen offset:3072 sc1
    v_mfma_f32_16x16x32_bf16 v[160:163], a[212:215], a[172:175], v[160:163]
    v_mfma_f32_16x16x32_bf16 v[104:107], a[216:219], a[160:163], v[104:107]
    buffer_load_dwordx4 a[232:235], v41, s[8:11], s61 offen offset:1024 sc1
    v_mfma_f32_16x16x32_bf16 v[124:127], a[216:219], a[164:167], v[124:127]
    v_mfma_f32_16x16x32_bf16 v[144:147], a[216:219], a[168:171], v[144:147]
    v_mfma_f32_16x16x32_bf16 v[164:167], a[216:219], a[172:175], v[164:167]
    v_mfma_f32_16x16x32_bf16 v[108:111], a[220:223], a[160:163], v[108:111]
    v_mfma_f32_16x16x32_bf16 v[128:131], a[220:223], a[164:167], v[128:131]
    v_mfma_f32_16x16x32_bf16 v[148:151], a[220:223], a[168:171], v[148:151]
    v_mfma_f32_16x16x32_bf16 v[168:171], a[220:223], a[172:175], v[168:171]
    v_mfma_f32_16x16x32_bf16 v[112:115], a[224:227], a[160:163], v[112:115]
    v_mfma_f32_16x16x32_bf16 v[132:135], a[224:227], a[164:167], v[132:135]
    v_mfma_f32_16x16x32_bf16 v[152:155], a[224:227], a[168:171], v[152:155]
    v_mfma_f32_16x16x32_bf16 v[172:175], a[224:227], a[172:175], v[172:175]
    s_waitcnt vmcnt(6)
    v_mfma_f32_16x16x32_bf16 v[176:179], a[0:3], a[176:179], 0
    s_bfe_u32 s60, 0x4000304, s89
    s_lshl_b32 s60, s60, 15
    s_add_u32 s60, s60, 196608
    buffer_load_dwordx4 a[160:163], v44, s[48:51], s60 offen offset:0 sc1
    v_mfma_f32_16x16x32_bf16 v[196:199], a[0:3], a[180:183], 0
    v_mfma_f32_16x16x32_bf16 v[216:219], a[0:3], a[184:187], 0
    buffer_load_dwordx4 a[164:167], v44, s[48:51], s60 offen offset:1024 sc1
    v_mfma_f32_16x16x32_bf16 v[236:239], a[0:3], a[188:191], 0
    v_mfma_f32_16x16x32_bf16 v[180:183], a[8:11], a[176:179], 0
    buffer_load_dwordx4 a[168:171], v44, s[48:51], s60 offen offset:2048 sc1
    v_mfma_f32_16x16x32_bf16 v[200:203], a[8:11], a[180:183], 0
    v_mfma_f32_16x16x32_bf16 v[220:223], a[8:11], a[184:187], 0
    buffer_load_dwordx4 a[172:175], v44, s[48:51], s60 offen offset:3072 sc1
    v_mfma_f32_16x16x32_bf16 v[240:243], a[8:11], a[188:191], 0
    v_mfma_f32_16x16x32_bf16 v[184:187], a[16:19], a[176:179], 0
    buffer_load_dwordx4 a[236:239], v41, s[8:11], s61 offen offset:2048 sc1
    v_mfma_f32_16x16x32_bf16 v[204:207], a[16:19], a[180:183], 0
    v_mfma_f32_16x16x32_bf16 v[224:227], a[16:19], a[184:187], 0
    v_mfma_f32_16x16x32_bf16 v[244:247], a[16:19], a[188:191], 0
    v_mfma_f32_16x16x32_bf16 v[188:191], a[24:27], a[176:179], 0
    v_mfma_f32_16x16x32_bf16 v[208:211], a[24:27], a[180:183], 0
    v_mfma_f32_16x16x32_bf16 v[228:231], a[24:27], a[184:187], 0
    v_mfma_f32_16x16x32_bf16 v[248:251], a[24:27], a[188:191], 0
    v_mfma_f32_16x16x32_bf16 v[192:195], a[32:35], a[176:179], 0
    v_mfma_f32_16x16x32_bf16 v[212:215], a[32:35], a[180:183], 0
    v_mfma_f32_16x16x32_bf16 v[232:235], a[32:35], a[184:187], 0
    v_mfma_f32_16x16x32_bf16 v[252:255], a[32:35], a[188:191], 0
    s_waitcnt vmcnt(6)
    v_mfma_f32_16x16x32_bf16 v[176:179], a[4:7], a[192:195], v[176:179]
    s_bfe_u32 s60, 0x4000304, s89
    s_lshl_b32 s60, s60, 15
    s_add_u32 s60, s60, 212992
    buffer_load_dwordx4 a[176:179], v44, s[48:51], s60 offen offset:0 sc1
    v_mfma_f32_16x16x32_bf16 v[196:199], a[4:7], a[196:199], v[196:199]
    v_mfma_f32_16x16x32_bf16 v[216:219], a[4:7], a[200:203], v[216:219]
    buffer_load_dwordx4 a[180:183], v44, s[48:51], s60 offen offset:1024 sc1
    v_mfma_f32_16x16x32_bf16 v[236:239], a[4:7], a[204:207], v[236:239]
    v_mfma_f32_16x16x32_bf16 v[180:183], a[12:15], a[192:195], v[180:183]
    buffer_load_dwordx4 a[184:187], v44, s[48:51], s60 offen offset:2048 sc1
    v_mfma_f32_16x16x32_bf16 v[200:203], a[12:15], a[196:199], v[200:203]
    v_mfma_f32_16x16x32_bf16 v[220:223], a[12:15], a[200:203], v[220:223]
    buffer_load_dwordx4 a[188:191], v44, s[48:51], s60 offen offset:3072 sc1
    v_mfma_f32_16x16x32_bf16 v[240:243], a[12:15], a[204:207], v[240:243]
    v_mfma_f32_16x16x32_bf16 v[184:187], a[20:23], a[192:195], v[184:187]
    buffer_load_dwordx4 a[240:243], v41, s[8:11], s61 offen offset:3072 sc1
    v_mfma_f32_16x16x32_bf16 v[204:207], a[20:23], a[196:199], v[204:207]
    v_mfma_f32_16x16x32_bf16 v[224:227], a[20:23], a[200:203], v[224:227]
    v_mfma_f32_16x16x32_bf16 v[244:247], a[20:23], a[204:207], v[244:247]
    v_mfma_f32_16x16x32_bf16 v[188:191], a[28:31], a[192:195], v[188:191]
    v_mfma_f32_16x16x32_bf16 v[208:211], a[28:31], a[196:199], v[208:211]
    v_mfma_f32_16x16x32_bf16 v[228:231], a[28:31], a[200:203], v[228:231]
    v_mfma_f32_16x16x32_bf16 v[248:251], a[28:31], a[204:207], v[248:251]
    v_mfma_f32_16x16x32_bf16 v[192:195], a[36:39], a[192:195], v[192:195]
    v_mfma_f32_16x16x32_bf16 v[212:215], a[36:39], a[196:199], v[212:215]
    v_mfma_f32_16x16x32_bf16 v[232:235], a[36:39], a[200:203], v[232:235]
    v_mfma_f32_16x16x32_bf16 v[252:255], a[36:39], a[204:207], v[252:255]
    s_waitcnt vmcnt(6)
    v_mfma_f32_16x16x32_bf16 v[176:179], a[40:43], a[160:163], v[176:179]
    s_bfe_u32 s60, 0x9090a0a, s89
    s_lshl_b32 s60, s60, 14
    buffer_load_dwordx4 a[192:195], v44, s[48:51], s60 offen offset:0 sc1
    ds_read_b128 a[0:3], v8 offset:32768
    ds_read_b128 a[4:7], v9 offset:32768
    v_mfma_f32_16x16x32_bf16 v[196:199], a[40:43], a[164:167], v[196:199]
    ds_read_b128 a[8:11], v8 offset:34816
    ds_read_b128 a[12:15], v9 offset:34816
    v_mfma_f32_16x16x32_bf16 v[216:219], a[40:43], a[168:171], v[216:219]
    buffer_load_dwordx4 a[196:199], v44, s[48:51], s60 offen offset:1024 sc1
    ds_read_b128 a[16:19], v8 offset:36864
    ds_read_b128 a[20:23], v9 offset:36864
    v_mfma_f32_16x16x32_bf16 v[236:239], a[40:43], a[172:175], v[236:239]
    ds_read_b128 a[24:27], v8 offset:38912
    ds_read_b128 a[28:31], v9 offset:38912
    v_mfma_f32_16x16x32_bf16 v[180:183], a[48:51], a[160:163], v[180:183]
    buffer_load_dwordx4 a[200:203], v44, s[48:51], s60 offen offset:2048 sc1
    ds_read_b128 a[32:35], v6 offset:0
    ds_read_b128 a[36:39], v7 offset:0
    v_mfma_f32_16x16x32_bf16 v[200:203], a[48:51], a[164:167], v[200:203]
    v_mfma_f32_16x16x32_bf16 v[220:223], a[48:51], a[168:171], v[220:223]
    buffer_load_dwordx4 a[204:207], v44, s[48:51], s60 offen offset:3072 sc1
    v_mfma_f32_16x16x32_bf16 v[240:243], a[48:51], a[172:175], v[240:243]
    v_mfma_f32_16x16x32_bf16 v[184:187], a[56:59], a[160:163], v[184:187]
    buffer_load_dwordx4 a[244:247], v42, s[8:11], s61 offen sc1
    v_mfma_f32_16x16x32_bf16 v[204:207], a[56:59], a[164:167], v[204:207]
    v_mfma_f32_16x16x32_bf16 v[224:227], a[56:59], a[168:171], v[224:227]
    v_mfma_f32_16x16x32_bf16 v[244:247], a[56:59], a[172:175], v[244:247]
    v_mfma_f32_16x16x32_bf16 v[188:191], a[64:67], a[160:163], v[188:191]
    v_mfma_f32_16x16x32_bf16 v[208:211], a[64:67], a[164:167], v[208:211]
    v_mfma_f32_16x16x32_bf16 v[228:231], a[64:67], a[168:171], v[228:231]
    v_mfma_f32_16x16x32_bf16 v[248:251], a[64:67], a[172:175], v[248:251]
    v_mfma_f32_16x16x32_bf16 v[192:195], a[72:75], a[160:163], v[192:195]
    v_mfma_f32_16x16x32_bf16 v[212:215], a[72:75], a[164:167], v[212:215]
    v_mfma_f32_16x16x32_bf16 v[232:235], a[72:75], a[168:171], v[232:235]
    v_mfma_f32_16x16x32_bf16 v[252:255], a[72:75], a[172:175], v[252:255]
    s_waitcnt vmcnt(6)
    v_mfma_f32_16x16x32_bf16 v[176:179], a[44:47], a[176:179], v[176:179]
    s_bfe_u32 s60, 0x1040000, s89
    s_lshl_b32 s60, s60, 15
    s_add_u32 s60, s60, 196608
    buffer_load_dwordx4 a[160:163], v44, s[48:51], s60 offen offset:0 sc1
    v_mfma_f32_16x16x32_bf16 v[196:199], a[44:47], a[180:183], v[196:199]
    v_mfma_f32_16x16x32_bf16 v[216:219], a[44:47], a[184:187], v[216:219]
    buffer_load_dwordx4 a[164:167], v44, s[48:51], s60 offen offset:1024 sc1
    v_mfma_f32_16x16x32_bf16 v[236:239], a[44:47], a[188:191], v[236:239]
    v_mfma_f32_16x16x32_bf16 v[180:183], a[52:55], a[176:179], v[180:183]
    buffer_load_dwordx4 a[168:171], v44, s[48:51], s60 offen offset:2048 sc1
    v_mfma_f32_16x16x32_bf16 v[200:203], a[52:55], a[180:183], v[200:203]
    v_mfma_f32_16x16x32_bf16 v[220:223], a[52:55], a[184:187], v[220:223]
    buffer_load_dwordx4 a[172:175], v44, s[48:51], s60 offen offset:3072 sc1
    v_mfma_f32_16x16x32_bf16 v[240:243], a[52:55], a[188:191], v[240:243]
    v_mfma_f32_16x16x32_bf16 v[184:187], a[60:63], a[176:179], v[184:187]
    s_bfe_u32 s61, 0xa0b0b0b, s89
    s_mul_i32 s61, s61, 20480
    buffer_load_dwordx4 v[12:15], v41, s[8:11], s61 offen offset:0 sc1
    v_mfma_f32_16x16x32_bf16 v[204:207], a[60:63], a[180:183], v[204:207]
    v_mfma_f32_16x16x32_bf16 v[224:227], a[60:63], a[184:187], v[224:227]
    buffer_load_dwordx4 v[16:19], v41, s[8:11], s61 offen offset:1024 sc1
    v_mfma_f32_16x16x32_bf16 v[244:247], a[60:63], a[188:191], v[244:247]
    v_mfma_f32_16x16x32_bf16 v[188:191], a[68:71], a[176:179], v[188:191]
    v_mfma_f32_16x16x32_bf16 v[208:211], a[68:71], a[180:183], v[208:211]
    v_mfma_f32_16x16x32_bf16 v[228:231], a[68:71], a[184:187], v[228:231]
    v_mfma_f32_16x16x32_bf16 v[248:251], a[68:71], a[188:191], v[248:251]
    v_mfma_f32_16x16x32_bf16 v[192:195], a[76:79], a[176:179], v[192:195]
    v_mfma_f32_16x16x32_bf16 v[212:215], a[76:79], a[180:183], v[212:215]
    v_mfma_f32_16x16x32_bf16 v[232:235], a[76:79], a[184:187], v[232:235]
    v_mfma_f32_16x16x32_bf16 v[252:255], a[76:79], a[188:191], v[252:255]
    s_waitcnt vmcnt(6)
    v_mfma_f32_16x16x32_bf16 v[96:99], a[228:231], a[192:195], v[96:99]
    s_waitcnt lgkmcnt(0)
    s_barrier
    s_bfe_u32 s60, 0x1040000, s89
    s_lshl_b32 s60, s60, 15
    s_add_u32 s60, s60, 212992
    buffer_load_dwordx4 a[176:179], v44, s[48:51], s60 offen offset:0 sc1
    v_mfma_f32_16x16x32_bf16 v[116:119], a[228:231], a[196:199], v[116:119]
    v_mfma_f32_16x16x32_bf16 v[136:139], a[228:231], a[200:203], v[136:139]
    buffer_load_dwordx4 a[180:183], v44, s[48:51], s60 offen offset:1024 sc1
    v_mfma_f32_16x16x32_bf16 v[156:159], a[228:231], a[204:207], v[156:159]
    v_mfma_f32_16x16x32_bf16 v[100:103], a[232:235], a[192:195], v[100:103]
    buffer_load_dwordx4 a[184:187], v44, s[48:51], s60 offen offset:2048 sc1
    v_mfma_f32_16x16x32_bf16 v[120:123], a[232:235], a[196:199], v[120:123]
    v_mfma_f32_16x16x32_bf16 v[140:143], a[232:235], a[200:203], v[140:143]
    buffer_load_dwordx4 a[188:191], v44, s[48:51], s60 offen offset:3072 sc1
    v_mfma_f32_16x16x32_bf16 v[160:163], a[232:235], a[204:207], v[160:163]
    v_mfma_f32_16x16x32_bf16 v[104:107], a[236:239], a[192:195], v[104:107]
    buffer_load_dwordx4 v[20:23], v41, s[8:11], s61 offen offset:2048 sc1
    v_mfma_f32_16x16x32_bf16 v[124:127], a[236:239], a[196:199], v[124:127]
    v_mfma_f32_16x16x32_bf16 v[144:147], a[236:239], a[200:203], v[144:147]
    v_mfma_f32_16x16x32_bf16 v[164:167], a[236:239], a[204:207], v[164:167]
    v_mfma_f32_16x16x32_bf16 v[108:111], a[240:243], a[192:195], v[108:111]
    v_mfma_f32_16x16x32_bf16 v[128:131], a[240:243], a[196:199], v[128:131]
    v_mfma_f32_16x16x32_bf16 v[148:151], a[240:243], a[200:203], v[148:151]
    v_mfma_f32_16x16x32_bf16 v[168:171], a[240:243], a[204:207], v[168:171]
    v_mfma_f32_16x16x32_bf16 v[112:115], a[244:247], a[192:195], v[112:115]
    v_mfma_f32_16x16x32_bf16 v[132:135], a[244:247], a[196:199], v[132:135]
    v_mfma_f32_16x16x32_bf16 v[152:155], a[244:247], a[200:203], v[152:155]
    v_mfma_f32_16x16x32_bf16 v[172:175], a[244:247], a[204:207], v[172:175]
    s_waitcnt vmcnt(7)
    v_mfma_f32_16x16x32_bf16 v[176:179], a[80:83], a[160:163], v[176:179]
    s_bfe_u32 s60, 0x10102, s89
    s_lshl_b32 s60, s60, 15
    s_add_u32 s60, s60, 196608
    buffer_load_dwordx4 a[192:195], v44, s[48:51], s60 offen offset:0 sc1
    v_mfma_f32_16x16x32_bf16 v[196:199], a[80:83], a[164:167], v[196:199]
    v_mfma_f32_16x16x32_bf16 v[216:219], a[80:83], a[168:171], v[216:219]
    buffer_load_dwordx4 a[196:199], v44, s[48:51], s60 offen offset:1024 sc1
    v_mfma_f32_16x16x32_bf16 v[236:239], a[80:83], a[172:175], v[236:239]
    v_mfma_f32_16x16x32_bf16 v[180:183], a[88:91], a[160:163], v[180:183]
    buffer_load_dwordx4 a[200:203], v44, s[48:51], s60 offen offset:2048 sc1
    v_mfma_f32_16x16x32_bf16 v[200:203], a[88:91], a[164:167], v[200:203]
    v_mfma_f32_16x16x32_bf16 v[220:223], a[88:91], a[168:171], v[220:223]
    buffer_load_dwordx4 a[204:207], v44, s[48:51], s60 offen offset:3072 sc1
    v_mfma_f32_16x16x32_bf16 v[240:243], a[88:91], a[172:175], v[240:243]
    v_mfma_f32_16x16x32_bf16 v[184:187], a[96:99], a[160:163], v[184:187]
    buffer_load_dwordx4 v[24:27], v41, s[8:11], s61 offen offset:3072 sc1
    v_mfma_f32_16x16x32_bf16 v[204:207], a[96:99], a[164:167], v[204:207]
    v_mfma_f32_16x16x32_bf16 v[224:227], a[96:99], a[168:171], v[224:227]
    v_mfma_f32_16x16x32_bf16 v[244:247], a[96:99], a[172:175], v[244:247]
    v_mfma_f32_16x16x32_bf16 v[188:191], a[104:107], a[160:163], v[188:191]
    v_mfma_f32_16x16x32_bf16 v[208:211], a[104:107], a[164:167], v[208:211]
    v_mfma_f32_16x16x32_bf16 v[228:231], a[104:107], a[168:171], v[228:231]
    v_mfma_f32_16x16x32_bf16 v[248:251], a[104:107], a[172:175], v[248:251]
    v_mfma_f32_16x16x32_bf16 v[192:195], a[112:115], a[160:163], v[192:195]
    v_mfma_f32_16x16x32_bf16 v[212:215], a[112:115], a[164:167], v[212:215]
    v_mfma_f32_16x16x32_bf16 v[232:235], a[112:115], a[168:171], v[232:235]
    v_mfma_f32_16x16x32_bf16 v[252:255], a[112:115], a[172:175], v[252:255]
    s_waitcnt vmcnt(6)
    v_mfma_f32_16x16x32_bf16 v[176:179], a[84:87], a[176:179], v[176:179]
    s_bfe_u32 s60, 0xa0b0b0b, s89
    s_lshl_b32 s60, s60, 14
    buffer_load_dwordx4 a[160:163], v44, s[48:51], s60 offen offset:0 sc1
    v_mfma_f32_16x16x32_bf16 v[196:199], a[84:87], a[180:183], v[196:199]
    v_mfma_f32_16x16x32_bf16 v[216:219], a[84:87], a[184:187], v[216:219]
    buffer_load_dwordx4 a[164:167], v44, s[48:51], s60 offen offset:1024 sc1
    v_mfma_f32_16x16x32_bf16 v[236:239], a[84:87], a[188:191], v[236:239]
    v_mfma_f32_16x16x32_bf16 v[180:183], a[92:95], a[176:179], v[180:183]
    buffer_load_dwordx4 a[168:171], v44, s[48:51], s60 offen offset:2048 sc1
    v_mfma_f32_16x16x32_bf16 v[200:203], a[92:95], a[180:183], v[200:203]
    v_mfma_f32_16x16x32_bf16 v[220:223], a[92:95], a[184:187], v[220:223]
    buffer_load_dwordx4 a[172:175], v44, s[48:51], s60 offen offset:3072 sc1
    v_mfma_f32_16x16x32_bf16 v[240:243], a[92:95], a[188:191], v[240:243]
    v_mfma_f32_16x16x32_bf16 v[184:187], a[100:103], a[176:179], v[184:187]
    buffer_load_dwordx4 v[28:31], v42, s[8:11], s61 offen sc1
    v_mfma_f32_16x16x32_bf16 v[204:207], a[100:103], a[180:183], v[204:207]
    v_mfma_f32_16x16x32_bf16 v[224:227], a[100:103], a[184:187], v[224:227]
    v_mfma_f32_16x16x32_bf16 v[244:247], a[100:103], a[188:191], v[244:247]
    v_mfma_f32_16x16x32_bf16 v[188:191], a[108:111], a[176:179], v[188:191]
    v_mfma_f32_16x16x32_bf16 v[208:211], a[108:111], a[180:183], v[208:211]
    v_mfma_f32_16x16x32_bf16 v[228:231], a[108:111], a[184:187], v[228:231]
    v_mfma_f32_16x16x32_bf16 v[248:251], a[108:111], a[188:191], v[248:251]
    v_mfma_f32_16x16x32_bf16 v[192:195], a[116:119], a[176:179], v[192:195]
    v_mfma_f32_16x16x32_bf16 v[212:215], a[116:119], a[180:183], v[212:215]
    v_mfma_f32_16x16x32_bf16 v[232:235], a[116:119], a[184:187], v[232:235]
    v_mfma_f32_16x16x32_bf16 v[252:255], a[116:119], a[188:191], v[252:255]
    s_waitcnt vmcnt(6)
    v_mfma_f32_16x16x32_bf16 v[176:179], a[120:123], a[192:195], v[176:179]
    s_bfe_u32 s60, 0x10102, s89
    s_lshl_b32 s60, s60, 15
    s_add_u32 s60, s60, 212992
    buffer_load_dwordx4 a[176:179], v44, s[48:51], s60 offen offset:0 sc1
    v_mfma_f32_16x16x32_bf16 v[196:199], a[120:123], a[196:199], v[196:199]
    v_mfma_f32_16x16x32_bf16 v[216:219], a[120:123], a[200:203], v[216:219]
    buffer_load_dwordx4 a[180:183], v44, s[48:51], s60 offen offset:1024 sc1
    v_mfma_f32_16x16x32_bf16 v[236:239], a[120:123], a[204:207], v[236:239]
    v_mfma_f32_16x16x32_bf16 v[180:183], a[128:131], a[192:195], v[180:183]
    buffer_load_dwordx4 a[184:187], v44, s[48:51], s60 offen offset:2048 sc1
    v_mfma_f32_16x16x32_bf16 v[200:203], a[128:131], a[196:199], v[200:203]
    v_mfma_f32_16x16x32_bf16 v[220:223], a[128:131], a[200:203], v[220:223]
    buffer_load_dwordx4 a[188:191], v44, s[48:51], s60 offen offset:3072 sc1
    v_mfma_f32_16x16x32_bf16 v[240:243], a[128:131], a[204:207], v[240:243]
    v_mfma_f32_16x16x32_bf16 v[184:187], a[136:139], a[192:195], v[184:187]
    v_mfma_f32_16x16x32_bf16 v[204:207], a[136:139], a[196:199], v[204:207]
    v_mfma_f32_16x16x32_bf16 v[224:227], a[136:139], a[200:203], v[224:227]
    v_mfma_f32_16x16x32_bf16 v[244:247], a[136:139], a[204:207], v[244:247]
    v_mfma_f32_16x16x32_bf16 v[188:191], a[144:147], a[192:195], v[188:191]
    v_mfma_f32_16x16x32_bf16 v[208:211], a[144:147], a[196:199], v[208:211]
    v_mfma_f32_16x16x32_bf16 v[228:231], a[144:147], a[200:203], v[228:231]
    v_mfma_f32_16x16x32_bf16 v[248:251], a[144:147], a[204:207], v[248:251]
    v_mfma_f32_16x16x32_bf16 v[192:195], a[152:155], a[192:195], v[192:195]
    v_mfma_f32_16x16x32_bf16 v[212:215], a[152:155], a[196:199], v[212:215]
    v_mfma_f32_16x16x32_bf16 v[232:235], a[152:155], a[200:203], v[232:235]
    v_mfma_f32_16x16x32_bf16 v[252:255], a[152:155], a[204:207], v[252:255]
    s_waitcnt vmcnt(4)
    v_mfma_f32_16x16x32_bf16 v[96:99], v[12:15], a[160:163], v[96:99]
    s_bfe_u32 s60, 0x2020201, s89
    s_lshl_b32 s60, s60, 15
    s_add_u32 s60, s60, 196608
    buffer_load_dwordx4 a[192:195], v44, s[48:51], s60 offen offset:0 sc1
    v_mfma_f32_16x16x32_bf16 v[116:119], v[12:15], a[164:167], v[116:119]
    v_mfma_f32_16x16x32_bf16 v[136:139], v[12:15], a[168:171], v[136:139]
    buffer_load_dwordx4 a[196:199], v44, s[48:51], s60 offen offset:1024 sc1
    v_mfma_f32_16x16x32_bf16 v[156:159], v[12:15], a[172:175], v[156:159]
    v_mfma_f32_16x16x32_bf16 v[100:103], v[16:19], a[160:163], v[100:103]
    buffer_load_dwordx4 a[200:203], v44, s[48:51], s60 offen offset:2048 sc1
    v_mfma_f32_16x16x32_bf16 v[120:123], v[16:19], a[164:167], v[120:123]
    v_mfma_f32_16x16x32_bf16 v[140:143], v[16:19], a[168:171], v[140:143]
    buffer_load_dwordx4 a[204:207], v44, s[48:51], s60 offen offset:3072 sc1
    v_mfma_f32_16x16x32_bf16 v[160:163], v[16:19], a[172:175], v[160:163]
    v_mfma_f32_16x16x32_bf16 v[104:107], v[20:23], a[160:163], v[104:107]
    v_mfma_f32_16x16x32_bf16 v[124:127], v[20:23], a[164:167], v[124:127]
    v_mfma_f32_16x16x32_bf16 v[144:147], v[20:23], a[168:171], v[144:147]
    v_mfma_f32_16x16x32_bf16 v[164:167], v[20:23], a[172:175], v[164:167]
    v_mfma_f32_16x16x32_bf16 v[108:111], v[24:27], a[160:163], v[108:111]
    v_mfma_f32_16x16x32_bf16 v[128:131], v[24:27], a[164:167], v[128:131]
    v_mfma_f32_16x16x32_bf16 v[148:151], v[24:27], a[168:171], v[148:151]
    v_mfma_f32_16x16x32_bf16 v[168:171], v[24:27], a[172:175], v[168:171]
    v_mfma_f32_16x16x32_bf16 v[112:115], v[28:31], a[160:163], v[112:115]
    v_mfma_f32_16x16x32_bf16 v[132:135], v[28:31], a[164:167], v[132:135]
    v_mfma_f32_16x16x32_bf16 v[152:155], v[28:31], a[168:171], v[152:155]
    v_mfma_f32_16x16x32_bf16 v[172:175], v[28:31], a[172:175], v[172:175]
    s_waitcnt vmcnt(4)
    v_mfma_f32_16x16x32_bf16 v[176:179], a[124:127], a[176:179], v[176:179]
    s_bfe_u32 s60, 0x2020201, s89
    s_lshl_b32 s60, s60, 15
    s_add_u32 s60, s60, 212992
    buffer_load_dwordx4 a[160:163], v44, s[48:51], s60 offen offset:0 sc1
    v_mul_f32 v96, v33, v96
    v_mul_f32 v97, v33, v97
    v_mfma_f32_16x16x32_bf16 v[196:199], a[124:127], a[180:183], v[196:199]
    v_mul_f32 v98, v33, v98
    v_mul_f32 v99, v33, v99
    v_mfma_f32_16x16x32_bf16 v[216:219], a[124:127], a[184:187], v[216:219]
    buffer_load_dwordx4 a[164:167], v44, s[48:51], s60 offen offset:1024 sc1
    v_mul_f32 v100, v33, v100
    v_mul_f32 v101, v33, v101
    v_mfma_f32_16x16x32_bf16 v[236:239], a[124:127], a[188:191], v[236:239]
    v_mul_f32 v102, v33, v102
    v_mul_f32 v103, v33, v103
    v_mfma_f32_16x16x32_bf16 v[180:183], a[132:135], a[176:179], v[180:183]
    buffer_load_dwordx4 a[168:171], v44, s[48:51], s60 offen offset:2048 sc1
    v_mul_f32 v104, v33, v104
    v_mul_f32 v105, v33, v105
    v_mfma_f32_16x16x32_bf16 v[200:203], a[132:135], a[180:183], v[200:203]
    v_mul_f32 v106, v33, v106
    v_mul_f32 v107, v33, v107
    v_mfma_f32_16x16x32_bf16 v[220:223], a[132:135], a[184:187], v[220:223]
    buffer_load_dwordx4 a[172:175], v44, s[48:51], s60 offen offset:3072 sc1
    v_mul_f32 v108, v33, v108
    v_mul_f32 v109, v33, v109
    v_mfma_f32_16x16x32_bf16 v[240:243], a[132:135], a[188:191], v[240:243]
    v_mul_f32 v110, v33, v110
    v_mul_f32 v111, v33, v111
    v_mfma_f32_16x16x32_bf16 v[184:187], a[140:143], a[176:179], v[184:187]
    v_mul_f32 v112, v33, v112
    v_mul_f32 v113, v33, v113
    v_mfma_f32_16x16x32_bf16 v[204:207], a[140:143], a[180:183], v[204:207]
    v_mul_f32 v114, v33, v114
    v_mul_f32 v115, v33, v115
    v_mfma_f32_16x16x32_bf16 v[224:227], a[140:143], a[184:187], v[224:227]
    v_mul_f32 v116, v35, v116
    v_mul_f32 v117, v35, v117
    v_mfma_f32_16x16x32_bf16 v[244:247], a[140:143], a[188:191], v[244:247]
    v_mul_f32 v118, v35, v118
    v_mul_f32 v119, v35, v119
    v_mfma_f32_16x16x32_bf16 v[188:191], a[148:151], a[176:179], v[188:191]
    v_mul_f32 v120, v35, v120
    v_mul_f32 v121, v35, v121
    v_mfma_f32_16x16x32_bf16 v[208:211], a[148:151], a[180:183], v[208:211]
    v_mul_f32 v122, v35, v122
    v_mul_f32 v123, v35, v123
    v_mfma_f32_16x16x32_bf16 v[228:231], a[148:151], a[184:187], v[228:231]
    v_mul_f32 v124, v35, v124
    v_mul_f32 v125, v35, v125
    v_mfma_f32_16x16x32_bf16 v[248:251], a[148:151], a[188:191], v[248:251]
    v_mul_f32 v126, v35, v126
    v_mul_f32 v127, v35, v127
    v_mfma_f32_16x16x32_bf16 v[192:195], a[156:159], a[176:179], v[192:195]
    v_mul_f32 v128, v35, v128
    v_mul_f32 v129, v35, v129
    v_mfma_f32_16x16x32_bf16 v[212:215], a[156:159], a[180:183], v[212:215]
    v_mul_f32 v130, v35, v130
    v_mul_f32 v131, v35, v131
    v_mfma_f32_16x16x32_bf16 v[232:235], a[156:159], a[184:187], v[232:235]
    v_mul_f32 v132, v35, v132
    v_mul_f32 v133, v35, v133
    v_mfma_f32_16x16x32_bf16 v[252:255], a[156:159], a[188:191], v[252:255]
    v_mul_f32 v134, v35, v134
    v_mul_f32 v135, v35, v135
    s_waitcnt vmcnt(4)
    v_mfma_f32_16x16x32_bf16 v[176:179], a[0:3], a[192:195], v[176:179]
    v_mul_f32 v136, v37, v136
    v_mul_f32 v137, v37, v137
    v_mfma_f32_16x16x32_bf16 v[196:199], a[0:3], a[196:199], v[196:199]
    v_mul_f32 v138, v37, v138
    v_mul_f32 v139, v37, v139
    v_mfma_f32_16x16x32_bf16 v[216:219], a[0:3], a[200:203], v[216:219]
    v_mul_f32 v140, v37, v140
    v_mul_f32 v141, v37, v141
    v_mfma_f32_16x16x32_bf16 v[236:239], a[0:3], a[204:207], v[236:239]
    v_mul_f32 v142, v37, v142
    v_mul_f32 v143, v37, v143
    v_mfma_f32_16x16x32_bf16 v[180:183], a[8:11], a[192:195], v[180:183]
    v_mul_f32 v144, v37, v144
    v_mul_f32 v145, v37, v145
    v_mfma_f32_16x16x32_bf16 v[200:203], a[8:11], a[196:199], v[200:203]
    v_mul_f32 v146, v37, v146
    v_mul_f32 v147, v37, v147
    v_mfma_f32_16x16x32_bf16 v[220:223], a[8:11], a[200:203], v[220:223]
    v_mul_f32 v148, v37, v148
    v_mul_f32 v149, v37, v149
    v_mfma_f32_16x16x32_bf16 v[240:243], a[8:11], a[204:207], v[240:243]
    v_mul_f32 v150, v37, v150
    v_mul_f32 v151, v37, v151
    v_mfma_f32_16x16x32_bf16 v[184:187], a[16:19], a[192:195], v[184:187]
    v_mul_f32 v152, v37, v152
    v_mul_f32 v153, v37, v153
    v_mfma_f32_16x16x32_bf16 v[204:207], a[16:19], a[196:199], v[204:207]
    v_mul_f32 v154, v37, v154
    v_mul_f32 v155, v37, v155
    v_mfma_f32_16x16x32_bf16 v[224:227], a[16:19], a[200:203], v[224:227]
    v_mul_f32 v156, v39, v156
    v_mul_f32 v157, v39, v157
    v_mfma_f32_16x16x32_bf16 v[244:247], a[16:19], a[204:207], v[244:247]
    v_mul_f32 v158, v39, v158
    v_mul_f32 v159, v39, v159
    v_mfma_f32_16x16x32_bf16 v[188:191], a[24:27], a[192:195], v[188:191]
    v_mul_f32 v160, v39, v160
    v_mul_f32 v161, v39, v161
    v_mfma_f32_16x16x32_bf16 v[208:211], a[24:27], a[196:199], v[208:211]
    v_mul_f32 v162, v39, v162
    v_mul_f32 v163, v39, v163
    v_mfma_f32_16x16x32_bf16 v[228:231], a[24:27], a[200:203], v[228:231]
    v_mul_f32 v164, v39, v164
    v_mul_f32 v165, v39, v165
    v_mfma_f32_16x16x32_bf16 v[248:251], a[24:27], a[204:207], v[248:251]
    v_mul_f32 v166, v39, v166
    v_mul_f32 v167, v39, v167
    v_mfma_f32_16x16x32_bf16 v[192:195], a[32:35], a[192:195], v[192:195]
    v_mul_f32 v168, v39, v168
    v_mul_f32 v169, v39, v169
    v_mfma_f32_16x16x32_bf16 v[212:215], a[32:35], a[196:199], v[212:215]
    v_mul_f32 v170, v39, v170
    v_mul_f32 v171, v39, v171
    v_mfma_f32_16x16x32_bf16 v[232:235], a[32:35], a[200:203], v[232:235]
    v_mul_f32 v172, v39, v172
    v_mul_f32 v173, v39, v173
    v_mfma_f32_16x16x32_bf16 v[252:255], a[32:35], a[204:207], v[252:255]
    v_mul_f32 v174, v39, v174
    v_mul_f32 v175, v39, v175
    s_waitcnt vmcnt(0)
    v_mfma_f32_16x16x32_bf16 v[176:179], a[4:7], a[160:163], v[176:179]
    v_mfma_f32_16x16x32_bf16 v[180:183], a[12:15], a[160:163], v[180:183]
    v_mfma_f32_16x16x32_bf16 v[184:187], a[20:23], a[160:163], v[184:187]
    v_mfma_f32_16x16x32_bf16 v[188:191], a[28:31], a[160:163], v[188:191]
    s_nop 4
    v_fmac_f32 v96, v32, v176
    v_fmac_f32 v97, v32, v177
    v_fmac_f32 v98, v32, v178
    v_fmac_f32 v99, v32, v179
    ds_write_b128 v82, v[96:99] offset:0
    v_mfma_f32_16x16x32_bf16 v[192:195], a[36:39], a[160:163], v[192:195]
    v_fmac_f32 v100, v32, v180
    v_fmac_f32 v101, v32, v181
    v_fmac_f32 v102, v32, v182
    v_fmac_f32 v103, v32, v183
    ds_write_b128 v82, v[100:103] offset:64
    v_mfma_f32_16x16x32_bf16 v[196:199], a[4:7], a[164:167], v[196:199]
    v_fmac_f32 v104, v32, v184
    v_fmac_f32 v105, v32, v185
    v_fmac_f32 v106, v32, v186
    v_fmac_f32 v107, v32, v187
    ds_write_b128 v82, v[104:107] offset:128
    v_mfma_f32_16x16x32_bf16 v[200:203], a[12:15], a[164:167], v[200:203]
    v_fmac_f32 v108, v32, v188
    v_fmac_f32 v109, v32, v189
    v_fmac_f32 v110, v32, v190
    v_fmac_f32 v111, v32, v191
    ds_write_b128 v82, v[108:111] offset:192
    v_mfma_f32_16x16x32_bf16 v[204:207], a[20:23], a[164:167], v[204:207]
    v_fmac_f32 v112, v32, v192
    v_fmac_f32 v113, v32, v193
    v_fmac_f32 v114, v32, v194
    v_fmac_f32 v115, v32, v195
    ds_write_b128 v82, v[112:115] offset:256
    v_mfma_f32_16x16x32_bf16 v[208:211], a[28:31], a[164:167], v[208:211]
    v_fmac_f32 v116, v34, v196
    v_fmac_f32 v117, v34, v197
    v_fmac_f32 v118, v34, v198
    v_fmac_f32 v119, v34, v199
    ds_write_b128 v82, v[116:119] offset:5120
    v_mfma_f32_16x16x32_bf16 v[212:215], a[36:39], a[164:167], v[212:215]
    v_fmac_f32 v120, v34, v200
    v_fmac_f32 v121, v34, v201
    v_fmac_f32 v122, v34, v202
    v_fmac_f32 v123, v34, v203
    ds_write_b128 v82, v[120:123] offset:5184
    v_mfma_f32_16x16x32_bf16 v[216:219], a[4:7], a[168:171], v[216:219]
    v_fmac_f32 v124, v34, v204
    v_fmac_f32 v125, v34, v205
    v_fmac_f32 v126, v34, v206
    v_fmac_f32 v127, v34, v207
    ds_write_b128 v82, v[124:127] offset:5248
    v_mfma_f32_16x16x32_bf16 v[220:223], a[12:15], a[168:171], v[220:223]
    v_fmac_f32 v128, v34, v208
    v_fmac_f32 v129, v34, v209
    v_fmac_f32 v130, v34, v210
    v_fmac_f32 v131, v34, v211
    ds_write_b128 v82, v[128:131] offset:5312
    v_mfma_f32_16x16x32_bf16 v[224:227], a[20:23], a[168:171], v[224:227]
    v_fmac_f32 v132, v34, v212
    v_fmac_f32 v133, v34, v213
    v_fmac_f32 v134, v34, v214
    v_fmac_f32 v135, v34, v215
    ds_write_b128 v82, v[132:135] offset:5376
    v_mfma_f32_16x16x32_bf16 v[228:231], a[28:31], a[168:171], v[228:231]
    v_mfma_f32_16x16x32_bf16 v[232:235], a[36:39], a[168:171], v[232:235]
    v_mfma_f32_16x16x32_bf16 v[236:239], a[4:7], a[172:175], v[236:239]
    v_mfma_f32_16x16x32_bf16 v[240:243], a[12:15], a[172:175], v[240:243]
    v_mfma_f32_16x16x32_bf16 v[244:247], a[20:23], a[172:175], v[244:247]
    v_mfma_f32_16x16x32_bf16 v[248:251], a[28:31], a[172:175], v[248:251]
    v_mfma_f32_16x16x32_bf16 v[252:255], a[36:39], a[172:175], v[252:255]
    s_waitcnt lgkmcnt(0)
    s_barrier
    ds_read_b128 v[176:179], v62 offset:0
    ds_read_b128 v[180:183], v62 offset:20480
    ds_read_b128 v[184:187], v62 offset:40960
    ds_read_b128 v[188:191], v62 offset:61440
    ds_read_b128 v[192:195], v63 offset:0
    ds_read_b128 v[196:199], v63 offset:20480
    ds_read_b128 v[200:203], v63 offset:40960
    ds_read_b128 v[204:207], v63 offset:61440
    v_pk_fma_f32 v[136:137], v[36:37], v[216:217], v[136:137] op_sel:[0,0,0] op_sel_hi:[0,1,1]
    v_pk_fma_f32 v[138:139], v[36:37], v[218:219], v[138:139] op_sel:[0,0,0] op_sel_hi:[0,1,1]
    ds_write_b128 v82, v[136:139] offset:10240
    v_pk_fma_f32 v[140:141], v[36:37], v[220:221], v[140:141] op_sel:[0,0,0] op_sel_hi:[0,1,1]
    v_pk_fma_f32 v[142:143], v[36:37], v[222:223], v[142:143] op_sel:[0,0,0] op_sel_hi:[0,1,1]
    ds_write_b128 v82, v[140:143] offset:10304
    v_pk_fma_f32 v[144:145], v[36:37], v[224:225], v[144:145] op_sel:[0,0,0] op_sel_hi:[0,1,1]
    v_pk_fma_f32 v[146:147], v[36:37], v[226:227], v[146:147] op_sel:[0,0,0] op_sel_hi:[0,1,1]
    ds_write_b128 v82, v[144:147] offset:10368
    v_pk_fma_f32 v[148:149], v[36:37], v[228:229], v[148:149] op_sel:[0,0,0] op_sel_hi:[0,1,1]
    v_pk_fma_f32 v[150:151], v[36:37], v[230:231], v[150:151] op_sel:[0,0,0] op_sel_hi:[0,1,1]
    ds_write_b128 v82, v[148:151] offset:10432
    v_pk_fma_f32 v[152:153], v[36:37], v[232:233], v[152:153] op_sel:[0,0,0] op_sel_hi:[0,1,1]
    v_pk_fma_f32 v[154:155], v[36:37], v[234:235], v[154:155] op_sel:[0,0,0] op_sel_hi:[0,1,1]
    ds_write_b128 v82, v[152:155] offset:10496
    s_waitcnt lgkmcnt(9)
    v_pk_add_f32 v[176:177], v[176:177], v[180:181]
    v_pk_add_f32 v[184:185], v[184:185], v[188:189]
    v_pk_add_f32 v[178:179], v[178:179], v[182:183]
    v_pk_add_f32 v[186:187], v[186:187], v[190:191]
    v_pk_add_f32 v[52:53], v[52:53], v[176:177]
    v_pk_add_f32 v[72:73], v[72:73], v[178:179]
    v_pk_add_f32 v[176:177], v[52:53], v[184:185]
    v_pk_add_f32 v[178:179], v[72:73], v[186:187]
    buffer_store_dwordx4 v[176:179], v67, s[16:19], 0 offen sc1
    v_pk_fma_f32 v[156:157], v[38:39], v[236:237], v[156:157] op_sel:[0,0,0] op_sel_hi:[0,1,1]
    v_pk_fma_f32 v[158:159], v[38:39], v[238:239], v[158:159] op_sel:[0,0,0] op_sel_hi:[0,1,1]
    ds_write_b128 v82, v[156:159] offset:15360
    v_pk_fma_f32 v[160:161], v[38:39], v[240:241], v[160:161] op_sel:[0,0,0] op_sel_hi:[0,1,1]
    v_pk_fma_f32 v[162:163], v[38:39], v[242:243], v[162:163] op_sel:[0,0,0] op_sel_hi:[0,1,1]
    ds_write_b128 v82, v[160:163] offset:15424
    v_pk_fma_f32 v[164:165], v[38:39], v[244:245], v[164:165] op_sel:[0,0,0] op_sel_hi:[0,1,1]
    v_pk_fma_f32 v[166:167], v[38:39], v[246:247], v[166:167] op_sel:[0,0,0] op_sel_hi:[0,1,1]
    ds_write_b128 v82, v[164:167] offset:15488
    v_pk_fma_f32 v[168:169], v[38:39], v[248:249], v[168:169] op_sel:[0,0,0] op_sel_hi:[0,1,1]
    v_pk_fma_f32 v[170:171], v[38:39], v[250:251], v[170:171] op_sel:[0,0,0] op_sel_hi:[0,1,1]
    ds_write_b128 v82, v[168:171] offset:15552
    v_pk_fma_f32 v[172:173], v[38:39], v[252:253], v[172:173] op_sel:[0,0,0] op_sel_hi:[0,1,1]
    v_pk_fma_f32 v[174:175], v[38:39], v[254:255], v[174:175] op_sel:[0,0,0] op_sel_hi:[0,1,1]
    ds_write_b128 v82, v[172:175] offset:15616
    s_waitcnt lgkmcnt(10)
    v_pk_add_f32 v[192:193], v[192:193], v[196:197]
    v_pk_add_f32 v[200:201], v[200:201], v[204:205]
    v_pk_add_f32 v[194:195], v[194:195], v[198:199]
    v_pk_add_f32 v[202:203], v[202:203], v[206:207]
    v_pk_add_f32 v[54:55], v[54:55], v[192:193]
    v_pk_add_f32 v[74:75], v[74:75], v[194:195]
    v_pk_add_f32 v[192:193], v[54:55], v[200:201]
    v_pk_add_f32 v[194:195], v[74:75], v[202:203]
    buffer_store_dwordx4 v[192:195], v68, s[16:19], 0 offen sc1
    s_waitcnt lgkmcnt(0)
    s_barrier
    ds_read_b128 v[208:211], v64 offset:0
    ds_read_b128 v[212:215], v64 offset:20480
    ds_read_b128 v[216:219], v64 offset:40960
    ds_read_b128 v[220:223], v64 offset:61440
    ds_read_b128 v[224:227], v65 offset:0
    ds_read_b128 v[228:231], v65 offset:20480
    ds_read_b128 v[232:235], v65 offset:40960
    ds_read_b128 v[236:239], v65 offset:61440
    ds_read_b128 v[240:243], v66 offset:0
    ds_read_b128 v[244:247], v66 offset:20480
    ds_read_b128 v[248:251], v66 offset:40960
    ds_read_b128 v[252:255], v66 offset:61440
    s_waitcnt lgkmcnt(8)
    v_pk_add_f32 v[208:209], v[208:209], v[212:213]
    v_pk_add_f32 v[216:217], v[216:217], v[220:221]
    v_pk_add_f32 v[210:211], v[210:211], v[214:215]
    v_pk_add_f32 v[218:219], v[218:219], v[222:223]
    v_pk_add_f32 v[56:57], v[56:57], v[208:209]
    v_pk_add_f32 v[76:77], v[76:77], v[210:211]
    v_pk_add_f32 v[208:209], v[56:57], v[216:217]
    v_pk_add_f32 v[210:211], v[76:77], v[218:219]
    buffer_store_dwordx4 v[208:211], v69, s[16:19], 0 offen sc1
    s_waitcnt lgkmcnt(4)
    v_pk_add_f32 v[224:225], v[224:225], v[228:229]
    v_pk_add_f32 v[232:233], v[232:233], v[236:237]
    v_pk_add_f32 v[226:227], v[226:227], v[230:231]
    v_pk_add_f32 v[234:235], v[234:235], v[238:239]
    v_pk_add_f32 v[58:59], v[58:59], v[224:225]
    v_pk_add_f32 v[78:79], v[78:79], v[226:227]
    v_pk_add_f32 v[224:225], v[58:59], v[232:233]
    v_pk_add_f32 v[226:227], v[78:79], v[234:235]
    buffer_store_dwordx4 v[224:227], v70, s[16:19], 0 offen sc1
    s_waitcnt lgkmcnt(0)
    v_pk_add_f32 v[240:241], v[240:241], v[244:245]
    v_pk_add_f32 v[248:249], v[248:249], v[252:253]
    v_pk_add_f32 v[242:243], v[242:243], v[246:247]
    v_pk_add_f32 v[250:251], v[250:251], v[254:255]
    v_pk_add_f32 v[60:61], v[60:61], v[240:241]
    v_pk_add_f32 v[80:81], v[80:81], v[242:243]
    v_pk_add_f32 v[240:241], v[60:61], v[248:249]
    v_pk_add_f32 v[242:243], v[80:81], v[250:251]
    buffer_store_dwordx4 v[240:243], v71, s[16:19], 0 offen sc1
L_end:
    s_endpgm

.section .rodata,"a"
.p2align 6
.amdhsa_kernel gated_mix__ssm_conv_s5__dense_activation_squared_relu__prompt_kernel
  .amdhsa_next_free_vgpr 512
  .amdhsa_next_free_sgpr 102
  .amdhsa_accum_offset 256
  .amdhsa_group_segment_fixed_size 0
  .amdhsa_kernarg_size 144
  .amdhsa_user_sgpr_count 2
  .amdhsa_user_sgpr_kernarg_segment_ptr 1
  .amdhsa_system_sgpr_workgroup_id_x 1
  .amdhsa_float_denorm_mode_32 3
.end_amdhsa_kernel
```
